```python
import torch

def _softmax(x, axis=-1):
    return torch.softmax(x, dim=axis)
def _gelu(x):
    return torch.nn.functional.gelu(x, approximate="tanh")
def _silu(x):
    return torch.nn.functional.silu(x)
def _sigmoid(x):
    return torch.sigmoid(x)
def _layernorm(x, axis=-1, eps=1e-5):
    m = x.mean(dim=axis, keepdim=True)
    v = x.var(dim=axis, keepdim=True, unbiased=False)
    return (x - m) / torch.sqrt(v + eps)
def _scatter_add(tgt, idx, src, axis=0):
    return tgt.clone().index_add_(axis, idx, src)
def _segment_sum(src, seg, n):
    out = torch.zeros((n,) + src.shape[1:], dtype=src.dtype)
    return out.index_add_(0, seg, src)
def _pad(x, pw):
    flat = tuple(v for pair in reversed(pw) for v in pair)
    return torch.nn.functional.pad(x, flat)

kernel_name = 'parallel_sum__ssm_conv_s5__mixer_channel_mlp__prompt'

def setup_inputs():

    _w = (lambda a: (lambda t: t.to(torch.bfloat16) if t.is_floating_point() else t)(torch.as_tensor(a)))
    def _A_setup():
        B, S, D = 1, 2048, 640
        P = D
        Lambda_re = -0.5 * (lambda _x: torch.exp(torch.as_tensor(_x)))((lambda *s: torch.randn(*s, dtype=torch.bfloat16) * 0.2)(P))
        Lambda_im = (lambda *s: torch.randn(*s, dtype=torch.bfloat16) * 0.8)(P) * 1.0
        B_re = (lambda *s: torch.randn(*s, dtype=torch.bfloat16) * 0.2)(P, D) * (D ** -0.5)
        B_im = (lambda *s: torch.randn(*s, dtype=torch.bfloat16) * 0.2)(P, D) * (D ** -0.5)
        C_re = (lambda *s: torch.randn(*s, dtype=torch.bfloat16) * 0.2)(D, P) * (P ** -0.5)
        C_im = (lambda *s: torch.randn(*s, dtype=torch.bfloat16) * 0.2)(D, P) * (P ** -0.5)
        log_dt = (lambda *s: torch.randn(*s, dtype=torch.bfloat16) * 0.2)(P) * 0.3 - 2.0
        Dskip = (lambda *s: torch.randn(*s, dtype=torch.bfloat16) * 0.05)(D)
        return {
            "x": _w((lambda *s: torch.randn(*s, dtype=torch.bfloat16) * 0.05)(B, S, D)),
            "Lambda_re": _w(Lambda_re),
            "Lambda_im": _w(Lambda_im),
            "B_re": _w(B_re),
            "B_im": _w(B_im),
            "C_re": _w(C_re),
            "C_im": _w(C_im),
            "log_dt": _w(log_dt),
            "Dskip": _w(Dskip),
        }
    _A_in = _A_setup()

    def _B_setup():
        B, S, D, F = 1, 2048, 640, 1536
        return {
            "x": _w((lambda *s: torch.randn(*s, dtype=torch.bfloat16) * 0.05)(B, S, D)),
            "w1": _w((lambda *s: torch.randn(*s, dtype=torch.bfloat16) * 1.6)(D, F) * (D ** -0.5)),
            "b1": _w((lambda *s: torch.randn(*s, dtype=torch.bfloat16) * 0.8)(F)),
            "w2": _w((lambda *s: torch.randn(*s, dtype=torch.bfloat16) * 0.05)(F, D) * (F ** -0.5)),
            "b2": _w((lambda *s: torch.randn(*s, dtype=torch.bfloat16) * 0.05)(D)),
        }
    _B_in = _B_setup()

    return {
        "A_x": _A_in["x"],
        "A_Lambda_re": _A_in["Lambda_re"],
        "A_Lambda_im": _A_in["Lambda_im"],
        "A_B_re": _A_in["B_re"],
        "A_B_im": _A_in["B_im"],
        "A_C_re": _A_in["C_re"],
        "A_C_im": _A_in["C_im"],
        "A_log_dt": _A_in["log_dt"],
        "A_Dskip": _A_in["Dskip"],
        "B_x": _B_in["x"],
        "B_w1": _B_in["w1"],
        "B_b1": _B_in["b1"],
        "B_w2": _B_in["w2"],
        "B_b2": _B_in["b2"],
    }

def reference(A_x, A_Lambda_re, A_Lambda_im, A_B_re, A_B_im, A_C_re, A_C_im, A_log_dt, A_Dskip, B_x, B_w1, B_b1, B_w2, B_b2):
    def _A_ref(x, Lambda_re, Lambda_im, B_re, B_im, C_re, C_im, log_dt, Dskip):
        Bsz, L, H = x.shape
        Lam = Lambda_re + 1j * Lambda_im
        Bmat = B_re + 1j * B_im
        Cmat = C_re + 1j * C_im
        dt = torch.exp(log_dt)
        Lam_bar = torch.exp(dt * Lam)
        B_bar = ((Lam_bar - 1.0) / Lam)[:, None] * Bmat
        Bu = torch.einsum("bld,pd->blp", x + 0j, B_bar)
        h = torch.zeros_like(Bu[:, 0, :])
        hs = []
        for t in range(L):
            h = Lam_bar[None, :] * h + Bu[:, t, :]
            hs.append(h)
        hseq = torch.stack(hs, 1)
        y = 2.0 * torch.einsum("blp,dp->bld", hseq, Cmat).real + x * Dskip[None, None, :]
        return y

    def _B_ref(x, w1, b1, w2, b2):
        y = _layernorm(x, axis=-1)
        h = _gelu(torch.einsum("bsd,df->bsf", y, w1) + b1)
        return torch.einsum("bsf,fd->bsd", h, w2) + b2

    x = A_x
    xn = _layernorm(x, axis=-1)
    return x + _A_ref(xn, A_Lambda_re, A_Lambda_im, A_B_re, A_B_im, A_C_re, A_C_im, A_log_dt, A_Dskip) + _B_ref(xn, B_w1, B_b1, B_w2, B_b2)
```

```asm
; @launch grid=(256,1,1) block=(256,1,1) lds=163840
.amdgcn_target "amdgcn-amd-amdhsa--gfx950"
.text
.globl parallel_sum__ssm_conv_s5__mixer_channel_mlp__prompt_kernel
.p2align 8
.type parallel_sum__ssm_conv_s5__mixer_channel_mlp__prompt_kernel,@function
parallel_sum__ssm_conv_s5__mixer_channel_mlp__prompt_kernel:
    s_cmp_ge_u32 s2, 256
    s_cbranch_scc1 L_end
    s_load_dwordx16 s[16:31], s[0:1], 0
    s_load_dwordx16 s[32:47], s[0:1], 64
    s_load_dwordx2 s[48:49], s[0:1], 128
    s_getpc_b64 s[84:85]
    s_lshr_b32 s13, s2, 3
    s_lshl_b32 s13, s13, 11
    v_lshrrev_b32 v40, 6, v0
    v_lshlrev_b32 v40, 9, v40
    v_and_b32 v41, 3, v0
    v_lshl_add_u32 v40, v41, 7, v40
    v_add_u32 v40, s13, v40
    v_min_u32 v40, CODE_BYTES, v40
    global_load_dword v12, v40, s[84:85]
    v_lshrrev_b32 v40, 6, v0
    v_and_b32 v1, 63, v0
    v_readfirstlane_b32 s3, v40
    s_and_b32 s12, s2, 7
    s_lshr_b32 s13, s2, 3
    s_lshr_b32 s8, s13, 4
    s_bfe_u32 s9, s13, 0x20002
    s_lshr_b32 s6, s12, 1
    s_lshl_b32 s14, s9, 2
    s_add_u32 s6, s6, s14
    s_and_b32 s14, s13, 3
    s_lshl_b32 s10, s8, 2
    s_add_u32 s10, s10, s14
    s_and_b32 s7, s12, 1
    s_lshl_b32 s7, s7, 2
    s_add_u32 s7, s7, s14
    s_lshr_b32 s4, s3, 1
    s_and_b32 s5, s3, 1
    v_lshrrev_b32 v40, 3, v1
    v_and_b32 v41, 7, v1
    v_lshrrev_b32 v42, 1, v40
    v_xor_b32 v42, v41, v42
    v_mul_u32_u24 v43, 5120, v40
    v_lshl_add_u32 v4, v42, 4, v43
    v_xor_b32 v5, 64, v4
    v_add_u32 v5, 40960, v5
    s_lshl_b32 s12, s6, 7
    s_lshl_b32 s13, s4, 6
    s_add_u32 s12, s12, s13
    s_lshl_b32 s13, s5, 1
    s_add_u32 s12, s12, s13
    s_mul_i32 s72, s12, 1280
    s_lshl_b32 s73, s3, 12
    s_cmp_eq_u32 s8, 1
    s_cbranch_scc1 L_e_mlp
    v_and_b32 v42, 6, v40
    v_or_b32 v43, s5, v42
    v_xor_b32 v41, v41, v43
    v_lshlrev_b32 v41, 4, v41
    v_and_b32 v43, 1, v40
    v_lshl_add_u32 v42, v42, 2, v43
    v_mul_u32_u24 v42, 1280, v42
    v_add_u32 v8, v42, v41
    v_add_u32 v42, 32, v40
    v_mul_u32_u24 v42, 1280, v42
    v_add_u32 v9, v42, v41
    s_mul_i32 s12, s7, 80
    s_mul_i32 s13, s4, 40
    s_add_u32 s12, s12, s13
    s_mul_i32 s75, s12, 1280
    s_add_u32 s76, s75, 5120
    s_mul_i32 s74, s4, 10240
    s_lshl_b32 s12, s5, 10
    s_add_u32 s74, s74, s12
    s_add_u32 s12, s10, s9
    s_and_b32 s12, s12, 0
    s_mul_i32 s12, s12, 10
    s_lshr_b32 s97, s12, 0
    s_lshl_b32 s12, s97, 7
    s_add_u32 s72, s72, s12
    s_mul_i32 s12, s97, 128
    s_add_u32 s75, s75, s12
    s_add_u32 s76, s76, s12
    s_movk_i32 s77, 128
    s_mov_b32 s51, 128
    s_waitcnt lgkmcnt(0)
    s_or_b32 s12, s2, s3
    s_cmp_lg_u32 s12, 0
    s_cbranch_scc1 L_nononce_ssm
    s_memrealtime s[12:13]
    s_waitcnt lgkmcnt(0)
    s_or_b32 s12, s12, 1
    v_mov_b32 v48, s12
    v_mov_b32 v49, 0
    global_store_dword v49, v48, s[46:47] sc1
L_nononce_ssm:
    s_mov_b32 s52, s16
    s_mov_b32 s53, s17
    s_mov_b32 s54, 2621440
    s_mov_b32 s55, 0x20000
    s_cmp_eq_u32 s5, 0
    s_cselect_b32 s56, s22, s24
    s_cselect_b32 s57, s23, s25
    s_mov_b32 s58, 819200
    s_mov_b32 s59, 0x20000
    s_add_u32 m0, s74, 90112
    s_nop 0
    buffer_load_dwordx4 v8, s[56:59], s75 offen offset:0  lds
    s_add_u32 m0, s73, 40960
    s_nop 0
    buffer_load_dwordx4 v4, s[52:55], s72 offen offset:0  lds
    s_add_u32 m0, s74, 89600
    s_nop 0
    buffer_load_dwordx4 v8, s[56:59], s75 offen offset:2560  lds
    s_add_u32 m0, s73, 41984
    s_nop 0
    buffer_load_dwordx4 v5, s[52:55], s72 offen offset:0  lds
    s_add_u32 m0, s74, 94208
    s_nop 0
    buffer_load_dwordx4 v8, s[56:59], s76 offen offset:0  lds
    s_add_u32 m0, s73, 41728
    s_nop 0
    buffer_load_dwordx4 v4, s[52:55], s72 offen offset:1280  lds
    s_add_u32 m0, s74, 93696
    s_nop 0
    buffer_load_dwordx4 v8, s[56:59], s76 offen offset:2560  lds
    s_add_u32 m0, s73, 42752
    s_nop 0
    buffer_load_dwordx4 v5, s[52:55], s72 offen offset:1280  lds
    s_add_u32 m0, s74, 98304
    s_nop 0
    buffer_load_dwordx4 v9, s[56:59], s75 offen offset:0  lds
    s_lshl_b32 s12, s2, 2
    s_add_u32 s12, s12, s3
    s_mul_i32 s12, s12, 5120
    v_min_u32 v48, 39, v1
    s_mov_b64 s[14:15], s[16:17]
    v_lshlrev_b32 v48, 7, v48
    v_add_u32 v48, s12, v48
    global_load_dword v12, v48, s[14:15]
    s_mov_b32 s60, s48
    s_mov_b32 s61, s49
    s_mov_b32 s62, 33554432
    s_mov_b32 s63, 0x20000
    s_branch L_ssm
L_e_mlp:
    v_and_b32 v42, 2, v40
    v_xor_b32 v42, v41, v42
    v_mul_u32_u24 v43, 3072, v40
    v_lshl_add_u32 v8, v42, 4, v43
    v_xor_b32 v9, 64, v8
    s_mul_i32 s75, s3, 49152
    s_mul_i32 s12, s7, 384
    s_add_u32 s75, s75, s12
    s_add_u32 s76, s75, 24576
    s_lshl_b32 s74, s3, 11
    s_add_u32 s12, s10, s9
    s_and_b32 s12, s12, 0
    s_mul_i32 s12, s12, 10
    s_lshr_b32 s97, s12, 0
    s_lshl_b32 s12, s97, 7
    s_add_u32 s72, s72, s12
    s_mul_i32 s12, s97, 196608
    s_add_u32 s75, s75, s12
    s_add_u32 s76, s76, s12
    s_movk_i32 s77, 128
    s_mov_b32 s51, 196608
    s_waitcnt lgkmcnt(0)
    s_or_b32 s12, s2, s3
    s_cmp_lg_u32 s12, 0
    s_cbranch_scc1 L_nononce_mlp
    s_memrealtime s[12:13]
    s_waitcnt lgkmcnt(0)
    s_or_b32 s12, s12, 1
    v_mov_b32 v48, s12
    v_mov_b32 v49, 0
    global_store_dword v49, v48, s[46:47] sc1
L_nononce_mlp:
    s_mov_b32 s52, s16
    s_mov_b32 s53, s17
    s_mov_b32 s54, 2621440
    s_mov_b32 s55, 0x20000
    s_mov_b32 s56, s36
    s_mov_b32 s57, s37
    s_mov_b32 s58, 1966080
    s_mov_b32 s59, 0x20000
    s_add_u32 m0, s74, 90112
    s_nop 0
    buffer_load_dwordx4 v8, s[56:59], s75 offen offset:0  lds
    s_add_u32 m0, s73, 40960
    s_nop 0
    buffer_load_dwordx4 v4, s[52:55], s72 offen offset:0  lds
    s_add_u32 m0, s74, 98176
    s_nop 0
    buffer_load_dwordx4 v8, s[56:59], s75 offen offset:128  lds
    s_add_u32 m0, s73, 41984
    s_nop 0
    buffer_load_dwordx4 v5, s[52:55], s72 offen offset:0  lds
    s_add_u32 m0, s74, 106240
    s_nop 0
    buffer_load_dwordx4 v8, s[56:59], s75 offen offset:256  lds
    s_add_u32 m0, s74, 91136
    s_nop 0
    buffer_load_dwordx4 v9, s[56:59], s76 offen offset:0  lds
    s_add_u32 m0, s73, 41728
    s_nop 0
    buffer_load_dwordx4 v4, s[52:55], s72 offen offset:1280  lds
    s_add_u32 m0, s74, 99200
    s_nop 0
    buffer_load_dwordx4 v9, s[56:59], s76 offen offset:128  lds
    s_add_u32 m0, s73, 42752
    s_nop 0
    buffer_load_dwordx4 v5, s[52:55], s72 offen offset:1280  lds
    s_add_u32 m0, s74, 107264
    s_nop 0
    buffer_load_dwordx4 v9, s[56:59], s76 offen offset:256  lds
    s_and_b32 s12, s2, 127
    s_lshl_b32 s13, s12, 1
    s_add_u32 s13, s13, s5
    s_mul_i32 s13, s13, 7680
    s_mul_i32 s12, s12, 6400
    s_cmp_eq_u32 s5, 0
    s_cselect_b64 s[14:15], s[22:23], s[24:25]
    s_cmp_eq_u32 s4, 0
    s_cselect_b32 s12, s12, s13
    s_cselect_b32 s13, 49, 59
    s_cselect_b64 s[14:15], s[14:15], s[36:37]
    v_min_u32 v48, s13, v1
    v_lshlrev_b32 v48, 7, v48
    v_add_u32 v48, s12, v48
    global_load_dword v12, v48, s[14:15]
    s_mov_b32 s60, s48
    s_mov_b32 s61, s49
    s_mov_b32 s62, 33554432
    s_mov_b32 s63, 0x20000
    s_branch L_mlp
L_ssm:
    v_and_b32 v2, 15, v1
    v_lshrrev_b32 v3, 4, v1
    v_lshlrev_b32 v26, 4, v1
    s_xor_b32 s50, s4, s5
    s_xor_b32 s88, s8, 1
    s_mov_b32 s81, 0x40000
    s_and_b32 s14, s2, 127
    s_sub_u32 s78, 127, s14
    s_cmp_lt_u32 s78, 96
    s_cselect_b32 s78, s78, 0
    s_cselect_b32 s89, 0, 67108864
    s_lshl_b32 s14, s50, 2
    v_add_u32 v44, s14, v3
    v_lshrrev_b32 v45, 1, v2
    v_xor_b32 v45, v44, v45
    v_lshlrev_b32 v45, 4, v45
    v_lshl_add_u32 v45, v2, 7, v45
    s_lshl_b32 s13, s5, 13
    s_add_u32 s13, s13, 40960
    v_add_u32 v6, s13, v45
    v_xor_b32 v7, 64, v6
    v_and_b32 v41, 1, v2
    v_lshrrev_b32 v42, 2, v2
    v_lshl_add_u32 v42, v42, 1, v41
    v_xor_b32 v40, v44, v42
    v_lshlrev_b32 v40, 4, v40
    v_lshl_add_u32 v40, v41, 10, v40
    v_lshrrev_b32 v42, 1, v2
    v_lshl_add_u32 v40, v42, 7, v40
    s_mul_i32 s12, s4, 10240
    s_add_u32 s12, s12, 90112
    v_add_u32 v14, s12, v40
    v_xor_b32 v15, 64, v14
    v_mov_b32 v46, 0x3f803f80
    v_cmp_eq_u32 vcc, 0, v2
    s_nop 1
    v_cndmask_b32 v46, 0, v46, vcc
    v_accvgpr_write_b32 a80, v46
    v_accvgpr_write_b32 a81, v46
    v_accvgpr_write_b32 a82, v46
    v_accvgpr_write_b32 a83, v46
    s_lshl_b32 s12, s8, 3
    s_add_u32 s12, s12, s7
    s_lshl_b32 s12, s12, 2
    s_add_u32 s12, s12, s3
    s_lshl_b32 s12, s12, 1
    s_lshl_b32 s13, s6, 7
    s_add_u32 s87, s12, s13
    s_mul_i32 s86, s87, 1280
    v_lshrrev_b32 v134, 5, v1
    v_mul_u32_u24 v134, 1280, v134
    v_and_b32 v135, 31, v1
    v_lshl_add_u32 v135, v135, 3, v134
    v_lshlrev_b32 v137, 1, v135
    v_sub_u32 v134, v137, v134
    v_mul_u32_u24 v39, 820, v0
    v_lshrrev_b32 v39, 16, v39
    v_min_u32 v39, 2, v39
    v_mul_u32_u24 v41, 80, v39
    v_sub_u32 v38, v0, v41
    v_min_u32 v38, 79, v38
    s_mul_i32 s12, s7, 160
    v_lshlrev_b32 v41, 1, v38
    s_mov_b32 s66, 1280
    s_mov_b32 s67, 0x20000
    s_mov_b32 s64, s18
    s_mov_b32 s65, s19
    buffer_load_ushort v100, v41, s[64:67], s12 offen
    s_mov_b32 s64, s20
    s_mov_b32 s65, s21
    buffer_load_ushort v101, v41, s[64:67], s12 offen
    s_mov_b32 s64, s30
    s_mov_b32 s65, s31
    buffer_load_ushort v102, v41, s[64:67], s12 offen
    v_lshrrev_b32 v40, 3, v1
    v_and_b32 v41, 7, v1
    v_mul_u32_u24 v40, 1280, v40
    v_lshl_add_u32 v40, v41, 4, v40
    v_or_b32 v11, s89, v40
    v_or_b32 v27, s89, v26
    s_lshl_b32 s12, s4, 26
    v_or_b32 v121, s12, v27
    s_lshl_b32 s80, s3, 10
    s_and_b32 s12, s78, 1
    s_lshr_b32 s13, s78, 1
    s_mov_b32 s67, 0x20000
    s_mov_b32 s64, s40
    s_mov_b32 s65, s41
    s_mov_b32 s66, 1966080
    s_lshl_b32 s14, s13, 2
    s_add_u32 s14, s14, s3
    s_mul_i32 s79, s14, 10240
    s_mul_i32 s14, s13, 5462
    s_lshr_b32 s14, s14, 16
    s_mul_i32 s14, s14, 10
    s_add_u32 s13, s13, s14
    s_mul_i32 s13, s13, 5120
    s_add_u32 s13, s13, 12582912
    s_mul_i32 s14, s12, 20
    s_add_u32 s14, s14, s3
    s_add_u32 s14, s14, 10
    s_mul_i32 s15, s14, 13108
    s_lshr_b32 s15, s15, 16
    s_mul_i32 s15, s15, 435
    s_add_u32 s15, s15, s14
    s_lshl_b32 s15, s15, 10
    s_add_u32 s92, s15, s13
    s_add_u32 s14, s14, 4
    s_mul_i32 s15, s14, 13108
    s_lshr_b32 s15, s15, 16
    s_mul_i32 s15, s15, 435
    s_add_u32 s15, s15, s14
    s_lshl_b32 s15, s15, 10
    s_add_u32 s93, s15, s13
    s_add_u32 s14, s14, 4
    s_mul_i32 s15, s14, 13108
    s_lshr_b32 s15, s15, 16
    s_mul_i32 s15, s15, 435
    s_add_u32 s15, s15, s14
    s_lshl_b32 s15, s15, 10
    s_add_u32 s94, s15, s13
    s_add_u32 s14, s14, 4
    v_lshrrev_b32 v40, 2, v2
    v_lshl_add_u32 v40, v3, 2, v40
    v_lshlrev_b32 v40, 7, v40
    v_and_b32 v41, 3, v2
    v_lshl_add_u32 v40, v41, 3, v40
    s_lshl_b32 s14, s3, 5
    s_add_u32 s14, s14, 20480
    s_mul_i32 s15, s4, 3968
    s_add_u32 s14, s14, s15
    s_add_u32 s14, s14, 64
    v_add_u32 v120, s14, v40
    s_mul_i32 s12, s12, 640
    s_add_u32 s79, s79, s12
    s_add_u32 s79, s79, 256
    s_lshl_b32 s78, s78, 1
    s_add_u32 s78, s78, 1
    s_mul_i32 s12, s7, 160
    s_mov_b32 s68, s32
    s_mov_b32 s69, s33
    s_mov_b32 s70, 1280
    s_mov_b32 s71, 0x20000
    s_mov_b32 m0, 20160
    s_mov_b32 exec_lo, 1023
    s_mov_b32 exec_hi, 0
    buffer_load_dwordx4 v26, s[68:71], s12 offen lds
    s_mov_b64 exec, -1
    s_mov_b32 s68, s42
    s_mov_b32 s69, s43
    s_mov_b32 s70, 1280
    s_mov_b32 s71, 0x20000
    s_mov_b32 m0, 20320
    s_mov_b32 exec_lo, 1023
    s_mov_b32 exec_hi, 0
    buffer_load_dwordx4 v26, s[68:71], s12 offen lds
    s_mov_b64 exec, -1
    s_mov_b32 s68, s28
    s_mov_b32 s69, s29
    s_mov_b32 s70, 819200
    s_mov_b32 s71, 0x20000
    s_mov_b64 s[84:85], s[26:27]
    v_add_u32 v40, 0, v1
    v_mul_u32_u24 v41, 3277, v40
    v_lshrrev_b32 v41, 16, v41
    v_mul_u32_u24 v42, 20, v41
    v_sub_u32 v42, v40, v42
    v_mul_u32_u24 v41, 1280, v41
    v_lshl_add_u32 v20, v42, 4, v41
    v_add_u32 v40, 64, v1
    v_mul_u32_u24 v41, 3277, v40
    v_lshrrev_b32 v41, 16, v41
    v_mul_u32_u24 v42, 20, v41
    v_sub_u32 v42, v40, v42
    v_mul_u32_u24 v41, 1280, v41
    v_lshl_add_u32 v21, v42, 4, v41
    v_add_u32 v40, 128, v1
    v_mul_u32_u24 v41, 3277, v40
    v_lshrrev_b32 v41, 16, v41
    v_mul_u32_u24 v42, 20, v41
    v_sub_u32 v42, v40, v42
    v_mul_u32_u24 v41, 1280, v41
    v_lshl_add_u32 v22, v42, 4, v41
    v_add_u32 v40, 192, v1
    v_mul_u32_u24 v41, 3277, v40
    v_lshrrev_b32 v41, 16, v41
    v_mul_u32_u24 v42, 20, v41
    v_sub_u32 v42, v40, v42
    v_mul_u32_u24 v41, 1280, v41
    v_lshl_add_u32 v23, v42, 4, v41
    v_add_u32 v40, 256, v1
    v_mul_u32_u24 v41, 3277, v40
    v_lshrrev_b32 v41, 16, v41
    v_mul_u32_u24 v42, 20, v41
    v_sub_u32 v42, v40, v42
    v_mul_u32_u24 v41, 1280, v41
    v_lshl_add_u32 v24, v42, 4, v41
    s_mul_i32 s42, s7, 102400
    s_mul_i32 s12, s3, 320
    s_add_u32 s42, s42, s12
    s_mul_i32 s13, s3, 5120
    s_add_u32 s18, s13, 20480
    s_add_u32 s19, s13, 110592
    s_add_u32 s20, s13, 57344
    s_add_u32 s21, s13, 131072
    s_mov_b32 s12, 77824
    s_cmp_eq_u32 s4, 0
    s_cselect_b32 s12, s12, 141312
    s_add_u32 s35, s13, s12
    s_and_b32 s14, s7, 3
    s_add_u32 s14, s14, s9
    s_and_b32 s14, s14, 3
    s_mul_i32 s14, s14, 0
    s_lshr_b32 s14, s14, 2
    s_sub_u32 s26, 10, s14
    s_mul_i32 s12, s3, 22
    s_add_u32 s12, s12, s14
    s_add_u32 s12, s12, 12
    s_mul_i32 s13, s7, 88
    s_add_u32 s13, s13, s12
    s_mul_i32 s13, s13, 5120
    s_add_u32 s27, s13, 12531712
    s_lshl_b32 s13, s6, 1
    s_add_u32 s13, s13, s88
    s_mul_i32 s14, s13, 88
    s_add_u32 s14, s14, s12
    s_lshl_b32 s14, s14, 12
    s_add_u32 s24, s14, 4096
    s_sub_u32 s25, s24, 40960
    s_sub_u32 s22, s24, 360448
    s_sub_u32 s23, s22, 40960
    s_mul_i32 s34, s3, 20480
    s_add_u32 s34, s34, 20480
    s_mul_i32 s12, s3, 320
    s_add_u32 s12, s12, 18688
    v_lshlrev_b32 v77, 4, v3
    v_add_u32 v76, s12, v77
    v_min_u32 v78, 1, v2
    v_mul_u32_u24 v78, 0x30000, v78
    v_add_u32 v76, v76, v78
    s_mul_i32 s12, s4, 640
    s_add_u32 s12, s12, 18688
    v_add_u32 v77, s12, v77
    s_lshl_b32 s12, s5, 10
    v_lshlrev_b32 v78, 6, v2
    v_add_u32 v78, s12, v78
    v_lshlrev_b32 v79, 3, v0
    v_lshrrev_b32 v82, 4, v0
    v_lshlrev_b32 v83, 3, v82
    v_lshlrev_b32 v87, 2, v2
    v_cvt_f32_u32 v87, v87
    v_lshlrev_b32 v84, 7, v82
    v_lshl_add_u32 v84, v2, 3, v84
    v_ffbl_b32 v85, v2
    v_lshlrev_b32 v85, 3, v85
    v_lshl_add_u32 v85, v82, 6, v85
    v_bcnt_u32_b32 v86, v2, -1
    v_min_u32 v86, 1, v86
    v_mul_u32_u24 v86, 0x30000, v86
    v_add_u32 v85, v85, v86
    s_mul_i32 s12, s4, 40
    v_lshlrev_b32 v96, 3, v3
    v_add_u32 v96, s12, v96
    v_lshlrev_b32 v97, 1, v3
    v_add_u32 v97, s12, v97
    v_add_u32 v97, 32, v97
    v_lshlrev_b32 v28, 6, v96
    v_lshlrev_b32 v29, 6, v97
    v_lshlrev_b32 v98, 3, v2
    v_lshl_add_u32 v30, v96, 7, v98
    v_lshl_add_u32 v31, v97, 7, v98
    s_mul_i32 s12, s5, 640
    v_lshlrev_b32 v32, 3, v96
    v_lshlrev_b32 v33, 3, v97
    v_add_u32 v32, s12, v32
    v_add_u32 v33, s12, v33
    v_sub_u32 v98, 15, v2
    v_min_u32 v98, 1, v98
    v_mul_u32_u24 v98, 0x30000, v98
    v_add_u32 v37, v98, v32
    v_add_u32 v119, v98, v33
    v_lshlrev_b32 v34, 3, v38
    v_lshlrev_b32 v35, 6, v38
    v_lshlrev_b32 v96, 4, v38
    v_lshl_add_u32 v36, v39, 26, v96
    v_mul_u32_u24 v98, 5, v39
    v_sub_u32 v98, s6, v98
    v_add_u32 v98, -1, v98
    v_mul_i32_i24 v114, 1280, v98
    v_cmp_le_i32 s[28:29], 0, v98
    v_add_u32 v114, v114, v96
    v_min_u32 v114, 67108864, v114
    v_add_u32 v98, -1, v98
    v_mul_i32_i24 v115, 1280, v98
    v_cmp_le_i32 s[30:31], 0, v98
    v_add_u32 v115, v115, v96
    v_min_u32 v115, 67108864, v115
    v_add_u32 v98, -1, v98
    v_mul_i32_i24 v116, 1280, v98
    v_cmp_le_i32 s[36:37], 0, v98
    v_add_u32 v116, v116, v96
    v_min_u32 v116, 67108864, v116
    v_add_u32 v98, -1, v98
    v_mul_i32_i24 v117, 1280, v98
    v_cmp_le_i32 s[38:39], 0, v98
    v_add_u32 v117, v117, v96
    v_min_u32 v117, 67108864, v117
    v_add_u32 v98, -1, v98
    v_mul_i32_i24 v118, 1280, v98
    v_cmp_le_i32 s[40:41], 0, v98
    v_add_u32 v118, v118, v96
    v_min_u32 v118, 67108864, v118
    s_add_u32 s72, s72, 128
    s_add_u32 s75, s75, 128
    s_add_u32 s76, s76, 128
    s_add_u32 m0, s74, 114688
    s_nop 0
    buffer_load_dwordx4 v8, s[56:59], s75 offen offset:0  lds
    s_add_u32 m0, s73, 57344
    s_nop 0
    buffer_load_dwordx4 v4, s[52:55], s72 offen offset:0  lds
    s_add_u32 m0, s74, 114176
    s_nop 0
    buffer_load_dwordx4 v8, s[56:59], s75 offen offset:2560  lds
    s_add_u32 m0, s73, 58368
    s_nop 0
    buffer_load_dwordx4 v5, s[52:55], s72 offen offset:0  lds
    s_add_u32 m0, s74, 118784
    s_nop 0
    buffer_load_dwordx4 v8, s[56:59], s76 offen offset:0  lds
    s_add_u32 m0, s73, 58112
    s_nop 0
    buffer_load_dwordx4 v4, s[52:55], s72 offen offset:1280  lds
    s_add_u32 m0, s74, 118272
    s_nop 0
    buffer_load_dwordx4 v8, s[56:59], s76 offen offset:2560  lds
    s_add_u32 m0, s73, 59136
    s_nop 0
    buffer_load_dwordx4 v5, s[52:55], s72 offen offset:1280  lds
    s_add_u32 m0, s74, 122880
    s_nop 0
    buffer_load_dwordx4 v9, s[56:59], s75 offen offset:0  lds
    s_waitcnt vmcnt(15)
    s_barrier
    ds_read_b128 a[0:3], v14 offset:0
    ds_read_b128 a[24:27], v6 offset:0
    ds_read_b128 a[4:7], v14 offset:2048
    ds_read_b128 a[28:31], v6 offset:2048
    ds_read_b128 a[8:11], v14 offset:4096
    ds_read_b128 a[32:35], v6 offset:4096
    ds_read_b128 a[12:15], v14 offset:6144
    ds_read_b128 a[36:39], v6 offset:6144
    ds_read_b128 a[16:19], v14 offset:8192
    s_waitcnt lgkmcnt(0)
    v_mfma_f32_16x16x32_bf16 v[160:163], a[0:3], a[24:27], 0
    s_add_u32 s72, s72, 128
    ds_read_b128 a[40:43], v15 offset:0
    v_mfma_f32_16x16x32_bf16 v[164:167], a[0:3], a[28:31], 0
    v_mov_b32 v13, 0
    v_mfma_f32_16x16x32_bf16 v[168:171], a[0:3], a[32:35], 0
    s_add_u32 s75, s75, 128
    ds_read_b128 a[64:67], v7 offset:0
    v_mfma_f32_16x16x32_bf16 v[172:175], a[0:3], a[36:39], 0
    s_add_u32 s76, s76, 128
    v_mfma_f32_16x16x32_bf16 v[176:179], a[4:7], a[24:27], 0
    s_add_u32 m0, s74, 139264
    ds_read_b128 a[44:47], v15 offset:2048
    v_mfma_f32_16x16x32_bf16 v[180:183], a[4:7], a[28:31], 0
    buffer_load_dwordx4 v8, s[56:59], s75 offen offset:0  lds
    v_mfma_f32_16x16x32_bf16 v[184:187], a[4:7], a[32:35], 0
    ds_read_b128 a[68:71], v7 offset:2048
    global_load_dword v13, v13, s[46:47] sc1
    v_mfma_f32_16x16x32_bf16 v[188:191], a[4:7], a[36:39], 0
    s_add_u32 m0, s73, 73728
    ds_read_b128 a[48:51], v15 offset:4096
    v_mfma_f32_16x16x32_bf16 v[192:195], a[8:11], a[24:27], 0
    buffer_load_dwordx4 v4, s[52:55], s72 offen offset:0  lds
    v_mfma_f32_16x16x32_bf16 v[196:199], a[8:11], a[28:31], 0
    ds_read_b128 a[72:75], v7 offset:4096
    v_mfma_f32_16x16x32_bf16 v[200:203], a[8:11], a[32:35], 0
    s_add_u32 m0, s74, 138752
    ds_read_b128 a[52:55], v15 offset:6144
    v_mfma_f32_16x16x32_bf16 v[204:207], a[8:11], a[36:39], 0
    buffer_load_dwordx4 v8, s[56:59], s75 offen offset:2560  lds
    v_mfma_f32_16x16x32_bf16 v[208:211], a[12:15], a[24:27], 0
    ds_read_b128 a[76:79], v7 offset:6144
    v_mfma_f32_16x16x32_bf16 v[212:215], a[12:15], a[28:31], 0
    s_add_u32 m0, s73, 74752
    ds_read_b128 a[56:59], v15 offset:8192
    v_mfma_f32_16x16x32_bf16 v[216:219], a[12:15], a[32:35], 0
    buffer_load_dwordx4 v5, s[52:55], s72 offen offset:0  lds
    v_mfma_f32_16x16x32_bf16 v[220:223], a[12:15], a[36:39], 0
    v_mfma_f32_16x16x32_bf16 v[224:227], a[16:19], a[24:27], 0
    s_add_u32 m0, s74, 143360
    v_mfma_f32_16x16x32_bf16 v[228:231], a[16:19], a[28:31], 0
    buffer_load_dwordx4 v8, s[56:59], s76 offen offset:0  lds
    v_mfma_f32_16x16x32_bf16 v[232:235], a[16:19], a[32:35], 0
    v_mfma_f32_16x16x32_bf16 v[236:239], a[16:19], a[36:39], 0
    s_waitcnt lgkmcnt(0)
    v_mfma_f32_16x16x32_bf16 v[160:163], a[40:43], a[64:67], v[160:163]
    v_mfma_f32_16x16x32_bf16 v[164:167], a[40:43], a[68:71], v[164:167]
    s_waitcnt vmcnt(6)
    s_barrier
    v_mfma_f32_16x16x32_bf16 v[168:171], a[40:43], a[72:75], v[168:171]
    s_add_u32 m0, s73, 74496
    ds_read_b128 a[0:3], v14 offset:24576
    v_mfma_f32_16x16x32_bf16 v[172:175], a[40:43], a[76:79], v[172:175]
    v_lshlrev_b32 v102, 16, v102
    v_lshlrev_b32 v100, 16, v100
    v_mfma_f32_16x16x32_bf16 v[176:179], a[44:47], a[64:67], v[176:179]
    buffer_load_dwordx4 v4, s[52:55], s72 offen offset:1280  lds
    v_mfma_f32_16x16x32_bf16 v[180:183], a[44:47], a[68:71], v[180:183]
    ds_read_b128 a[24:27], v6 offset:16384
    v_mul_f32 v102, 0x3fb8aa3b, v102
    v_mfma_f32_16x16x32_bf16 v[184:187], a[44:47], a[72:75], v[184:187]
    s_add_u32 m0, s74, 142848
    ds_read_b128 a[4:7], v14 offset:26624
    v_mfma_f32_16x16x32_bf16 v[188:191], a[44:47], a[76:79], v[188:191]
    buffer_load_dwordx4 v8, s[56:59], s76 offen offset:2560  lds
    v_mfma_f32_16x16x32_bf16 v[192:195], a[48:51], a[64:67], v[192:195]
    ds_read_b128 a[28:31], v6 offset:18432
    v_exp_f32 v102, v102
    v_mfma_f32_16x16x32_bf16 v[196:199], a[48:51], a[68:71], v[196:199]
    v_lshlrev_b32 v101, 16, v101
    v_cvt_pk_bf16_f32 v102, v102, v102
    v_mfma_f32_16x16x32_bf16 v[200:203], a[48:51], a[72:75], v[200:203]
    s_add_u32 m0, s73, 75520
    ds_read_b128 a[8:11], v14 offset:28672
    v_mfma_f32_16x16x32_bf16 v[204:207], a[48:51], a[76:79], v[204:207]
    buffer_load_dwordx4 v5, s[52:55], s72 offen offset:1280  lds
    v_mfma_f32_16x16x32_bf16 v[208:211], a[52:55], a[64:67], v[208:211]
    ds_read_b128 a[32:35], v6 offset:20480
    v_and_b32 v102, 0xffff0000, v102
    v_mfma_f32_16x16x32_bf16 v[212:215], a[52:55], a[68:71], v[212:215]
    s_add_u32 m0, s74, 147456
    v_mul_f32 v88, v102, v100
    v_mfma_f32_16x16x32_bf16 v[216:219], a[52:55], a[72:75], v[216:219]
    ds_read_b128 a[12:15], v14 offset:30720
    v_mul_f32 v89, v102, v101
    v_mfma_f32_16x16x32_bf16 v[220:223], a[52:55], a[76:79], v[220:223]
    buffer_load_dwordx4 v9, s[56:59], s75 offen offset:0  lds
    v_mfma_f32_16x16x32_bf16 v[224:227], a[56:59], a[64:67], v[224:227]
    ds_read_b128 a[36:39], v6 offset:22528
    v_mul_f32 v88, 0x3fb8aa3b, v88
    v_mfma_f32_16x16x32_bf16 v[228:231], a[56:59], a[68:71], v[228:231]
    s_add_u32 m0, s80, 20480
    v_mul_f32 v89, 0.15915494, v89
    v_mfma_f32_16x16x32_bf16 v[232:235], a[56:59], a[72:75], v[232:235]
    buffer_load_dwordx4 v11, s[64:67], s79 offen offset:0  lds
    v_mfma_f32_16x16x32_bf16 v[236:239], a[56:59], a[76:79], v[236:239]
    ds_read_b128 a[16:19], v14 offset:32768
    v_lshlrev_b32 v80, 6, v39
    v_mfma_f32_16x16x32_bf16 a[84:87], a[40:43], a[80:83], 0
    v_max_u32 v80, 1, v80
    v_mfma_f32_16x16x32_bf16 a[88:91], a[44:47], a[80:83], 0
    s_add_u32 m0, s80, 24448
    v_cvt_f32_u32 v80, v80
    v_mfma_f32_16x16x32_bf16 a[92:95], a[48:51], a[80:83], 0
    buffer_load_dwordx4 v11, s[64:67], s79 offen offset:128  lds
    v_mfma_f32_16x16x32_bf16 a[96:99], a[52:55], a[80:83], 0
    v_lshlrev_b32 v81, 3, v38
    v_mfma_f32_16x16x32_bf16 a[100:103], a[56:59], a[80:83], 0
    s_waitcnt lgkmcnt(0)
    ds_write_b64 v81, v[88:89] offset:17408
    v_mfma_f32_16x16x32_bf16 v[160:163], a[0:3], a[24:27], v[160:163]
    s_add_u32 m0, s80, 28416
    ds_read_b128 a[40:43], v15 offset:24576
    v_mfma_f32_16x16x32_bf16 v[164:167], a[0:3], a[28:31], v[164:167]
    buffer_load_dwordx4 v11, s[64:67], s79 offen offset:256  lds
    v_mfma_f32_16x16x32_bf16 v[168:171], a[0:3], a[32:35], v[168:171]
    ds_read_b128 a[64:67], v7 offset:16384
    v_mul_f32 v91, v80, v89
    v_mfma_f32_16x16x32_bf16 v[172:175], a[0:3], a[36:39], v[172:175]
    s_add_u32 s72, s72, 128
    v_mul_f32 v90, v80, v88
    v_mfma_f32_16x16x32_bf16 v[176:179], a[4:7], a[24:27], v[176:179]
    s_add_u32 s75, s75, 128
    ds_read_b128 a[44:47], v15 offset:26624
    v_mfma_f32_16x16x32_bf16 v[180:183], a[4:7], a[28:31], v[180:183]
    s_add_u32 s76, s76, 128
    ds_read_b128 a[68:71], v7 offset:18432
    v_mfma_f32_16x16x32_bf16 v[184:187], a[4:7], a[32:35], v[184:187]
    s_add_u32 m0, s74, 90112
    v_fract_f32 v91, v91
    v_mfma_f32_16x16x32_bf16 v[188:191], a[4:7], a[36:39], v[188:191]
    buffer_load_dwordx4 v8, s[56:59], s75 offen offset:0  lds
    v_mfma_f32_16x16x32_bf16 v[192:195], a[8:11], a[24:27], v[192:195]
    ds_read_b128 a[48:51], v15 offset:28672
    v_mfma_f32_16x16x32_bf16 v[196:199], a[8:11], a[28:31], v[196:199]
    s_add_u32 m0, s73, 40960
    ds_read_b128 a[72:75], v7 offset:20480
    v_mfma_f32_16x16x32_bf16 v[200:203], a[8:11], a[32:35], v[200:203]
    buffer_load_dwordx4 v4, s[52:55], s72 offen offset:0  lds
    v_mfma_f32_16x16x32_bf16 v[204:207], a[8:11], a[36:39], v[204:207]
    s_add_u32 m0, s74, 89600
    ds_read_b128 a[52:55], v15 offset:30720
    v_mfma_f32_16x16x32_bf16 v[208:211], a[12:15], a[24:27], v[208:211]
    buffer_load_dwordx4 v8, s[56:59], s75 offen offset:2560  lds
    v_mfma_f32_16x16x32_bf16 v[212:215], a[12:15], a[28:31], v[212:215]
    ds_read_b128 a[76:79], v7 offset:22528
    v_cos_f32 v92, v91
    v_mfma_f32_16x16x32_bf16 v[216:219], a[12:15], a[32:35], v[216:219]
    s_add_u32 m0, s73, 41984
    ds_read_b128 a[56:59], v15 offset:32768
    v_mfma_f32_16x16x32_bf16 v[220:223], a[12:15], a[36:39], v[220:223]
    buffer_load_dwordx4 v5, s[52:55], s72 offen offset:0  lds
    v_mfma_f32_16x16x32_bf16 v[224:227], a[16:19], a[24:27], v[224:227]
    v_sin_f32 v93, v91
    v_mfma_f32_16x16x32_bf16 v[228:231], a[16:19], a[28:31], v[228:231]
    s_add_u32 m0, s74, 94208
    v_mfma_f32_16x16x32_bf16 v[232:235], a[16:19], a[32:35], v[232:235]
    buffer_load_dwordx4 v8, s[56:59], s76 offen offset:0  lds
    v_mfma_f32_16x16x32_bf16 v[236:239], a[16:19], a[36:39], v[236:239]
    v_exp_f32 v90, v90
    s_waitcnt lgkmcnt(0)
    v_mfma_f32_16x16x32_bf16 v[160:163], a[40:43], a[64:67], v[160:163]
    v_mfma_f32_16x16x32_bf16 v[164:167], a[40:43], a[68:71], v[164:167]
    s_waitcnt vmcnt(5)
    s_barrier
    v_readfirstlane_b32 s11, v13
    s_cmp_lg_u32 s11, 0
    s_cbranch_scc1 L_ncok_ssm
L_ncl_ssm:
    s_sleep 1
    global_load_dword v13, v13, s[46:47] sc1
    s_sub_u32 s81, s81, 1
    s_cbranch_scc1 L_end
    s_waitcnt vmcnt(0)
    v_readfirstlane_b32 s11, v13
    s_cmp_eq_u32 s11, 0
    s_cbranch_scc1 L_ncl_ssm
L_ncok_ssm:
    s_nop 0
    ds_read_b64_tr_b16 v[136:137], v120 offset:0
    ds_read_b64_tr_b16 v[138:139], v120 offset:2048
    ds_read_b64_tr_b16 v[140:141], v120 offset:4096
    ds_read_b64_tr_b16 v[142:143], v120 offset:6144
    ds_read_b64_tr_b16 v[144:145], v120 offset:8192
    ds_read_b64_tr_b16 v[146:147], v120 offset:10240
    s_mov_b32 s64, s84
    s_mov_b32 s65, s85
    s_mov_b32 s66, 819200
    v_mfma_f32_16x16x32_bf16 v[168:171], a[40:43], a[72:75], v[168:171]
    buffer_load_dwordx4 v[124:127], v134, s[52:55], s86 offen offset:0
    v_mfma_f32_16x16x32_bf16 v[172:175], a[40:43], a[76:79], v[172:175]
    ds_read_b128 a[0:3], v14 offset:49152
    v_mul_f32 v156, v90, v92
    v_mfma_f32_16x16x32_bf16 v[176:179], a[44:47], a[64:67], v[176:179]
    ds_read_b128 a[24:27], v6 offset:32768
    v_mul_f32 v157, v90, v93
    v_mfma_f32_16x16x32_bf16 v[180:183], a[44:47], a[68:71], v[180:183]
    buffer_load_dwordx4 v[128:131], v134, s[52:55], s86 offen offset:512
    v_mfma_f32_16x16x32_bf16 v[184:187], a[44:47], a[72:75], v[184:187]
    ds_read_b128 a[4:7], v14 offset:51200
    v_lshlrev_b32 v81, 3, v39
    v_mfma_f32_16x16x32_bf16 v[188:191], a[44:47], a[76:79], v[188:191]
    buffer_load_dwordx2 v[132:133], v135, s[52:55], s86 offen offset:1024
    v_mfma_f32_16x16x32_bf16 v[192:195], a[48:51], a[64:67], v[192:195]
    ds_read_b128 a[28:31], v6 offset:34816
    v_min_u32 v90, 1, v39
    v_mfma_f32_16x16x32_bf16 v[196:199], a[48:51], a[68:71], v[196:199]
    v_mad_u32_u24 v81, v90, 40, v81
    v_mfma_f32_16x16x32_bf16 v[200:203], a[48:51], a[72:75], v[200:203]
    s_add_u32 m0, s73, 41728
    ds_read_b128 a[8:11], v14 offset:53248
    v_mfma_f32_16x16x32_bf16 v[204:207], a[48:51], a[76:79], v[204:207]
    buffer_load_dwordx4 v4, s[52:55], s72 offen offset:1280  lds
    v_mfma_f32_16x16x32_bf16 v[208:211], a[52:55], a[64:67], v[208:211]
    ds_read_b128 a[32:35], v6 offset:36864
    v_lshl_add_u32 v81, v38, 6, v81
    v_mfma_f32_16x16x32_bf16 v[212:215], a[52:55], a[68:71], v[212:215]
    s_add_u32 m0, s74, 93696
    v_mul_f32 v91, v100, v100
    v_mfma_f32_16x16x32_bf16 v[216:219], a[52:55], a[72:75], v[216:219]
    ds_read_b128 a[12:15], v14 offset:55296
    v_add_f32 v90, -1.0, v156
    v_mfma_f32_16x16x32_bf16 v[220:223], a[52:55], a[76:79], v[220:223]
    buffer_load_dwordx4 v8, s[56:59], s76 offen offset:2560  lds
    v_mfma_f32_16x16x32_bf16 v[224:227], a[56:59], a[64:67], v[224:227]
    ds_read_b128 a[36:39], v6 offset:38912
    v_fma_f32 v91, v101, v101, v91
    v_mfma_f32_16x16x32_bf16 v[228:231], a[56:59], a[68:71], v[228:231]
    s_add_u32 m0, s73, 42752
    v_mfma_f32_16x16x32_bf16 v[232:235], a[56:59], a[72:75], v[232:235]
    buffer_load_dwordx4 v5, s[52:55], s72 offen offset:1280  lds
    v_mfma_f32_16x16x32_bf16 v[236:239], a[56:59], a[76:79], v[236:239]
    ds_read_b128 a[16:19], v14 offset:57344
    v_rcp_f32 v91, v91
    v_mfma_f32_16x16x32_bf16 a[84:87], a[40:43], a[80:83], a[84:87]
    v_mul_f32 v92, v90, v100
    v_mfma_f32_16x16x32_bf16 a[88:91], a[44:47], a[80:83], a[88:91]
    s_add_u32 m0, s74, 98304
    v_fma_f32 v92, v157, v101, v92
    v_mfma_f32_16x16x32_bf16 a[92:95], a[48:51], a[80:83], a[92:95]
    buffer_load_dwordx4 v9, s[56:59], s75 offen offset:0  lds
    v_mfma_f32_16x16x32_bf16 a[96:99], a[52:55], a[80:83], a[96:99]
    v_mul_f32 v93, v157, v100
    v_mfma_f32_16x16x32_bf16 a[100:103], a[56:59], a[80:83], a[100:103]
    v_fma_f32 v93, -v90, v101, v93
    v_add_f32 v91, v91, v91
    s_waitcnt lgkmcnt(0)
    buffer_store_dwordx4 v[136:139], v27, s[60:63], s92 offen sc1
    v_mfma_f32_16x16x32_bf16 v[160:163], a[0:3], a[24:27], v[160:163]
    s_add_u32 s72, s72, 128
    ds_read_b128 a[40:43], v15 offset:49152
    v_mfma_f32_16x16x32_bf16 v[164:167], a[0:3], a[28:31], v[164:167]
    s_waitcnt vmcnt(5)
    v_lshlrev_b32 v65, 16, v124
    v_mfma_f32_16x16x32_bf16 v[168:171], a[0:3], a[32:35], v[168:171]
    s_add_u32 s75, s75, 128
    ds_read_b128 a[64:67], v7 offset:32768
    v_mfma_f32_16x16x32_bf16 v[172:175], a[0:3], a[36:39], v[172:175]
    s_add_u32 s76, s76, 128
    v_and_b32 v66, 0xffff0000, v124
    v_mfma_f32_16x16x32_bf16 v[176:179], a[4:7], a[24:27], v[176:179]
    s_add_u32 m0, s74, 114688
    ds_read_b128 a[44:47], v15 offset:51200
    v_mfma_f32_16x16x32_bf16 v[180:183], a[4:7], a[28:31], v[180:183]
    buffer_load_dwordx4 v8, s[56:59], s75 offen offset:0  lds
    v_mfma_f32_16x16x32_bf16 v[184:187], a[4:7], a[32:35], v[184:187]
    ds_read_b128 a[68:71], v7 offset:34816
    v_mov_b32 v60, v65
    v_mfma_f32_16x16x32_bf16 v[188:191], a[4:7], a[36:39], v[188:191]
    s_add_u32 m0, s73, 57344
    ds_read_b128 a[48:51], v15 offset:53248
    v_mfma_f32_16x16x32_bf16 v[192:195], a[8:11], a[24:27], v[192:195]
    buffer_load_dwordx4 v4, s[52:55], s72 offen offset:0  lds
    v_mfma_f32_16x16x32_bf16 v[196:199], a[8:11], a[28:31], v[196:199]
    ds_read_b128 a[72:75], v7 offset:36864
    v_mov_b32 v62, v66
    v_mfma_f32_16x16x32_bf16 v[200:203], a[8:11], a[32:35], v[200:203]
    s_add_u32 m0, s74, 114176
    ds_read_b128 a[52:55], v15 offset:55296
    v_mfma_f32_16x16x32_bf16 v[204:207], a[8:11], a[36:39], v[204:207]
    buffer_load_dwordx4 v8, s[56:59], s75 offen offset:2560  lds
    v_mfma_f32_16x16x32_bf16 v[208:211], a[12:15], a[24:27], v[208:211]
    ds_read_b128 a[76:79], v7 offset:38912
    v_mul_f32 v61, v65, v65
    v_mfma_f32_16x16x32_bf16 v[212:215], a[12:15], a[28:31], v[212:215]
    s_add_u32 m0, s73, 58368
    ds_read_b128 a[56:59], v15 offset:57344
    v_mfma_f32_16x16x32_bf16 v[216:219], a[12:15], a[32:35], v[216:219]
    buffer_load_dwordx4 v5, s[52:55], s72 offen offset:0  lds
    v_mfma_f32_16x16x32_bf16 v[220:223], a[12:15], a[36:39], v[220:223]
    v_mul_f32 v63, v66, v66
    v_lshlrev_b32 v65, 16, v125
    v_mfma_f32_16x16x32_bf16 v[224:227], a[16:19], a[24:27], v[224:227]
    s_add_u32 m0, s74, 118784
    v_and_b32 v66, 0xffff0000, v125
    v_mfma_f32_16x16x32_bf16 v[228:231], a[16:19], a[28:31], v[228:231]
    buffer_load_dwordx4 v8, s[56:59], s76 offen offset:0  lds
    v_mfma_f32_16x16x32_bf16 v[232:235], a[16:19], a[32:35], v[232:235]
    v_add_f32 v60, v60, v65
    v_add_f32 v62, v62, v66
    v_mfma_f32_16x16x32_bf16 v[236:239], a[16:19], a[36:39], v[236:239]
    v_fmac_f32 v61, v65, v65
    v_fmac_f32 v63, v66, v66
    s_waitcnt lgkmcnt(0)
    v_mfma_f32_16x16x32_bf16 v[160:163], a[40:43], a[64:67], v[160:163]
    v_mfma_f32_16x16x32_bf16 v[164:167], a[40:43], a[68:71], v[164:167]
    s_waitcnt vmcnt(6)
    s_barrier
    v_mfma_f32_16x16x32_bf16 v[168:171], a[40:43], a[72:75], v[168:171]
    s_add_u32 m0, s73, 58112
    ds_read_b128 a[0:3], v14 offset:0
    v_mfma_f32_16x16x32_bf16 v[172:175], a[40:43], a[76:79], v[172:175]
    v_lshlrev_b32 v65, 16, v126
    v_and_b32 v66, 0xffff0000, v126
    v_mfma_f32_16x16x32_bf16 v[176:179], a[44:47], a[64:67], v[176:179]
    buffer_load_dwordx4 v4, s[52:55], s72 offen offset:1280  lds
    v_mfma_f32_16x16x32_bf16 v[180:183], a[44:47], a[68:71], v[180:183]
    ds_read_b128 a[24:27], v6 offset:0
    v_add_f32 v60, v60, v65
    v_mfma_f32_16x16x32_bf16 v[184:187], a[44:47], a[72:75], v[184:187]
    ds_read_b128 a[4:7], v14 offset:2048
    v_add_f32 v62, v62, v66
    v_mfma_f32_16x16x32_bf16 v[188:191], a[44:47], a[76:79], v[188:191]
    v_fmac_f32 v61, v65, v65
    v_fmac_f32 v63, v66, v66
    v_mfma_f32_16x16x32_bf16 v[192:195], a[48:51], a[64:67], v[192:195]
    s_add_u32 m0, s74, 118272
    ds_read_b128 a[28:31], v6 offset:2048
    v_mfma_f32_16x16x32_bf16 v[196:199], a[48:51], a[68:71], v[196:199]
    v_lshlrev_b32 v65, 16, v127
    v_and_b32 v66, 0xffff0000, v127
    v_mfma_f32_16x16x32_bf16 v[200:203], a[48:51], a[72:75], v[200:203]
    buffer_load_dwordx4 v8, s[56:59], s76 offen offset:2560  lds
    v_mfma_f32_16x16x32_bf16 v[204:207], a[48:51], a[76:79], v[204:207]
    ds_read_b128 a[8:11], v14 offset:4096
    v_add_f32 v60, v60, v65
    v_mfma_f32_16x16x32_bf16 v[208:211], a[52:55], a[64:67], v[208:211]
    ds_read_b128 a[32:35], v6 offset:4096
    v_add_f32 v62, v62, v66
    v_mfma_f32_16x16x32_bf16 v[212:215], a[52:55], a[68:71], v[212:215]
    s_add_u32 m0, s73, 59136
    v_fmac_f32 v61, v65, v65
    v_mfma_f32_16x16x32_bf16 v[216:219], a[52:55], a[72:75], v[216:219]
    ds_read_b128 a[12:15], v14 offset:6144
    v_fmac_f32 v63, v66, v66
    v_mfma_f32_16x16x32_bf16 v[220:223], a[52:55], a[76:79], v[220:223]
    buffer_load_dwordx4 v5, s[52:55], s72 offen offset:1280  lds
    v_mfma_f32_16x16x32_bf16 v[224:227], a[56:59], a[64:67], v[224:227]
    ds_read_b128 a[36:39], v6 offset:6144
    v_lshlrev_b32 v65, 16, v128
    v_mfma_f32_16x16x32_bf16 v[228:231], a[56:59], a[68:71], v[228:231]
    v_and_b32 v66, 0xffff0000, v128
    v_add_f32 v60, v60, v65
    v_mfma_f32_16x16x32_bf16 v[232:235], a[56:59], a[72:75], v[232:235]
    ds_read_b128 a[16:19], v14 offset:8192
    v_add_f32 v62, v62, v66
    v_mfma_f32_16x16x32_bf16 v[236:239], a[56:59], a[76:79], v[236:239]
    s_add_u32 m0, s74, 122880
    v_fmac_f32 v61, v65, v65
    v_mfma_f32_16x16x32_bf16 a[84:87], a[40:43], a[80:83], a[84:87]
    v_fmac_f32 v63, v66, v66
    v_lshlrev_b32 v65, 16, v129
    v_mfma_f32_16x16x32_bf16 a[88:91], a[44:47], a[80:83], a[88:91]
    buffer_load_dwordx4 v9, s[56:59], s75 offen offset:0  lds
    v_mfma_f32_16x16x32_bf16 a[92:95], a[48:51], a[80:83], a[92:95]
    v_and_b32 v66, 0xffff0000, v129
    v_add_f32 v60, v60, v65
    v_mfma_f32_16x16x32_bf16 a[96:99], a[52:55], a[80:83], a[96:99]
    v_add_f32 v62, v62, v66
    v_fmac_f32 v61, v65, v65
    v_mfma_f32_16x16x32_bf16 a[100:103], a[56:59], a[80:83], a[100:103]
    v_fmac_f32 v63, v66, v66
    v_lshlrev_b32 v65, 16, v130
    s_waitcnt lgkmcnt(0)
    buffer_store_dwordx4 v[140:143], v27, s[60:63], s93 offen sc1
    v_mfma_f32_16x16x32_bf16 v[160:163], a[0:3], a[24:27], v[160:163]
    s_add_u32 s72, s72, 128
    ds_read_b128 a[40:43], v15 offset:0
    v_mfma_f32_16x16x32_bf16 v[164:167], a[0:3], a[28:31], v[164:167]
    v_and_b32 v66, 0xffff0000, v130
    v_add_f32 v60, v60, v65
    v_mfma_f32_16x16x32_bf16 v[168:171], a[0:3], a[32:35], v[168:171]
    s_add_u32 s75, s75, 128
    ds_read_b128 a[64:67], v7 offset:0
    v_mfma_f32_16x16x32_bf16 v[172:175], a[0:3], a[36:39], v[172:175]
    s_add_u32 s76, s76, 128
    v_add_f32 v62, v62, v66
    v_mfma_f32_16x16x32_bf16 v[176:179], a[4:7], a[24:27], v[176:179]
    s_add_u32 m0, s74, 139264
    ds_read_b128 a[44:47], v15 offset:2048
    v_mfma_f32_16x16x32_bf16 v[180:183], a[4:7], a[28:31], v[180:183]
    buffer_load_dwordx4 v8, s[56:59], s75 offen offset:0  lds
    v_mfma_f32_16x16x32_bf16 v[184:187], a[4:7], a[32:35], v[184:187]
    ds_read_b128 a[68:71], v7 offset:2048
    v_fmac_f32 v61, v65, v65
    v_mfma_f32_16x16x32_bf16 v[188:191], a[4:7], a[36:39], v[188:191]
    s_add_u32 m0, s73, 73728
    ds_read_b128 a[48:51], v15 offset:4096
    v_mfma_f32_16x16x32_bf16 v[192:195], a[8:11], a[24:27], v[192:195]
    buffer_load_dwordx4 v4, s[52:55], s72 offen offset:0  lds
    v_mfma_f32_16x16x32_bf16 v[196:199], a[8:11], a[28:31], v[196:199]
    ds_read_b128 a[72:75], v7 offset:4096
    v_fmac_f32 v63, v66, v66
    v_mfma_f32_16x16x32_bf16 v[200:203], a[8:11], a[32:35], v[200:203]
    s_add_u32 m0, s74, 138752
    ds_read_b128 a[52:55], v15 offset:6144
    v_mfma_f32_16x16x32_bf16 v[204:207], a[8:11], a[36:39], v[204:207]
    buffer_load_dwordx4 v8, s[56:59], s75 offen offset:2560  lds
    v_mfma_f32_16x16x32_bf16 v[208:211], a[12:15], a[24:27], v[208:211]
    ds_read_b128 a[76:79], v7 offset:6144
    v_lshlrev_b32 v65, 16, v131
    v_mfma_f32_16x16x32_bf16 v[212:215], a[12:15], a[28:31], v[212:215]
    s_add_u32 m0, s73, 74752
    ds_read_b128 a[56:59], v15 offset:8192
    v_mfma_f32_16x16x32_bf16 v[216:219], a[12:15], a[32:35], v[216:219]
    buffer_load_dwordx4 v5, s[52:55], s72 offen offset:0  lds
    v_mfma_f32_16x16x32_bf16 v[220:223], a[12:15], a[36:39], v[220:223]
    v_and_b32 v66, 0xffff0000, v131
    v_add_f32 v60, v60, v65
    v_mfma_f32_16x16x32_bf16 v[224:227], a[16:19], a[24:27], v[224:227]
    s_add_u32 m0, s74, 143360
    v_add_f32 v62, v62, v66
    v_mfma_f32_16x16x32_bf16 v[228:231], a[16:19], a[28:31], v[228:231]
    buffer_load_dwordx4 v8, s[56:59], s76 offen offset:0  lds
    v_mfma_f32_16x16x32_bf16 v[232:235], a[16:19], a[32:35], v[232:235]
    v_fmac_f32 v61, v65, v65
    v_fmac_f32 v63, v66, v66
    v_mfma_f32_16x16x32_bf16 v[236:239], a[16:19], a[36:39], v[236:239]
    v_lshlrev_b32 v65, 16, v132
    v_and_b32 v66, 0xffff0000, v132
    s_waitcnt lgkmcnt(0)
    v_mfma_f32_16x16x32_bf16 v[160:163], a[40:43], a[64:67], v[160:163]
    v_mfma_f32_16x16x32_bf16 v[164:167], a[40:43], a[68:71], v[164:167]
    s_waitcnt vmcnt(6)
    s_barrier
    v_mfma_f32_16x16x32_bf16 v[168:171], a[40:43], a[72:75], v[168:171]
    s_add_u32 m0, s73, 74496
    ds_read_b128 a[0:3], v14 offset:24576
    v_mfma_f32_16x16x32_bf16 v[172:175], a[40:43], a[76:79], v[172:175]
    v_add_f32 v60, v60, v65
    v_add_f32 v62, v62, v66
    v_mfma_f32_16x16x32_bf16 v[176:179], a[44:47], a[64:67], v[176:179]
    buffer_load_dwordx4 v4, s[52:55], s72 offen offset:1280  lds
    v_mfma_f32_16x16x32_bf16 v[180:183], a[44:47], a[68:71], v[180:183]
    ds_read_b128 a[24:27], v6 offset:16384
    v_fmac_f32 v61, v65, v65
    v_mfma_f32_16x16x32_bf16 v[184:187], a[44:47], a[72:75], v[184:187]
    ds_read_b128 a[4:7], v14 offset:26624
    v_fmac_f32 v63, v66, v66
    v_mfma_f32_16x16x32_bf16 v[188:191], a[44:47], a[76:79], v[188:191]
    v_lshlrev_b32 v65, 16, v133
    v_and_b32 v66, 0xffff0000, v133
    v_mfma_f32_16x16x32_bf16 v[192:195], a[48:51], a[64:67], v[192:195]
    s_add_u32 m0, s74, 142848
    ds_read_b128 a[28:31], v6 offset:18432
    v_mfma_f32_16x16x32_bf16 v[196:199], a[48:51], a[68:71], v[196:199]
    v_add_f32 v60, v60, v65
    v_add_f32 v62, v62, v66
    v_mfma_f32_16x16x32_bf16 v[200:203], a[48:51], a[72:75], v[200:203]
    buffer_load_dwordx4 v8, s[56:59], s76 offen offset:2560  lds
    v_mfma_f32_16x16x32_bf16 v[204:207], a[48:51], a[76:79], v[204:207]
    ds_read_b128 a[8:11], v14 offset:28672
    v_fmac_f32 v61, v65, v65
    v_mfma_f32_16x16x32_bf16 v[208:211], a[52:55], a[64:67], v[208:211]
    ds_read_b128 a[32:35], v6 offset:20480
    v_fmac_f32 v63, v66, v66
    v_mfma_f32_16x16x32_bf16 v[212:215], a[52:55], a[68:71], v[212:215]
    s_add_u32 m0, s73, 75520
    v_add_f32 v60, v60, v62
    v_mfma_f32_16x16x32_bf16 v[216:219], a[52:55], a[72:75], v[216:219]
    ds_read_b128 a[12:15], v14 offset:30720
    v_add_f32 v61, v61, v63
    v_mfma_f32_16x16x32_bf16 v[220:223], a[52:55], a[76:79], v[220:223]
    buffer_load_dwordx4 v5, s[52:55], s72 offen offset:1280  lds
    v_mfma_f32_16x16x32_bf16 v[224:227], a[56:59], a[64:67], v[224:227]
    ds_read_b128 a[36:39], v6 offset:22528
    v_mov_b32 v65, 0
    v_mfma_f32_16x16x32_bf16 v[228:231], a[56:59], a[68:71], v[228:231]
    v_add_f32_dpp v60, v60, v60 row_shr:1 row_mask:0xf bank_mask:0xf bound_ctrl:0
    v_add_f32_dpp v61, v61, v61 row_shr:1 row_mask:0xf bank_mask:0xf bound_ctrl:0
    v_mfma_f32_16x16x32_bf16 v[232:235], a[56:59], a[72:75], v[232:235]
    ds_read_b128 a[16:19], v14 offset:32768
    v_add_f32_dpp v60, v60, v60 row_shr:2 row_mask:0xf bank_mask:0xf bound_ctrl:0
    v_mfma_f32_16x16x32_bf16 v[236:239], a[56:59], a[76:79], v[236:239]
    s_add_u32 m0, s74, 147456
    v_add_f32_dpp v61, v61, v61 row_shr:2 row_mask:0xf bank_mask:0xf bound_ctrl:0
    v_mfma_f32_16x16x32_bf16 a[84:87], a[40:43], a[80:83], a[84:87]
    v_add_f32_dpp v60, v60, v60 row_shr:4 row_mask:0xf bank_mask:0xf bound_ctrl:0
    v_add_f32_dpp v61, v61, v61 row_shr:4 row_mask:0xf bank_mask:0xf bound_ctrl:0
    v_mfma_f32_16x16x32_bf16 a[88:91], a[44:47], a[80:83], a[88:91]
    buffer_load_dwordx4 v9, s[56:59], s75 offen offset:0  lds
    v_mfma_f32_16x16x32_bf16 a[92:95], a[48:51], a[80:83], a[92:95]
    v_add_f32_dpp v60, v60, v60 row_shr:8 row_mask:0xf bank_mask:0xf bound_ctrl:0
    v_add_f32_dpp v61, v61, v61 row_shr:8 row_mask:0xf bank_mask:0xf bound_ctrl:0
    v_mfma_f32_16x16x32_bf16 a[96:99], a[52:55], a[80:83], a[96:99]
    v_add_f32_dpp v60, v60, v60 row_bcast:15 row_mask:0xa bank_mask:0xf bound_ctrl:0
    v_add_f32_dpp v61, v61, v61 row_bcast:15 row_mask:0xa bank_mask:0xf bound_ctrl:0
    v_mfma_f32_16x16x32_bf16 a[100:103], a[56:59], a[80:83], a[100:103]
    v_mul_f32 v62, 0x3acccccd, v60
    v_mul_f32 v63, 0x3acccccd, v61
    s_waitcnt lgkmcnt(0)
    buffer_store_dwordx4 v[144:147], v121, s[60:63], s94 offen sc1
    v_mfma_f32_16x16x32_bf16 v[160:163], a[0:3], a[24:27], v[160:163]
    s_add_u32 s72, s72, 128
    ds_read_b128 a[40:43], v15 offset:24576
    v_mfma_f32_16x16x32_bf16 v[164:167], a[0:3], a[28:31], v[164:167]
    v_mov_b32 v40, s11
    v_mov_b32 v41, s11
    v_mfma_f32_16x16x32_bf16 v[168:171], a[0:3], a[32:35], v[168:171]
    s_add_u32 s75, s75, 128
    ds_read_b128 a[64:67], v7 offset:16384
    v_mfma_f32_16x16x32_bf16 v[172:175], a[0:3], a[36:39], v[172:175]
    s_add_u32 s76, s76, 128
    s_lshl_b32 s79, s78, 7
    v_mfma_f32_16x16x32_bf16 v[176:179], a[4:7], a[24:27], v[176:179]
    s_add_u32 m0, s74, 90112
    ds_read_b128 a[44:47], v15 offset:26624
    v_mfma_f32_16x16x32_bf16 v[180:183], a[4:7], a[28:31], v[180:183]
    buffer_load_dwordx4 v8, s[56:59], s75 offen offset:0  lds
    v_mfma_f32_16x16x32_bf16 v[184:187], a[4:7], a[32:35], v[184:187]
    ds_read_b128 a[68:71], v7 offset:18432
    s_lshl_b32 s13, s3, 4
    v_mfma_f32_16x16x32_bf16 v[188:191], a[4:7], a[36:39], v[188:191]
    s_add_u32 m0, s73, 40960
    ds_read_b128 a[48:51], v15 offset:28672
    v_mfma_f32_16x16x32_bf16 v[192:195], a[8:11], a[24:27], v[192:195]
    buffer_load_dwordx4 v4, s[52:55], s72 offen offset:0  lds
    v_mfma_f32_16x16x32_bf16 v[196:199], a[8:11], a[28:31], v[196:199]
    ds_read_b128 a[72:75], v7 offset:20480
    s_add_u32 s79, s79, s13
    v_mfma_f32_16x16x32_bf16 v[200:203], a[8:11], a[32:35], v[200:203]
    s_add_u32 m0, s74, 89600
    ds_read_b128 a[52:55], v15 offset:30720
    v_mfma_f32_16x16x32_bf16 v[204:207], a[8:11], a[36:39], v[204:207]
    buffer_load_dwordx4 v8, s[56:59], s75 offen offset:2560  lds
    v_mfma_f32_16x16x32_bf16 v[208:211], a[12:15], a[24:27], v[208:211]
    ds_read_b128 a[76:79], v7 offset:22528
    s_add_u32 s79, s79, 17825792
    v_mfma_f32_16x16x32_bf16 v[212:215], a[12:15], a[28:31], v[212:215]
    s_add_u32 m0, s73, 41984
    ds_read_b128 a[56:59], v15 offset:32768
    v_mfma_f32_16x16x32_bf16 v[216:219], a[12:15], a[32:35], v[216:219]
    buffer_load_dwordx4 v5, s[52:55], s72 offen offset:0  lds
    v_mfma_f32_16x16x32_bf16 v[220:223], a[12:15], a[36:39], v[220:223]
    s_add_u32 s79, s79, 16384
    v_lshlrev_b32 v42, 26, v1
    v_mfma_f32_16x16x32_bf16 v[224:227], a[16:19], a[24:27], v[224:227]
    s_add_u32 m0, s74, 94208
    v_or_b32 v42, s89, v42
    v_mfma_f32_16x16x32_bf16 v[228:231], a[16:19], a[28:31], v[228:231]
    buffer_load_dwordx4 v8, s[56:59], s76 offen offset:0  lds
    v_mfma_f32_16x16x32_bf16 v[232:235], a[16:19], a[32:35], v[232:235]
    v_mul_f32 v158, v92, v91
    v_mul_f32 v159, v93, v91
    v_mfma_f32_16x16x32_bf16 v[236:239], a[16:19], a[36:39], v[236:239]
    v_fma_f32 v63, -v62, v62, v63
    v_min_u32 v90, 1, v39
    s_waitcnt lgkmcnt(0)
    v_mfma_f32_16x16x32_bf16 v[160:163], a[40:43], a[64:67], v[160:163]
    v_mfma_f32_16x16x32_bf16 v[164:167], a[40:43], a[68:71], v[164:167]
    s_waitcnt vmcnt(6)
    s_barrier
    v_mfma_f32_16x16x32_bf16 v[168:171], a[40:43], a[72:75], v[168:171]
    s_add_u32 m0, s73, 41728
    ds_read_b128 a[0:3], v14 offset:49152
    v_mfma_f32_16x16x32_bf16 v[172:175], a[40:43], a[76:79], v[172:175]
    v_max_f32 v63, 0, v63
    v_cvt_pk_bf16_f32 v68, v62, v62
    v_mfma_f32_16x16x32_bf16 v[176:179], a[44:47], a[64:67], v[176:179]
    buffer_load_dwordx4 v4, s[52:55], s72 offen offset:1280  lds
    v_mfma_f32_16x16x32_bf16 v[180:183], a[44:47], a[68:71], v[180:183]
    ds_read_b128 a[24:27], v6 offset:32768
    v_and_b32 v68, 0xffff0000, v68
    v_mfma_f32_16x16x32_bf16 v[184:187], a[44:47], a[72:75], v[184:187]
    ds_read_b128 a[4:7], v14 offset:51200
    v_cvt_pk_bf16_f32 v65, v63, v63
    v_mfma_f32_16x16x32_bf16 v[188:191], a[44:47], a[76:79], v[188:191]
    v_and_b32 v65, 0xffff0000, v65
    v_mul_u32_u24 v90, 0x30000, v90
    v_mfma_f32_16x16x32_bf16 v[192:195], a[48:51], a[64:67], v[192:195]
    s_add_u32 m0, s74, 93696
    ds_read_b128 a[28:31], v6 offset:34816
    v_mfma_f32_16x16x32_bf16 v[196:199], a[48:51], a[68:71], v[196:199]
    v_add_f32 v65, 0x3727c5ac, v65
    v_add_u32 v86, v81, v90
    v_mfma_f32_16x16x32_bf16 v[200:203], a[48:51], a[72:75], v[200:203]
    buffer_load_dwordx4 v8, s[56:59], s76 offen offset:2560  lds
    v_mfma_f32_16x16x32_bf16 v[204:207], a[48:51], a[76:79], v[204:207]
    ds_read_b128 a[8:11], v14 offset:53248
    v_cvt_pk_bf16_f32 v65, v65, v65
    v_mfma_f32_16x16x32_bf16 v[208:211], a[52:55], a[64:67], v[208:211]
    ds_read_b128 a[32:35], v6 offset:36864
    v_and_b32 v65, 0xffff0000, v65
    v_mfma_f32_16x16x32_bf16 v[212:215], a[52:55], a[68:71], v[212:215]
    s_add_u32 m0, s73, 42752
    ds_read_b64 v[104:105], v83 offset:17408
    v_mfma_f32_16x16x32_bf16 v[216:219], a[52:55], a[72:75], v[216:219]
    ds_read_b128 a[12:15], v14 offset:55296
    v_mfma_f32_16x16x32_bf16 v[220:223], a[52:55], a[76:79], v[220:223]
    buffer_load_dwordx4 v5, s[52:55], s72 offen offset:1280  lds
    v_mfma_f32_16x16x32_bf16 v[224:227], a[56:59], a[64:67], v[224:227]
    ds_read_b128 a[36:39], v6 offset:38912
    v_sqrt_f32 v65, v65
    v_mfma_f32_16x16x32_bf16 v[228:231], a[56:59], a[68:71], v[228:231]
    v_sub_f32 v66, v62, v68
    v_cvt_pk_bf16_f32 v64, v65, v65
    v_mfma_f32_16x16x32_bf16 v[232:235], a[56:59], a[72:75], v[232:235]
    ds_read_b128 a[16:19], v14 offset:57344
    v_and_b32 v64, 0xffff0000, v64
    v_mfma_f32_16x16x32_bf16 v[236:239], a[56:59], a[76:79], v[236:239]
    s_add_u32 m0, s74, 98304
    v_mfma_f32_16x16x32_bf16 a[84:87], a[40:43], a[80:83], a[84:87]
    v_rcp_f32 v70, v64
    v_mfma_f32_16x16x32_bf16 a[88:91], a[44:47], a[80:83], a[88:91]
    buffer_load_dwordx4 v9, s[56:59], s75 offen offset:0  lds
    v_mfma_f32_16x16x32_bf16 a[92:95], a[48:51], a[80:83], a[92:95]
    v_mul_f32 v66, v66, v70
    v_mul_f32 v65, v63, v70
    v_mfma_f32_16x16x32_bf16 a[96:99], a[52:55], a[80:83], a[96:99]
    v_cvt_pk_bf16_f32 v66, v66, v66
    v_mfma_f32_16x16x32_bf16 a[100:103], a[56:59], a[80:83], a[100:103]
    v_and_b32 v66, 0xffff0000, v66
    v_mul_f32 v65, v65, v70
    s_waitcnt lgkmcnt(0)
    s_waitcnt vmcnt(9)
    buffer_store_dwordx2 v[40:41], v42, s[60:63], s79 offen sc1
    v_mfma_f32_16x16x32_bf16 v[160:163], a[0:3], a[24:27], v[160:163]
    s_add_u32 s72, s72, 128
    ds_read_b128 a[40:43], v15 offset:49152
    v_mfma_f32_16x16x32_bf16 v[164:167], a[0:3], a[28:31], v[164:167]
    v_cvt_pk_bf16_f32 v65, v65, v65
    ds_read_b64 v[106:107], v83 offset:17536
    v_mfma_f32_16x16x32_bf16 v[168:171], a[0:3], a[32:35], v[168:171]
    s_add_u32 s75, s75, 128
    ds_read_b128 a[64:67], v7 offset:32768
    v_mfma_f32_16x16x32_bf16 v[172:175], a[0:3], a[36:39], v[172:175]
    s_add_u32 s76, s76, 128
    v_and_b32 v65, 0xffff0000, v65
    v_mfma_f32_16x16x32_bf16 v[176:179], a[4:7], a[24:27], v[176:179]
    s_add_u32 m0, s74, 114688
    ds_read_b128 a[44:47], v15 offset:51200
    v_mfma_f32_16x16x32_bf16 v[180:183], a[4:7], a[28:31], v[180:183]
    buffer_load_dwordx4 v8, s[56:59], s75 offen offset:0  lds
    v_mfma_f32_16x16x32_bf16 v[184:187], a[4:7], a[32:35], v[184:187]
    ds_read_b128 a[68:71], v7 offset:34816
    v_add_f32 v65, 0x3727c5ac, v65
    v_mfma_f32_16x16x32_bf16 v[188:191], a[4:7], a[36:39], v[188:191]
    s_add_u32 m0, s73, 57344
    ds_read_b128 a[48:51], v15 offset:53248
    v_mfma_f32_16x16x32_bf16 v[192:195], a[8:11], a[24:27], v[192:195]
    buffer_load_dwordx4 v4, s[52:55], s72 offen offset:0  lds
    v_mfma_f32_16x16x32_bf16 v[196:199], a[8:11], a[28:31], v[196:199]
    ds_read_b128 a[72:75], v7 offset:36864
    v_cvt_pk_bf16_f32 v65, v65, v65
    v_mfma_f32_16x16x32_bf16 v[200:203], a[8:11], a[32:35], v[200:203]
    s_add_u32 m0, s74, 114176
    ds_read_b128 a[52:55], v15 offset:55296
    v_mfma_f32_16x16x32_bf16 v[204:207], a[8:11], a[36:39], v[204:207]
    buffer_load_dwordx4 v8, s[56:59], s75 offen offset:2560  lds
    v_mfma_f32_16x16x32_bf16 v[208:211], a[12:15], a[24:27], v[208:211]
    ds_read_b128 a[76:79], v7 offset:38912
    v_and_b32 v65, 0xffff0000, v65
    v_mfma_f32_16x16x32_bf16 v[212:215], a[12:15], a[28:31], v[212:215]
    s_add_u32 m0, s73, 58368
    ds_read_b128 a[56:59], v15 offset:57344
    v_mfma_f32_16x16x32_bf16 v[216:219], a[12:15], a[32:35], v[216:219]
    buffer_load_dwordx4 v5, s[52:55], s72 offen offset:0  lds
    v_mfma_f32_16x16x32_bf16 v[220:223], a[12:15], a[36:39], v[220:223]
    v_sqrt_f32 v65, v65
    v_mfma_f32_16x16x32_bf16 v[224:227], a[16:19], a[24:27], v[224:227]
    s_add_u32 m0, s74, 118784
    v_fma_f32 v66, v66, v64, v68
    v_mfma_f32_16x16x32_bf16 v[228:231], a[16:19], a[28:31], v[228:231]
    buffer_load_dwordx4 v8, s[56:59], s76 offen offset:0  lds
    v_mfma_f32_16x16x32_bf16 v[232:235], a[16:19], a[32:35], v[232:235]
    v_cvt_pk_bf16_f32 v65, v65, v65
    v_mfma_f32_16x16x32_bf16 v[236:239], a[16:19], a[36:39], v[236:239]
    v_and_b32 v65, 0xffff0000, v65
    s_waitcnt lgkmcnt(0)
    v_mfma_f32_16x16x32_bf16 v[160:163], a[40:43], a[64:67], v[160:163]
    v_mfma_f32_16x16x32_bf16 v[164:167], a[40:43], a[68:71], v[164:167]
    s_waitcnt vmcnt(6)
    s_barrier
    v_mfma_f32_16x16x32_bf16 v[168:171], a[40:43], a[72:75], v[168:171]
    s_add_u32 m0, s73, 58112
    ds_read_b128 a[0:3], v14 offset:0
    v_mfma_f32_16x16x32_bf16 v[172:175], a[40:43], a[76:79], v[172:175]
    v_mul_f32 v65, v65, v64
    ds_read_b64 v[108:109], v83 offset:17664
    v_mfma_f32_16x16x32_bf16 v[176:179], a[44:47], a[64:67], v[176:179]
    buffer_load_dwordx4 v4, s[52:55], s72 offen offset:1280  lds
    v_mfma_f32_16x16x32_bf16 v[180:183], a[44:47], a[68:71], v[180:183]
    ds_read_b128 a[24:27], v6 offset:0
    v_mfma_f32_16x16x32_bf16 v[184:187], a[44:47], a[72:75], v[184:187]
    ds_read_b128 a[4:7], v14 offset:2048
    v_rcp_f32 v72, v65
    v_mfma_f32_16x16x32_bf16 v[188:191], a[44:47], a[76:79], v[188:191]
    v_and_b32 v65, 31, v1
    v_mul_f32 v74, v72, v66
    v_mfma_f32_16x16x32_bf16 v[192:195], a[48:51], a[64:67], v[192:195]
    s_add_u32 m0, s74, 118272
    ds_read_b128 a[28:31], v6 offset:2048
    v_mfma_f32_16x16x32_bf16 v[196:199], a[48:51], a[68:71], v[196:199]
    v_sub_u32 v65, 31, v65
    v_and_b32 v66, 32, v1
    v_mfma_f32_16x16x32_bf16 v[200:203], a[48:51], a[72:75], v[200:203]
    buffer_load_dwordx4 v8, s[56:59], s76 offen offset:2560  lds
    v_mfma_f32_16x16x32_bf16 v[204:207], a[48:51], a[76:79], v[204:207]
    ds_read_b128 a[8:11], v14 offset:4096
    v_lshl_add_u32 v65, v65, 26, v66
    v_mfma_f32_16x16x32_bf16 v[208:211], a[52:55], a[64:67], v[208:211]
    ds_read_b128 a[32:35], v6 offset:4096
    s_lshl_b32 s12, s87, 5
    v_mfma_f32_16x16x32_bf16 v[212:215], a[52:55], a[68:71], v[212:215]
    s_add_u32 m0, s73, 59136
    s_add_u32 s12, s12, 18874368
    v_mfma_f32_16x16x32_bf16 v[216:219], a[52:55], a[72:75], v[216:219]
    ds_read_b128 a[12:15], v14 offset:6144
    v_mov_b32 v69, s11
    v_mfma_f32_16x16x32_bf16 v[220:223], a[52:55], a[76:79], v[220:223]
    buffer_load_dwordx4 v5, s[52:55], s72 offen offset:1280  lds
    v_mfma_f32_16x16x32_bf16 v[224:227], a[56:59], a[64:67], v[224:227]
    ds_read_b128 a[36:39], v6 offset:6144
    v_mov_b32 v71, s11
    v_mfma_f32_16x16x32_bf16 v[228:231], a[56:59], a[68:71], v[228:231]
    v_mov_b32 v73, s11
    v_mov_b32 v75, s11
    v_mfma_f32_16x16x32_bf16 v[232:235], a[56:59], a[72:75], v[232:235]
    ds_read_b128 a[16:19], v14 offset:8192
    v_mfma_f32_16x16x32_bf16 v[236:239], a[56:59], a[76:79], v[236:239]
    s_add_u32 m0, s74, 122880
    v_mfma_f32_16x16x32_bf16 a[84:87], a[40:43], a[80:83], a[84:87]
    buffer_store_dwordx4 v[68:71], v65, s[60:63], s12 offen sc1
    v_mfma_f32_16x16x32_bf16 a[88:91], a[44:47], a[80:83], a[88:91]
    buffer_load_dwordx4 v9, s[56:59], s75 offen offset:0  lds
    v_mfma_f32_16x16x32_bf16 a[92:95], a[48:51], a[80:83], a[92:95]
    buffer_store_dwordx4 v[72:75], v65, s[60:63], s12 offen offset:16 sc1
    v_mfma_f32_16x16x32_bf16 a[96:99], a[52:55], a[80:83], a[96:99]
    v_mfma_f32_16x16x32_bf16 a[100:103], a[56:59], a[80:83], a[100:103]
    s_waitcnt lgkmcnt(0)
    v_mfma_f32_16x16x32_bf16 v[160:163], a[0:3], a[24:27], v[160:163]
    s_add_u32 s72, s72, 128
    ds_read_b128 a[40:43], v15 offset:0
    v_mfma_f32_16x16x32_bf16 v[164:167], a[0:3], a[28:31], v[164:167]
    ds_read_b64 v[110:111], v83 offset:17792
    v_mfma_f32_16x16x32_bf16 v[168:171], a[0:3], a[32:35], v[168:171]
    s_add_u32 s75, s75, 128
    ds_read_b128 a[64:67], v7 offset:0
    v_mfma_f32_16x16x32_bf16 v[172:175], a[0:3], a[36:39], v[172:175]
    s_add_u32 s76, s76, 128
    ds_read_b64 v[112:113], v83 offset:17920
    v_mfma_f32_16x16x32_bf16 v[176:179], a[4:7], a[24:27], v[176:179]
    s_add_u32 m0, s74, 139264
    ds_read_b128 a[44:47], v15 offset:2048
    v_mfma_f32_16x16x32_bf16 v[180:183], a[4:7], a[28:31], v[180:183]
    buffer_load_dwordx4 v8, s[56:59], s75 offen offset:0  lds
    v_mfma_f32_16x16x32_bf16 v[184:187], a[4:7], a[32:35], v[184:187]
    ds_read_b128 a[68:71], v7 offset:2048
    v_mfma_f32_16x16x32_bf16 v[188:191], a[4:7], a[36:39], v[188:191]
    s_add_u32 m0, s73, 73728
    ds_read_b128 a[48:51], v15 offset:4096
    v_mfma_f32_16x16x32_bf16 v[192:195], a[8:11], a[24:27], v[192:195]
    buffer_load_dwordx4 v4, s[52:55], s72 offen offset:0  lds
    v_mfma_f32_16x16x32_bf16 v[196:199], a[8:11], a[28:31], v[196:199]
    ds_read_b128 a[72:75], v7 offset:4096
    v_mfma_f32_16x16x32_bf16 v[200:203], a[8:11], a[32:35], v[200:203]
    s_add_u32 m0, s74, 138752
    ds_read_b128 a[52:55], v15 offset:6144
    v_mfma_f32_16x16x32_bf16 v[204:207], a[8:11], a[36:39], v[204:207]
    buffer_load_dwordx4 v8, s[56:59], s75 offen offset:2560  lds
    v_mfma_f32_16x16x32_bf16 v[208:211], a[12:15], a[24:27], v[208:211]
    ds_read_b128 a[76:79], v7 offset:6144
    v_mfma_f32_16x16x32_bf16 v[212:215], a[12:15], a[28:31], v[212:215]
    s_add_u32 m0, s73, 74752
    ds_read_b128 a[56:59], v15 offset:8192
    v_mfma_f32_16x16x32_bf16 v[216:219], a[12:15], a[32:35], v[216:219]
    buffer_load_dwordx4 v5, s[52:55], s72 offen offset:0  lds
    v_mfma_f32_16x16x32_bf16 v[220:223], a[12:15], a[36:39], v[220:223]
    v_mfma_f32_16x16x32_bf16 v[224:227], a[16:19], a[24:27], v[224:227]
    s_add_u32 m0, s74, 143360
    v_mfma_f32_16x16x32_bf16 v[228:231], a[16:19], a[28:31], v[228:231]
    buffer_load_dwordx4 v8, s[56:59], s76 offen offset:0  lds
    v_mfma_f32_16x16x32_bf16 v[232:235], a[16:19], a[32:35], v[232:235]
    v_mfma_f32_16x16x32_bf16 v[236:239], a[16:19], a[36:39], v[236:239]
    s_waitcnt lgkmcnt(0)
    v_mfma_f32_16x16x32_bf16 v[160:163], a[40:43], a[64:67], v[160:163]
    v_mfma_f32_16x16x32_bf16 v[164:167], a[40:43], a[68:71], v[164:167]
    s_waitcnt vmcnt(6)
    s_barrier
    v_mfma_f32_16x16x32_bf16 v[168:171], a[40:43], a[72:75], v[168:171]
    s_add_u32 m0, s73, 74496
    ds_read_b128 a[0:3], v14 offset:24576
    v_mfma_f32_16x16x32_bf16 v[172:175], a[40:43], a[76:79], v[172:175]
    v_mul_f32 v91, v87, v105
    v_mul_f32 v90, v87, v104
    v_mfma_f32_16x16x32_bf16 v[176:179], a[44:47], a[64:67], v[176:179]
    buffer_load_dwordx4 v4, s[52:55], s72 offen offset:1280  lds
    v_mfma_f32_16x16x32_bf16 v[180:183], a[44:47], a[68:71], v[180:183]
    ds_read_b128 a[24:27], v6 offset:16384
    v_fract_f32 v91, v91
    v_mfma_f32_16x16x32_bf16 v[184:187], a[44:47], a[72:75], v[184:187]
    ds_read_b128 a[4:7], v14 offset:26624
    v_mfma_f32_16x16x32_bf16 v[188:191], a[44:47], a[76:79], v[188:191]
    v_cos_f32 v92, v91
    v_mfma_f32_16x16x32_bf16 v[192:195], a[48:51], a[64:67], v[192:195]
    s_add_u32 m0, s74, 142848
    ds_read_b128 a[28:31], v6 offset:18432
    v_mfma_f32_16x16x32_bf16 v[196:199], a[48:51], a[68:71], v[196:199]
    v_sin_f32 v93, v91
    v_mfma_f32_16x16x32_bf16 v[200:203], a[48:51], a[72:75], v[200:203]
    buffer_load_dwordx4 v8, s[56:59], s76 offen offset:2560  lds
    v_mfma_f32_16x16x32_bf16 v[204:207], a[48:51], a[76:79], v[204:207]
    ds_read_b128 a[8:11], v14 offset:28672
    v_mfma_f32_16x16x32_bf16 v[208:211], a[52:55], a[64:67], v[208:211]
    ds_read_b128 a[32:35], v6 offset:20480
    v_exp_f32 v90, v90
    v_mfma_f32_16x16x32_bf16 v[212:215], a[52:55], a[68:71], v[212:215]
    s_add_u32 m0, s73, 75520
    v_mul_f32 v104, v90, v92
    v_mfma_f32_16x16x32_bf16 v[216:219], a[52:55], a[72:75], v[216:219]
    ds_read_b128 a[12:15], v14 offset:30720
    v_mul_f32 v105, v90, v93
    v_mfma_f32_16x16x32_bf16 v[220:223], a[52:55], a[76:79], v[220:223]
    buffer_load_dwordx4 v5, s[52:55], s72 offen offset:1280  lds
    v_mfma_f32_16x16x32_bf16 v[224:227], a[56:59], a[64:67], v[224:227]
    ds_read_b128 a[36:39], v6 offset:22528
    v_mul_f32 v91, v87, v107
    v_mfma_f32_16x16x32_bf16 v[228:231], a[56:59], a[68:71], v[228:231]
    v_mul_f32 v90, v87, v106
    v_fract_f32 v91, v91
    v_mfma_f32_16x16x32_bf16 v[232:235], a[56:59], a[72:75], v[232:235]
    ds_read_b128 a[16:19], v14 offset:32768
    v_mfma_f32_16x16x32_bf16 v[236:239], a[56:59], a[76:79], v[236:239]
    s_add_u32 m0, s74, 147456
    v_mfma_f32_16x16x32_bf16 a[84:87], a[40:43], a[80:83], a[84:87]
    v_cos_f32 v92, v91
    v_mfma_f32_16x16x32_bf16 a[88:91], a[44:47], a[80:83], a[88:91]
    buffer_load_dwordx4 v9, s[56:59], s75 offen offset:0  lds
    v_mfma_f32_16x16x32_bf16 a[92:95], a[48:51], a[80:83], a[92:95]
    v_sin_f32 v93, v91
    v_mfma_f32_16x16x32_bf16 a[96:99], a[52:55], a[80:83], a[96:99]
    v_exp_f32 v90, v90
    v_mfma_f32_16x16x32_bf16 a[100:103], a[56:59], a[80:83], a[100:103]
    v_mul_f32 v106, v90, v92
    v_mul_f32 v107, v90, v93
    s_waitcnt lgkmcnt(0)
    v_mfma_f32_16x16x32_bf16 v[160:163], a[0:3], a[24:27], v[160:163]
    s_add_u32 s72, s72, 128
    ds_read_b128 a[40:43], v15 offset:24576
    v_mfma_f32_16x16x32_bf16 v[164:167], a[0:3], a[28:31], v[164:167]
    s_add_u32 s75, s75, 128
    v_mul_f32 v91, v87, v109
    v_mfma_f32_16x16x32_bf16 v[168:171], a[0:3], a[32:35], v[168:171]
    s_add_u32 s76, s76, 128
    ds_read_b128 a[64:67], v7 offset:16384
    v_mfma_f32_16x16x32_bf16 v[172:175], a[0:3], a[36:39], v[172:175]
    s_add_u32 m0, s74, 90112
    v_mul_f32 v90, v87, v108
    v_mfma_f32_16x16x32_bf16 v[176:179], a[4:7], a[24:27], v[176:179]
    buffer_load_dwordx4 v8, s[56:59], s75 offen offset:0  lds
    v_mfma_f32_16x16x32_bf16 v[180:183], a[4:7], a[28:31], v[180:183]
    ds_read_b128 a[44:47], v15 offset:26624
    v_fract_f32 v91, v91
    v_mfma_f32_16x16x32_bf16 v[184:187], a[4:7], a[32:35], v[184:187]
    s_add_u32 m0, s73, 40960
    ds_read_b128 a[68:71], v7 offset:18432
    v_mfma_f32_16x16x32_bf16 v[188:191], a[4:7], a[36:39], v[188:191]
    buffer_load_dwordx4 v4, s[52:55], s72 offen offset:0  lds
    v_mfma_f32_16x16x32_bf16 v[192:195], a[8:11], a[24:27], v[192:195]
    ds_read_b128 a[48:51], v15 offset:28672
    v_cos_f32 v92, v91
    v_mfma_f32_16x16x32_bf16 v[196:199], a[8:11], a[28:31], v[196:199]
    s_add_u32 m0, s74, 89600
    ds_read_b128 a[72:75], v7 offset:20480
    v_mfma_f32_16x16x32_bf16 v[200:203], a[8:11], a[32:35], v[200:203]
    buffer_load_dwordx4 v8, s[56:59], s75 offen offset:2560  lds
    v_mfma_f32_16x16x32_bf16 v[204:207], a[8:11], a[36:39], v[204:207]
    s_add_u32 m0, s73, 41984
    ds_read_b128 a[52:55], v15 offset:30720
    v_mfma_f32_16x16x32_bf16 v[208:211], a[12:15], a[24:27], v[208:211]
    buffer_load_dwordx4 v5, s[52:55], s72 offen offset:0  lds
    v_mfma_f32_16x16x32_bf16 v[212:215], a[12:15], a[28:31], v[212:215]
    ds_read_b128 a[76:79], v7 offset:22528
    v_sin_f32 v93, v91
    v_mfma_f32_16x16x32_bf16 v[216:219], a[12:15], a[32:35], v[216:219]
    s_add_u32 m0, s74, 94208
    ds_read_b128 a[56:59], v15 offset:32768
    v_mfma_f32_16x16x32_bf16 v[220:223], a[12:15], a[36:39], v[220:223]
    buffer_load_dwordx4 v8, s[56:59], s76 offen offset:0  lds
    v_mfma_f32_16x16x32_bf16 v[224:227], a[16:19], a[24:27], v[224:227]
    v_exp_f32 v90, v90
    v_mfma_f32_16x16x32_bf16 v[228:231], a[16:19], a[28:31], v[228:231]
    s_add_u32 m0, s73, 41728
    v_mul_f32 v108, v90, v92
    v_mfma_f32_16x16x32_bf16 v[232:235], a[16:19], a[32:35], v[232:235]
    buffer_load_dwordx4 v4, s[52:55], s72 offen offset:1280  lds
    v_mfma_f32_16x16x32_bf16 v[236:239], a[16:19], a[36:39], v[236:239]
    v_mul_f32 v109, v90, v93
    v_mul_f32 v91, v87, v111
    s_waitcnt lgkmcnt(0)
    v_mfma_f32_16x16x32_bf16 v[160:163], a[40:43], a[64:67], v[160:163]
    v_mfma_f32_16x16x32_bf16 v[164:167], a[40:43], a[68:71], v[164:167]
    s_waitcnt vmcnt(6)
    s_barrier
    v_mfma_f32_16x16x32_bf16 v[168:171], a[40:43], a[72:75], v[168:171]
    s_add_u32 m0, s74, 93696
    ds_read_b128 a[0:3], v14 offset:49152
    v_mfma_f32_16x16x32_bf16 v[172:175], a[40:43], a[76:79], v[172:175]
    v_mul_f32 v90, v87, v110
    v_fract_f32 v91, v91
    v_mfma_f32_16x16x32_bf16 v[176:179], a[44:47], a[64:67], v[176:179]
    buffer_load_dwordx4 v8, s[56:59], s76 offen offset:2560  lds
    v_mfma_f32_16x16x32_bf16 v[180:183], a[44:47], a[68:71], v[180:183]
    ds_read_b128 a[24:27], v6 offset:32768
    v_mfma_f32_16x16x32_bf16 v[184:187], a[44:47], a[72:75], v[184:187]
    s_add_u32 m0, s73, 42752
    ds_read_b128 a[4:7], v14 offset:51200
    v_mfma_f32_16x16x32_bf16 v[188:191], a[44:47], a[76:79], v[188:191]
    buffer_load_dwordx4 v5, s[52:55], s72 offen offset:1280  lds
    v_mfma_f32_16x16x32_bf16 v[192:195], a[48:51], a[64:67], v[192:195]
    ds_read_b128 a[28:31], v6 offset:34816
    v_cos_f32 v92, v91
    v_mfma_f32_16x16x32_bf16 v[196:199], a[48:51], a[68:71], v[196:199]
    s_add_u32 m0, s74, 98304
    v_mfma_f32_16x16x32_bf16 v[200:203], a[48:51], a[72:75], v[200:203]
    ds_read_b128 a[8:11], v14 offset:53248
    v_mfma_f32_16x16x32_bf16 v[204:207], a[48:51], a[76:79], v[204:207]
    buffer_load_dwordx4 v9, s[56:59], s75 offen offset:0  lds
    v_mfma_f32_16x16x32_bf16 v[208:211], a[52:55], a[64:67], v[208:211]
    ds_read_b128 a[32:35], v6 offset:36864
    v_sin_f32 v93, v91
    v_mfma_f32_16x16x32_bf16 v[212:215], a[52:55], a[68:71], v[212:215]
    s_add_u32 s43, s42, 0
    v_mfma_f32_16x16x32_bf16 v[216:219], a[52:55], a[72:75], v[216:219]
    s_add_u32 m0, s18, 0
    ds_read_b128 a[12:15], v14 offset:55296
    v_mfma_f32_16x16x32_bf16 v[220:223], a[52:55], a[76:79], v[220:223]
    buffer_load_dwordx4 v20, s[64:67], s43 offen lds
    v_mfma_f32_16x16x32_bf16 v[224:227], a[56:59], a[64:67], v[224:227]
    ds_read_b128 a[36:39], v6 offset:38912
    v_exp_f32 v90, v90
    v_mfma_f32_16x16x32_bf16 v[228:231], a[56:59], a[68:71], v[228:231]
    v_mul_f32 v110, v90, v92
    v_mul_f32 v111, v90, v93
    v_mfma_f32_16x16x32_bf16 v[232:235], a[56:59], a[72:75], v[232:235]
    s_add_u32 m0, s18, 1024
    ds_read_b128 a[16:19], v14 offset:57344
    v_mfma_f32_16x16x32_bf16 v[236:239], a[56:59], a[76:79], v[236:239]
    buffer_load_dwordx4 v21, s[64:67], s43 offen lds
    v_mfma_f32_16x16x32_bf16 a[84:87], a[40:43], a[80:83], a[84:87]
    v_mul_f32 v91, v87, v113
    v_mul_f32 v90, v87, v112
    v_mfma_f32_16x16x32_bf16 a[88:91], a[44:47], a[80:83], a[88:91]
    s_add_u32 m0, s18, 2048
    v_fract_f32 v91, v91
    v_mfma_f32_16x16x32_bf16 a[92:95], a[48:51], a[80:83], a[92:95]
    buffer_load_dwordx4 v22, s[64:67], s43 offen lds
    v_mfma_f32_16x16x32_bf16 a[96:99], a[52:55], a[80:83], a[96:99]
    v_cos_f32 v92, v91
    v_mfma_f32_16x16x32_bf16 a[100:103], a[56:59], a[80:83], a[100:103]
    v_sin_f32 v93, v91
    s_waitcnt lgkmcnt(0)
    v_mfma_f32_16x16x32_bf16 v[160:163], a[0:3], a[24:27], v[160:163]
    s_add_u32 m0, s18, 3072
    ds_read_b128 a[40:43], v15 offset:49152
    v_mfma_f32_16x16x32_bf16 v[164:167], a[0:3], a[28:31], v[164:167]
    s_lshl_b32 s12, s6, 12
    s_add_u32 s12, s12, 18874368
    v_mfma_f32_16x16x32_bf16 v[168:171], a[0:3], a[32:35], v[168:171]
    buffer_load_dwordx4 v23, s[64:67], s43 offen lds
    v_mfma_f32_16x16x32_bf16 v[172:175], a[0:3], a[36:39], v[172:175]
    ds_read_b128 a[64:67], v7 offset:32768
    v_lshlrev_b32 v128, 4, v0
    v_mfma_f32_16x16x32_bf16 v[176:179], a[4:7], a[24:27], v[176:179]
    ds_read_b128 a[44:47], v15 offset:51200
    v_add_u32 v128, s12, v128
    v_mfma_f32_16x16x32_bf16 v[180:183], a[4:7], a[28:31], v[180:183]
    ds_read_b128 a[68:71], v7 offset:34816
    v_exp_f32 v90, v90
    v_mfma_f32_16x16x32_bf16 v[184:187], a[4:7], a[32:35], v[184:187]
    s_add_u32 m0, s18, 4096
    v_mul_f32 v112, v90, v92
    v_mfma_f32_16x16x32_bf16 v[188:191], a[4:7], a[36:39], v[188:191]
    ds_read_b128 a[48:51], v15 offset:53248
    buffer_load_dwordx4 v[124:127], v128, s[60:63], 0 offen sc1
    v_mfma_f32_16x16x32_bf16 v[192:195], a[8:11], a[24:27], v[192:195]
    buffer_load_dwordx4 v24, s[64:67], s43 offen lds
    v_mfma_f32_16x16x32_bf16 v[196:199], a[8:11], a[28:31], v[196:199]
    ds_read_b128 a[72:75], v7 offset:36864
    v_mul_f32 v113, v90, v93
    v_mfma_f32_16x16x32_bf16 v[200:203], a[8:11], a[32:35], v[200:203]
    ds_read_b128 a[52:55], v15 offset:55296
    s_mul_i32 s87, s7, 20480
    v_mfma_f32_16x16x32_bf16 v[204:207], a[8:11], a[36:39], v[204:207]
    ds_read_b128 a[76:79], v7 offset:38912
    s_add_u32 s87, s87, 16777216
    v_mfma_f32_16x16x32_bf16 v[208:211], a[12:15], a[24:27], v[208:211]
    s_add_u32 s43, s42, 20480
    s_mul_i32 s86, s6, 1280
    v_mfma_f32_16x16x32_bf16 v[212:215], a[12:15], a[28:31], v[212:215]
    ds_read_b128 a[56:59], v15 offset:57344
    s_add_u32 s86, s86, s87
    v_mfma_f32_16x16x32_bf16 v[216:219], a[12:15], a[32:35], v[216:219]
    s_add_u32 m0, s19, 0
    v_mfma_f32_16x16x32_bf16 v[220:223], a[12:15], a[36:39], v[220:223]
    v_mfma_f32_16x16x32_bf16 v[224:227], a[16:19], a[24:27], v[224:227]
    buffer_load_dwordx4 v20, s[64:67], s43 offen lds
    v_mfma_f32_16x16x32_bf16 v[228:231], a[16:19], a[28:31], v[228:231]
    v_mfma_f32_16x16x32_bf16 v[232:235], a[16:19], a[32:35], v[232:235]
    v_mfma_f32_16x16x32_bf16 v[236:239], a[16:19], a[36:39], v[236:239]
    s_waitcnt lgkmcnt(0)
    v_mfma_f32_16x16x32_bf16 v[160:163], a[40:43], a[64:67], v[160:163]
    v_mfma_f32_16x16x32_bf16 v[164:167], a[40:43], a[68:71], v[164:167]
    s_waitcnt vmcnt(7)
    s_barrier
    v_mfma_f32_16x16x32_bf16 v[168:171], a[40:43], a[72:75], v[168:171]
    s_add_u32 m0, s19, 1024
    ds_read_b128 a[0:3], v14 offset:0
    v_mfma_f32_16x16x32_bf16 v[172:175], a[40:43], a[76:79], v[172:175]
    v_mfma_f32_16x16x32_bf16 v[176:179], a[44:47], a[64:67], v[176:179]
    buffer_load_dwordx4 v21, s[64:67], s43 offen lds
    v_mfma_f32_16x16x32_bf16 v[180:183], a[44:47], a[68:71], v[180:183]
    ds_read_b128 a[24:27], v6 offset:0
    v_mfma_f32_16x16x32_bf16 v[184:187], a[44:47], a[72:75], v[184:187]
    ds_read_b128 a[4:7], v14 offset:2048
    v_mfma_f32_16x16x32_bf16 v[188:191], a[44:47], a[76:79], v[188:191]
    s_add_u32 m0, s19, 2048
    v_mfma_f32_16x16x32_bf16 v[192:195], a[48:51], a[64:67], v[192:195]
    buffer_load_dwordx4 v22, s[64:67], s43 offen lds
    v_mfma_f32_16x16x32_bf16 v[196:199], a[48:51], a[68:71], v[196:199]
    ds_read_b128 a[28:31], v6 offset:2048
    v_mfma_f32_16x16x32_bf16 v[200:203], a[48:51], a[72:75], v[200:203]
    ds_read_b128 a[8:11], v14 offset:4096
    v_mfma_f32_16x16x32_bf16 v[204:207], a[48:51], a[76:79], v[204:207]
    s_add_u32 m0, s19, 3072
    v_mfma_f32_16x16x32_bf16 v[208:211], a[52:55], a[64:67], v[208:211]
    buffer_load_dwordx4 v23, s[64:67], s43 offen lds
    v_mfma_f32_16x16x32_bf16 v[212:215], a[52:55], a[68:71], v[212:215]
    ds_read_b128 a[32:35], v6 offset:4096
    v_mfma_f32_16x16x32_bf16 v[216:219], a[52:55], a[72:75], v[216:219]
    ds_read_b128 a[12:15], v14 offset:6144
    v_mfma_f32_16x16x32_bf16 v[220:223], a[52:55], a[76:79], v[220:223]
    s_add_u32 m0, s19, 4096
    v_mfma_f32_16x16x32_bf16 v[224:227], a[56:59], a[64:67], v[224:227]
    buffer_load_dwordx4 v24, s[64:67], s43 offen lds
    v_mfma_f32_16x16x32_bf16 v[228:231], a[56:59], a[68:71], v[228:231]
    ds_read_b128 a[36:39], v6 offset:6144
    v_mfma_f32_16x16x32_bf16 v[232:235], a[56:59], a[72:75], v[232:235]
    ds_read_b128 a[16:19], v14 offset:8192
    v_mfma_f32_16x16x32_bf16 v[236:239], a[56:59], a[76:79], v[236:239]
    s_add_u32 s43, s42, 40960
    v_mfma_f32_16x16x32_bf16 a[84:87], a[40:43], a[80:83], a[84:87]
    s_add_u32 m0, s20, 0
    v_mfma_f32_16x16x32_bf16 a[88:91], a[44:47], a[80:83], a[88:91]
    v_mfma_f32_16x16x32_bf16 a[92:95], a[48:51], a[80:83], a[92:95]
    buffer_load_dwordx4 v20, s[64:67], s43 offen lds
    v_mfma_f32_16x16x32_bf16 a[96:99], a[52:55], a[80:83], a[96:99]
    v_mfma_f32_16x16x32_bf16 a[100:103], a[56:59], a[80:83], a[100:103]
    s_waitcnt lgkmcnt(0)
    v_mfma_f32_16x16x32_bf16 v[160:163], a[0:3], a[24:27], v[160:163]
    s_add_u32 m0, s20, 1024
    ds_read_b128 a[40:43], v15 offset:0
    v_mfma_f32_16x16x32_bf16 v[164:167], a[0:3], a[28:31], v[164:167]
    v_mfma_f32_16x16x32_bf16 v[168:171], a[0:3], a[32:35], v[168:171]
    buffer_load_dwordx4 v21, s[64:67], s43 offen lds
    v_mfma_f32_16x16x32_bf16 v[172:175], a[0:3], a[36:39], v[172:175]
    ds_read_b128 a[64:67], v7 offset:0
    v_mfma_f32_16x16x32_bf16 v[176:179], a[4:7], a[24:27], v[176:179]
    s_add_u32 m0, s20, 2048
    ds_read_b128 a[44:47], v15 offset:2048
    v_mfma_f32_16x16x32_bf16 v[180:183], a[4:7], a[28:31], v[180:183]
    buffer_load_dwordx4 v22, s[64:67], s43 offen lds
    v_mfma_f32_16x16x32_bf16 v[184:187], a[4:7], a[32:35], v[184:187]
    ds_read_b128 a[68:71], v7 offset:2048
    v_mfma_f32_16x16x32_bf16 v[188:191], a[4:7], a[36:39], v[188:191]
    ds_read_b128 a[48:51], v15 offset:4096
    v_mfma_f32_16x16x32_bf16 v[192:195], a[8:11], a[24:27], v[192:195]
    s_add_u32 m0, s20, 3072
    ds_read_b128 a[72:75], v7 offset:4096
    v_mfma_f32_16x16x32_bf16 v[196:199], a[8:11], a[28:31], v[196:199]
    buffer_load_dwordx4 v23, s[64:67], s43 offen lds
    v_mfma_f32_16x16x32_bf16 v[200:203], a[8:11], a[32:35], v[200:203]
    ds_read_b128 a[52:55], v15 offset:6144
    v_mfma_f32_16x16x32_bf16 v[204:207], a[8:11], a[36:39], v[204:207]
    s_add_u32 m0, s20, 4096
    ds_read_b128 a[76:79], v7 offset:6144
    v_mfma_f32_16x16x32_bf16 v[208:211], a[12:15], a[24:27], v[208:211]
    buffer_load_dwordx4 v24, s[64:67], s43 offen lds
    v_mfma_f32_16x16x32_bf16 v[212:215], a[12:15], a[28:31], v[212:215]
    ds_read_b128 a[56:59], v15 offset:8192
    v_mfma_f32_16x16x32_bf16 v[216:219], a[12:15], a[32:35], v[216:219]
    v_mfma_f32_16x16x32_bf16 v[220:223], a[12:15], a[36:39], v[220:223]
    s_add_u32 s43, s42, 61440
    v_mfma_f32_16x16x32_bf16 v[224:227], a[16:19], a[24:27], v[224:227]
    s_add_u32 m0, s21, 0
    v_mfma_f32_16x16x32_bf16 v[228:231], a[16:19], a[28:31], v[228:231]
    buffer_load_dwordx4 v20, s[64:67], s43 offen lds
    v_mfma_f32_16x16x32_bf16 v[232:235], a[16:19], a[32:35], v[232:235]
    v_mfma_f32_16x16x32_bf16 v[236:239], a[16:19], a[36:39], v[236:239]
    s_waitcnt lgkmcnt(0)
    v_mfma_f32_16x16x32_bf16 a[84:87], a[40:43], a[80:83], a[84:87]
    v_mfma_f32_16x16x32_bf16 a[88:91], a[44:47], a[80:83], a[88:91]
    s_waitcnt vmcnt(12)
L_chk_rs_ssm:
    v_cmp_ne_u32 vcc, s11, v125
    v_cmp_ne_u32 s[12:13], s11, v127
    s_or_b64 vcc, vcc, s[12:13]
    s_cmp_eq_u64 vcc, 0
    s_cbranch_scc1 L_chkok_rs_ssm
    s_sub_u32 s81, s81, 1
    s_cbranch_scc1 L_end
    buffer_load_dwordx4 v[124:127], v128, s[60:63], 0 offen sc1
    s_waitcnt vmcnt(0)
    s_branch L_chk_rs_ssm
L_chkok_rs_ssm:
    ds_write2_b32 v79, v124, v126 offset0:0 offset1:1
    v_mfma_f32_16x16x32_bf16 a[92:95], a[48:51], a[80:83], a[92:95]
    s_add_u32 m0, s21, 1024
    ds_write_b64 v81, v[156:157] offset:2048
    v_mfma_f32_16x16x32_bf16 a[96:99], a[52:55], a[80:83], a[96:99]
    v_mfma_f32_16x16x32_bf16 a[100:103], a[56:59], a[80:83], a[100:103]
    buffer_load_dwordx4 v21, s[64:67], s43 offen lds
    v_mfma_f32_16x16x32_bf16 v[160:163], a[40:43], a[64:67], v[160:163]
    ds_write_b64 v86, v[158:159] offset:2056
    v_mfma_f32_16x16x32_bf16 v[164:167], a[40:43], a[68:71], v[164:167]
    ds_write_b64 v84, v[104:105] offset:7168
    v_mfma_f32_16x16x32_bf16 v[168:171], a[40:43], a[72:75], v[168:171]
    s_add_u32 m0, s21, 2048
    ds_write_b64 v85, v[104:105] offset:2064
    v_mfma_f32_16x16x32_bf16 v[172:175], a[40:43], a[76:79], v[172:175]
    buffer_load_dwordx4 v22, s[64:67], s43 offen lds
    v_mfma_f32_16x16x32_bf16 v[176:179], a[44:47], a[64:67], v[176:179]
    ds_write_b64 v84, v[106:107] offset:9216
    v_mfma_f32_16x16x32_bf16 v[180:183], a[44:47], a[68:71], v[180:183]
    ds_write_b64 v85, v[106:107] offset:3088
    v_mfma_f32_16x16x32_bf16 v[184:187], a[44:47], a[72:75], v[184:187]
    s_add_u32 m0, s21, 3072
    ds_write_b128 v76, a[84:87] offset:0
    v_mfma_f32_16x16x32_bf16 v[188:191], a[44:47], a[76:79], v[188:191]
    buffer_load_dwordx4 v23, s[64:67], s43 offen lds
    v_mfma_f32_16x16x32_bf16 v[192:195], a[48:51], a[64:67], v[192:195]
    ds_write_b128 v76, a[88:91] offset:64
    v_mfma_f32_16x16x32_bf16 v[196:199], a[48:51], a[68:71], v[196:199]
    ds_write_b64 v84, v[108:109] offset:11264
    v_mfma_f32_16x16x32_bf16 v[200:203], a[48:51], a[72:75], v[200:203]
    s_add_u32 m0, s21, 4096
    ds_write_b128 v76, a[92:95] offset:128
    v_mfma_f32_16x16x32_bf16 v[204:207], a[48:51], a[76:79], v[204:207]
    buffer_load_dwordx4 v24, s[64:67], s43 offen lds
    v_mfma_f32_16x16x32_bf16 v[208:211], a[52:55], a[64:67], v[208:211]
    ds_write_b128 v76, a[96:99] offset:192
    v_mfma_f32_16x16x32_bf16 v[212:215], a[52:55], a[68:71], v[212:215]
    ds_write_b128 v76, a[100:103] offset:256
    v_mfma_f32_16x16x32_bf16 v[216:219], a[52:55], a[72:75], v[216:219]
    s_add_u32 s43, s42, 81920
    ds_write_b64 v85, v[108:109] offset:4112
    v_mfma_f32_16x16x32_bf16 v[220:223], a[52:55], a[76:79], v[220:223]
    s_add_u32 m0, s35, 0
    ds_write_b64 v84, v[110:111] offset:13312
    v_mfma_f32_16x16x32_bf16 v[224:227], a[56:59], a[64:67], v[224:227]
    ds_write_b64 v85, v[110:111] offset:5136
    v_mfma_f32_16x16x32_bf16 v[228:231], a[56:59], a[68:71], v[228:231]
    buffer_load_dwordx4 v20, s[64:67], s43 offen lds
    v_mfma_f32_16x16x32_bf16 v[232:235], a[56:59], a[72:75], v[232:235]
    ds_write_b64 v84, v[112:113] offset:15360
    v_mfma_f32_16x16x32_bf16 v[236:239], a[56:59], a[76:79], v[236:239]
    ds_write_b64 v85, v[112:113] offset:6160
    v_mov_b32 v8, v114
    v_mov_b32 v9, v115
    v_mov_b32 v10, v116
    v_mov_b32 v11, v117
    v_mov_b32 v12, v118
    v_mov_b32 v13, v119
    s_waitcnt lgkmcnt(0)
    s_barrier
    ds_read_b128 v[48:51], v78 offset:0
    ds_read_b128 v[52:55], v78 offset:16
    ds_read_b128 v[56:59], v78 offset:32
    ds_read_b128 v[60:63], v78 offset:48
    ds_read_b128 v[100:103], v77 offset:320
    ds_read_b128 v[104:107], v77 offset:384
    ds_read_b128 v[108:111], v77 offset:448
    ds_read_b128 v[112:115], v77 offset:512
    ds_read_b128 v[116:119], v77 offset:576
    ds_read_b128 v[64:67], v77 offset:0
    ds_read_b128 v[68:71], v77 offset:64
    ds_read_b128 v[72:75], v77 offset:128
    ds_read_b128 v[80:83], v77 offset:256
    ds_read_b128 v[76:79], v77 offset:192
    s_waitcnt lgkmcnt(0)
    v_pk_add_f32 v[64:65], v[64:65], v[100:101]
    v_pk_add_f32 v[66:67], v[66:67], v[102:103]
    v_pk_add_f32 v[68:69], v[68:69], v[104:105]
    v_pk_add_f32 v[70:71], v[70:71], v[106:107]
    v_pk_add_f32 v[72:73], v[72:73], v[108:109]
    v_pk_add_f32 v[74:75], v[74:75], v[110:111]
    v_pk_add_f32 v[76:77], v[76:77], v[112:113]
    v_pk_add_f32 v[78:79], v[78:79], v[114:115]
    v_pk_add_f32 v[80:81], v[80:81], v[116:117]
    v_pk_add_f32 v[82:83], v[82:83], v[118:119]
    ds_read_b128 v[100:103], v28 offset:2048
    ds_read_b128 v[104:107], v28 offset:2112
    ds_read_b128 v[108:111], v28 offset:2176
    ds_read_b128 v[112:115], v28 offset:2240
    ds_read_b128 v[116:119], v28 offset:2304
    ds_read_b128 v[120:123], v28 offset:2368
    ds_read_b128 v[124:127], v28 offset:2432
    ds_read_b128 v[128:131], v28 offset:2496
    ds_read_b128 v[132:135], v29 offset:2048
    ds_read_b128 v[136:139], v29 offset:2112
.p2align 3
    v_pk_fma_f32 v[160:161], v[64:65], v[48:49], v[160:161] op_sel:[0,0,0] op_sel_hi:[1,0,1] neg_lo:[0,1,0] neg_hi:[0,1,0]
    v_pk_fma_f32 v[164:165], v[64:65], v[52:53], v[164:165] op_sel:[0,0,0] op_sel_hi:[1,0,1] neg_lo:[0,1,0] neg_hi:[0,1,0]
    v_pk_fma_f32 v[168:169], v[64:65], v[56:57], v[168:169] op_sel:[0,0,0] op_sel_hi:[1,0,1] neg_lo:[0,1,0] neg_hi:[0,1,0]
    v_pk_fma_f32 v[172:173], v[64:65], v[60:61], v[172:173] op_sel:[0,0,0] op_sel_hi:[1,0,1] neg_lo:[0,1,0] neg_hi:[0,1,0]
    v_pk_mul_f32 v[160:161], v[160:161], v[48:49] op_sel:[0,1] op_sel_hi:[1,1]
    v_pk_mul_f32 v[164:165], v[164:165], v[52:53] op_sel:[0,1] op_sel_hi:[1,1]
    v_pk_mul_f32 v[168:169], v[168:169], v[56:57] op_sel:[0,1] op_sel_hi:[1,1]
    v_pk_mul_f32 v[172:173], v[172:173], v[60:61] op_sel:[0,1] op_sel_hi:[1,1]
    v_pk_fma_f32 v[162:163], v[66:67], v[48:49], v[162:163] op_sel:[0,0,0] op_sel_hi:[1,0,1] neg_lo:[0,1,0] neg_hi:[0,1,0]
    v_pk_fma_f32 v[166:167], v[66:67], v[52:53], v[166:167] op_sel:[0,0,0] op_sel_hi:[1,0,1] neg_lo:[0,1,0] neg_hi:[0,1,0]
    v_pk_fma_f32 v[170:171], v[66:67], v[56:57], v[170:171] op_sel:[0,0,0] op_sel_hi:[1,0,1] neg_lo:[0,1,0] neg_hi:[0,1,0]
    v_pk_fma_f32 v[174:175], v[66:67], v[60:61], v[174:175] op_sel:[0,0,0] op_sel_hi:[1,0,1] neg_lo:[0,1,0] neg_hi:[0,1,0]
    v_pk_mul_f32 v[162:163], v[162:163], v[48:49] op_sel:[0,1] op_sel_hi:[1,1]
    v_pk_mul_f32 v[166:167], v[166:167], v[52:53] op_sel:[0,1] op_sel_hi:[1,1]
    v_pk_mul_f32 v[170:171], v[170:171], v[56:57] op_sel:[0,1] op_sel_hi:[1,1]
    v_pk_mul_f32 v[174:175], v[174:175], v[60:61] op_sel:[0,1] op_sel_hi:[1,1]
    v_pk_fma_f32 v[176:177], v[68:69], v[48:49], v[176:177] op_sel:[0,0,0] op_sel_hi:[1,0,1] neg_lo:[0,1,0] neg_hi:[0,1,0]
    v_pk_fma_f32 v[180:181], v[68:69], v[52:53], v[180:181] op_sel:[0,0,0] op_sel_hi:[1,0,1] neg_lo:[0,1,0] neg_hi:[0,1,0]
    v_pk_fma_f32 v[184:185], v[68:69], v[56:57], v[184:185] op_sel:[0,0,0] op_sel_hi:[1,0,1] neg_lo:[0,1,0] neg_hi:[0,1,0]
    v_pk_fma_f32 v[188:189], v[68:69], v[60:61], v[188:189] op_sel:[0,0,0] op_sel_hi:[1,0,1] neg_lo:[0,1,0] neg_hi:[0,1,0]
    v_pk_mul_f32 v[176:177], v[176:177], v[48:49] op_sel:[0,1] op_sel_hi:[1,1]
    v_pk_mul_f32 v[180:181], v[180:181], v[52:53] op_sel:[0,1] op_sel_hi:[1,1]
    v_pk_mul_f32 v[184:185], v[184:185], v[56:57] op_sel:[0,1] op_sel_hi:[1,1]
    v_pk_mul_f32 v[188:189], v[188:189], v[60:61] op_sel:[0,1] op_sel_hi:[1,1]
    v_pk_fma_f32 v[178:179], v[70:71], v[48:49], v[178:179] op_sel:[0,0,0] op_sel_hi:[1,0,1] neg_lo:[0,1,0] neg_hi:[0,1,0]
    v_pk_fma_f32 v[182:183], v[70:71], v[52:53], v[182:183] op_sel:[0,0,0] op_sel_hi:[1,0,1] neg_lo:[0,1,0] neg_hi:[0,1,0]
    v_pk_fma_f32 v[186:187], v[70:71], v[56:57], v[186:187] op_sel:[0,0,0] op_sel_hi:[1,0,1] neg_lo:[0,1,0] neg_hi:[0,1,0]
    v_pk_fma_f32 v[190:191], v[70:71], v[60:61], v[190:191] op_sel:[0,0,0] op_sel_hi:[1,0,1] neg_lo:[0,1,0] neg_hi:[0,1,0]
    v_pk_mul_f32 v[178:179], v[178:179], v[48:49] op_sel:[0,1] op_sel_hi:[1,1]
    v_pk_mul_f32 v[182:183], v[182:183], v[52:53] op_sel:[0,1] op_sel_hi:[1,1]
    v_pk_mul_f32 v[186:187], v[186:187], v[56:57] op_sel:[0,1] op_sel_hi:[1,1]
    v_pk_mul_f32 v[190:191], v[190:191], v[60:61] op_sel:[0,1] op_sel_hi:[1,1]
    v_pk_fma_f32 v[192:193], v[72:73], v[48:49], v[192:193] op_sel:[0,0,0] op_sel_hi:[1,0,1] neg_lo:[0,1,0] neg_hi:[0,1,0]
    v_pk_fma_f32 v[196:197], v[72:73], v[52:53], v[196:197] op_sel:[0,0,0] op_sel_hi:[1,0,1] neg_lo:[0,1,0] neg_hi:[0,1,0]
    v_pk_fma_f32 v[200:201], v[72:73], v[56:57], v[200:201] op_sel:[0,0,0] op_sel_hi:[1,0,1] neg_lo:[0,1,0] neg_hi:[0,1,0]
    v_pk_fma_f32 v[204:205], v[72:73], v[60:61], v[204:205] op_sel:[0,0,0] op_sel_hi:[1,0,1] neg_lo:[0,1,0] neg_hi:[0,1,0]
    v_pk_mul_f32 v[192:193], v[192:193], v[48:49] op_sel:[0,1] op_sel_hi:[1,1]
    v_pk_mul_f32 v[196:197], v[196:197], v[52:53] op_sel:[0,1] op_sel_hi:[1,1]
    v_pk_mul_f32 v[200:201], v[200:201], v[56:57] op_sel:[0,1] op_sel_hi:[1,1]
    v_pk_mul_f32 v[204:205], v[204:205], v[60:61] op_sel:[0,1] op_sel_hi:[1,1]
    v_pk_fma_f32 v[194:195], v[74:75], v[48:49], v[194:195] op_sel:[0,0,0] op_sel_hi:[1,0,1] neg_lo:[0,1,0] neg_hi:[0,1,0]
    v_pk_fma_f32 v[198:199], v[74:75], v[52:53], v[198:199] op_sel:[0,0,0] op_sel_hi:[1,0,1] neg_lo:[0,1,0] neg_hi:[0,1,0]
    v_pk_fma_f32 v[202:203], v[74:75], v[56:57], v[202:203] op_sel:[0,0,0] op_sel_hi:[1,0,1] neg_lo:[0,1,0] neg_hi:[0,1,0]
    v_pk_fma_f32 v[206:207], v[74:75], v[60:61], v[206:207] op_sel:[0,0,0] op_sel_hi:[1,0,1] neg_lo:[0,1,0] neg_hi:[0,1,0]
    v_pk_mul_f32 v[194:195], v[194:195], v[48:49] op_sel:[0,1] op_sel_hi:[1,1]
    v_pk_mul_f32 v[198:199], v[198:199], v[52:53] op_sel:[0,1] op_sel_hi:[1,1]
    v_pk_mul_f32 v[202:203], v[202:203], v[56:57] op_sel:[0,1] op_sel_hi:[1,1]
    v_pk_mul_f32 v[206:207], v[206:207], v[60:61] op_sel:[0,1] op_sel_hi:[1,1]
    s_add_u32 m0, s35, 1024
    s_nop 0
    buffer_load_dwordx4 v21, s[64:67], s43 offen lds
    v_pk_fma_f32 v[208:209], v[76:77], v[48:49], v[208:209] op_sel:[0,0,0] op_sel_hi:[1,0,1] neg_lo:[0,1,0] neg_hi:[0,1,0]
    v_pk_fma_f32 v[212:213], v[76:77], v[52:53], v[212:213] op_sel:[0,0,0] op_sel_hi:[1,0,1] neg_lo:[0,1,0] neg_hi:[0,1,0]
    v_pk_fma_f32 v[216:217], v[76:77], v[56:57], v[216:217] op_sel:[0,0,0] op_sel_hi:[1,0,1] neg_lo:[0,1,0] neg_hi:[0,1,0]
    v_pk_fma_f32 v[220:221], v[76:77], v[60:61], v[220:221] op_sel:[0,0,0] op_sel_hi:[1,0,1] neg_lo:[0,1,0] neg_hi:[0,1,0]
    v_pk_mul_f32 v[208:209], v[208:209], v[48:49] op_sel:[0,1] op_sel_hi:[1,1]
    v_pk_mul_f32 v[212:213], v[212:213], v[52:53] op_sel:[0,1] op_sel_hi:[1,1]
    v_pk_mul_f32 v[216:217], v[216:217], v[56:57] op_sel:[0,1] op_sel_hi:[1,1]
    v_pk_mul_f32 v[220:221], v[220:221], v[60:61] op_sel:[0,1] op_sel_hi:[1,1]
    v_pk_fma_f32 v[210:211], v[78:79], v[48:49], v[210:211] op_sel:[0,0,0] op_sel_hi:[1,0,1] neg_lo:[0,1,0] neg_hi:[0,1,0]
    v_pk_fma_f32 v[214:215], v[78:79], v[52:53], v[214:215] op_sel:[0,0,0] op_sel_hi:[1,0,1] neg_lo:[0,1,0] neg_hi:[0,1,0]
    v_pk_fma_f32 v[218:219], v[78:79], v[56:57], v[218:219] op_sel:[0,0,0] op_sel_hi:[1,0,1] neg_lo:[0,1,0] neg_hi:[0,1,0]
    v_pk_fma_f32 v[222:223], v[78:79], v[60:61], v[222:223] op_sel:[0,0,0] op_sel_hi:[1,0,1] neg_lo:[0,1,0] neg_hi:[0,1,0]
    v_pk_mul_f32 v[210:211], v[210:211], v[48:49] op_sel:[0,1] op_sel_hi:[1,1]
    v_pk_mul_f32 v[214:215], v[214:215], v[52:53] op_sel:[0,1] op_sel_hi:[1,1]
    v_pk_mul_f32 v[218:219], v[218:219], v[56:57] op_sel:[0,1] op_sel_hi:[1,1]
    v_pk_mul_f32 v[222:223], v[222:223], v[60:61] op_sel:[0,1] op_sel_hi:[1,1]
    v_pk_fma_f32 v[224:225], v[80:81], v[48:49], v[224:225] op_sel:[0,0,0] op_sel_hi:[1,0,1] neg_lo:[0,1,0] neg_hi:[0,1,0]
    v_pk_fma_f32 v[228:229], v[80:81], v[52:53], v[228:229] op_sel:[0,0,0] op_sel_hi:[1,0,1] neg_lo:[0,1,0] neg_hi:[0,1,0]
    v_pk_fma_f32 v[232:233], v[80:81], v[56:57], v[232:233] op_sel:[0,0,0] op_sel_hi:[1,0,1] neg_lo:[0,1,0] neg_hi:[0,1,0]
    v_pk_fma_f32 v[236:237], v[80:81], v[60:61], v[236:237] op_sel:[0,0,0] op_sel_hi:[1,0,1] neg_lo:[0,1,0] neg_hi:[0,1,0]
    v_pk_mul_f32 v[224:225], v[224:225], v[48:49] op_sel:[0,1] op_sel_hi:[1,1]
    v_pk_mul_f32 v[228:229], v[228:229], v[52:53] op_sel:[0,1] op_sel_hi:[1,1]
    v_pk_mul_f32 v[232:233], v[232:233], v[56:57] op_sel:[0,1] op_sel_hi:[1,1]
    v_pk_mul_f32 v[236:237], v[236:237], v[60:61] op_sel:[0,1] op_sel_hi:[1,1]
    v_pk_fma_f32 v[226:227], v[82:83], v[48:49], v[226:227] op_sel:[0,0,0] op_sel_hi:[1,0,1] neg_lo:[0,1,0] neg_hi:[0,1,0]
    v_pk_fma_f32 v[230:231], v[82:83], v[52:53], v[230:231] op_sel:[0,0,0] op_sel_hi:[1,0,1] neg_lo:[0,1,0] neg_hi:[0,1,0]
    v_pk_fma_f32 v[234:235], v[82:83], v[56:57], v[234:235] op_sel:[0,0,0] op_sel_hi:[1,0,1] neg_lo:[0,1,0] neg_hi:[0,1,0]
    v_pk_fma_f32 v[238:239], v[82:83], v[60:61], v[238:239] op_sel:[0,0,0] op_sel_hi:[1,0,1] neg_lo:[0,1,0] neg_hi:[0,1,0]
    v_pk_mul_f32 v[226:227], v[226:227], v[48:49] op_sel:[0,1] op_sel_hi:[1,1]
    v_pk_mul_f32 v[230:231], v[230:231], v[52:53] op_sel:[0,1] op_sel_hi:[1,1]
    v_pk_mul_f32 v[234:235], v[234:235], v[56:57] op_sel:[0,1] op_sel_hi:[1,1]
    v_pk_mul_f32 v[238:239], v[238:239], v[60:61] op_sel:[0,1] op_sel_hi:[1,1]
    s_waitcnt lgkmcnt(0)
    ds_read_b64 v[40:41], v28 offset:2064
    ds_read_b64 v[42:43], v28 offset:2128
    ds_read_b64 v[44:45], v28 offset:2192
    ds_read_b64 v[46:47], v28 offset:2256
    ds_read_b64 v[48:49], v28 offset:2320
    ds_read_b64 v[50:51], v28 offset:2384
    ds_read_b64 v[52:53], v28 offset:2448
    ds_read_b64 v[54:55], v28 offset:2512
    ds_read_b64 v[56:57], v29 offset:2064
    ds_read_b64 v[58:59], v29 offset:2128
    ds_read_b64 v[60:61], v28 offset:2072
    ds_read_b64 v[62:63], v28 offset:2136
    ds_read_b64 v[64:65], v28 offset:2200
    ds_read_b64 v[66:67], v28 offset:2264
    ds_read_b64 v[68:69], v28 offset:2328
    ds_read_b64 v[70:71], v28 offset:2392
    ds_read_b64 v[72:73], v28 offset:2456
    ds_read_b64 v[74:75], v28 offset:2520
    ds_read_b64 v[76:77], v29 offset:2072
    ds_read_b64 v[78:79], v29 offset:2136
.p2align 3
    v_pk_fma_f32 v[140:141], v[160:161], v[100:101], v[164:165] op_sel:[0,0,0] op_sel_hi:[1,0,1]
    v_pk_fma_f32 v[140:141], v[160:161], v[100:101], v[140:141] op_sel:[1,1,0] op_sel_hi:[0,1,1] neg_lo:[0,1,0]
    v_pk_fma_f32 v[142:143], v[162:163], v[104:105], v[166:167] op_sel:[0,0,0] op_sel_hi:[1,0,1]
    v_pk_fma_f32 v[142:143], v[162:163], v[104:105], v[142:143] op_sel:[1,1,0] op_sel_hi:[0,1,1] neg_lo:[0,1,0]
    v_pk_fma_f32 v[144:145], v[176:177], v[108:109], v[180:181] op_sel:[0,0,0] op_sel_hi:[1,0,1]
    v_pk_fma_f32 v[144:145], v[176:177], v[108:109], v[144:145] op_sel:[1,1,0] op_sel_hi:[0,1,1] neg_lo:[0,1,0]
    v_pk_fma_f32 v[146:147], v[178:179], v[112:113], v[182:183] op_sel:[0,0,0] op_sel_hi:[1,0,1]
    v_pk_fma_f32 v[146:147], v[178:179], v[112:113], v[146:147] op_sel:[1,1,0] op_sel_hi:[0,1,1] neg_lo:[0,1,0]
    v_pk_fma_f32 v[148:149], v[192:193], v[116:117], v[196:197] op_sel:[0,0,0] op_sel_hi:[1,0,1]
    v_pk_fma_f32 v[148:149], v[192:193], v[116:117], v[148:149] op_sel:[1,1,0] op_sel_hi:[0,1,1] neg_lo:[0,1,0]
    v_pk_fma_f32 v[150:151], v[194:195], v[120:121], v[198:199] op_sel:[0,0,0] op_sel_hi:[1,0,1]
    v_pk_fma_f32 v[150:151], v[194:195], v[120:121], v[150:151] op_sel:[1,1,0] op_sel_hi:[0,1,1] neg_lo:[0,1,0]
    v_pk_fma_f32 v[152:153], v[208:209], v[124:125], v[212:213] op_sel:[0,0,0] op_sel_hi:[1,0,1]
    v_pk_fma_f32 v[152:153], v[208:209], v[124:125], v[152:153] op_sel:[1,1,0] op_sel_hi:[0,1,1] neg_lo:[0,1,0]
    v_pk_fma_f32 v[154:155], v[210:211], v[128:129], v[214:215] op_sel:[0,0,0] op_sel_hi:[1,0,1]
    v_pk_fma_f32 v[154:155], v[210:211], v[128:129], v[154:155] op_sel:[1,1,0] op_sel_hi:[0,1,1] neg_lo:[0,1,0]
    v_pk_fma_f32 v[156:157], v[224:225], v[132:133], v[228:229] op_sel:[0,0,0] op_sel_hi:[1,0,1]
    v_pk_fma_f32 v[156:157], v[224:225], v[132:133], v[156:157] op_sel:[1,1,0] op_sel_hi:[0,1,1] neg_lo:[0,1,0]
    v_pk_fma_f32 v[158:159], v[226:227], v[136:137], v[230:231] op_sel:[0,0,0] op_sel_hi:[1,0,1]
    v_pk_fma_f32 v[158:159], v[226:227], v[136:137], v[158:159] op_sel:[1,1,0] op_sel_hi:[0,1,1] neg_lo:[0,1,0]
    s_add_u32 m0, s35, 2048
    s_nop 0
    buffer_load_dwordx4 v22, s[64:67], s43 offen lds
    v_pk_fma_f32 v[240:241], v[140:141], v[100:101], v[168:169] op_sel:[0,0,0] op_sel_hi:[1,0,1]
    v_pk_fma_f32 v[240:241], v[140:141], v[100:101], v[240:241] op_sel:[1,1,0] op_sel_hi:[0,1,1] neg_lo:[0,1,0]
    v_pk_fma_f32 v[242:243], v[142:143], v[104:105], v[170:171] op_sel:[0,0,0] op_sel_hi:[1,0,1]
    v_pk_fma_f32 v[242:243], v[142:143], v[104:105], v[242:243] op_sel:[1,1,0] op_sel_hi:[0,1,1] neg_lo:[0,1,0]
    v_pk_fma_f32 v[244:245], v[144:145], v[108:109], v[184:185] op_sel:[0,0,0] op_sel_hi:[1,0,1]
    v_pk_fma_f32 v[244:245], v[144:145], v[108:109], v[244:245] op_sel:[1,1,0] op_sel_hi:[0,1,1] neg_lo:[0,1,0]
    v_pk_fma_f32 v[246:247], v[146:147], v[112:113], v[186:187] op_sel:[0,0,0] op_sel_hi:[1,0,1]
    v_pk_fma_f32 v[246:247], v[146:147], v[112:113], v[246:247] op_sel:[1,1,0] op_sel_hi:[0,1,1] neg_lo:[0,1,0]
    v_pk_fma_f32 v[248:249], v[148:149], v[116:117], v[200:201] op_sel:[0,0,0] op_sel_hi:[1,0,1]
    v_pk_fma_f32 v[248:249], v[148:149], v[116:117], v[248:249] op_sel:[1,1,0] op_sel_hi:[0,1,1] neg_lo:[0,1,0]
    v_pk_fma_f32 v[250:251], v[150:151], v[120:121], v[202:203] op_sel:[0,0,0] op_sel_hi:[1,0,1]
    v_pk_fma_f32 v[250:251], v[150:151], v[120:121], v[250:251] op_sel:[1,1,0] op_sel_hi:[0,1,1] neg_lo:[0,1,0]
    v_pk_fma_f32 v[252:253], v[152:153], v[124:125], v[216:217] op_sel:[0,0,0] op_sel_hi:[1,0,1]
    v_pk_fma_f32 v[252:253], v[152:153], v[124:125], v[252:253] op_sel:[1,1,0] op_sel_hi:[0,1,1] neg_lo:[0,1,0]
    v_pk_fma_f32 v[254:255], v[154:155], v[128:129], v[218:219] op_sel:[0,0,0] op_sel_hi:[1,0,1]
    v_pk_fma_f32 v[254:255], v[154:155], v[128:129], v[254:255] op_sel:[1,1,0] op_sel_hi:[0,1,1] neg_lo:[0,1,0]
    v_pk_fma_f32 v[88:89], v[156:157], v[132:133], v[232:233] op_sel:[0,0,0] op_sel_hi:[1,0,1]
    v_pk_fma_f32 v[88:89], v[156:157], v[132:133], v[88:89] op_sel:[1,1,0] op_sel_hi:[0,1,1] neg_lo:[0,1,0]
    v_pk_fma_f32 v[90:91], v[158:159], v[136:137], v[234:235] op_sel:[0,0,0] op_sel_hi:[1,0,1]
    v_pk_fma_f32 v[90:91], v[158:159], v[136:137], v[90:91] op_sel:[1,1,0] op_sel_hi:[0,1,1] neg_lo:[0,1,0]
    v_pk_fma_f32 v[140:141], v[240:241], v[100:101], v[172:173] op_sel:[0,0,0] op_sel_hi:[1,0,1]
    v_pk_fma_f32 v[140:141], v[240:241], v[100:101], v[140:141] op_sel:[1,1,0] op_sel_hi:[0,1,1] neg_lo:[0,1,0]
    v_pk_fma_f32 v[142:143], v[242:243], v[104:105], v[174:175] op_sel:[0,0,0] op_sel_hi:[1,0,1]
    v_pk_fma_f32 v[142:143], v[242:243], v[104:105], v[142:143] op_sel:[1,1,0] op_sel_hi:[0,1,1] neg_lo:[0,1,0]
    v_pk_fma_f32 v[144:145], v[244:245], v[108:109], v[188:189] op_sel:[0,0,0] op_sel_hi:[1,0,1]
    v_pk_fma_f32 v[144:145], v[244:245], v[108:109], v[144:145] op_sel:[1,1,0] op_sel_hi:[0,1,1] neg_lo:[0,1,0]
    v_pk_fma_f32 v[146:147], v[246:247], v[112:113], v[190:191] op_sel:[0,0,0] op_sel_hi:[1,0,1]
    v_pk_fma_f32 v[146:147], v[246:247], v[112:113], v[146:147] op_sel:[1,1,0] op_sel_hi:[0,1,1] neg_lo:[0,1,0]
    v_pk_fma_f32 v[148:149], v[248:249], v[116:117], v[204:205] op_sel:[0,0,0] op_sel_hi:[1,0,1]
    v_pk_fma_f32 v[148:149], v[248:249], v[116:117], v[148:149] op_sel:[1,1,0] op_sel_hi:[0,1,1] neg_lo:[0,1,0]
    v_pk_fma_f32 v[150:151], v[250:251], v[120:121], v[206:207] op_sel:[0,0,0] op_sel_hi:[1,0,1]
    v_pk_fma_f32 v[150:151], v[250:251], v[120:121], v[150:151] op_sel:[1,1,0] op_sel_hi:[0,1,1] neg_lo:[0,1,0]
    v_pk_fma_f32 v[152:153], v[252:253], v[124:125], v[220:221] op_sel:[0,0,0] op_sel_hi:[1,0,1]
    v_pk_fma_f32 v[152:153], v[252:253], v[124:125], v[152:153] op_sel:[1,1,0] op_sel_hi:[0,1,1] neg_lo:[0,1,0]
    v_pk_fma_f32 v[154:155], v[254:255], v[128:129], v[222:223] op_sel:[0,0,0] op_sel_hi:[1,0,1]
    v_pk_fma_f32 v[154:155], v[254:255], v[128:129], v[154:155] op_sel:[1,1,0] op_sel_hi:[0,1,1] neg_lo:[0,1,0]
    v_pk_fma_f32 v[156:157], v[88:89], v[132:133], v[236:237] op_sel:[0,0,0] op_sel_hi:[1,0,1]
    v_pk_fma_f32 v[156:157], v[88:89], v[132:133], v[156:157] op_sel:[1,1,0] op_sel_hi:[0,1,1] neg_lo:[0,1,0]
    v_pk_fma_f32 v[158:159], v[90:91], v[136:137], v[238:239] op_sel:[0,0,0] op_sel_hi:[1,0,1]
    v_pk_fma_f32 v[158:159], v[90:91], v[136:137], v[158:159] op_sel:[1,1,0] op_sel_hi:[0,1,1] neg_lo:[0,1,0]
.p2align 3
    v_mov_b32_dpp v240, v140 row_shr:1 row_mask:0xf bank_mask:0xf bound_ctrl:0
    v_mov_b32_dpp v241, v141 row_shr:1 row_mask:0xf bank_mask:0xf bound_ctrl:0
    v_mov_b32_dpp v242, v142 row_shr:1 row_mask:0xf bank_mask:0xf bound_ctrl:0
    v_mov_b32_dpp v243, v143 row_shr:1 row_mask:0xf bank_mask:0xf bound_ctrl:0
    v_mov_b32_dpp v244, v144 row_shr:1 row_mask:0xf bank_mask:0xf bound_ctrl:0
    v_mov_b32_dpp v245, v145 row_shr:1 row_mask:0xf bank_mask:0xf bound_ctrl:0
    v_mov_b32_dpp v246, v146 row_shr:1 row_mask:0xf bank_mask:0xf bound_ctrl:0
    v_mov_b32_dpp v247, v147 row_shr:1 row_mask:0xf bank_mask:0xf bound_ctrl:0
    v_mov_b32_dpp v248, v148 row_shr:1 row_mask:0xf bank_mask:0xf bound_ctrl:0
    v_mov_b32_dpp v249, v149 row_shr:1 row_mask:0xf bank_mask:0xf bound_ctrl:0
    v_mov_b32_dpp v250, v150 row_shr:1 row_mask:0xf bank_mask:0xf bound_ctrl:0
    v_mov_b32_dpp v251, v151 row_shr:1 row_mask:0xf bank_mask:0xf bound_ctrl:0
    v_mov_b32_dpp v252, v152 row_shr:1 row_mask:0xf bank_mask:0xf bound_ctrl:0
    v_mov_b32_dpp v253, v153 row_shr:1 row_mask:0xf bank_mask:0xf bound_ctrl:0
    v_mov_b32_dpp v254, v154 row_shr:1 row_mask:0xf bank_mask:0xf bound_ctrl:0
    v_mov_b32_dpp v255, v155 row_shr:1 row_mask:0xf bank_mask:0xf bound_ctrl:0
    v_mov_b32_dpp v88, v156 row_shr:1 row_mask:0xf bank_mask:0xf bound_ctrl:0
    v_mov_b32_dpp v89, v157 row_shr:1 row_mask:0xf bank_mask:0xf bound_ctrl:0
    v_mov_b32_dpp v90, v158 row_shr:1 row_mask:0xf bank_mask:0xf bound_ctrl:0
    v_mov_b32_dpp v91, v159 row_shr:1 row_mask:0xf bank_mask:0xf bound_ctrl:0
    s_add_u32 m0, s35, 3072
    s_nop 0
    buffer_load_dwordx4 v23, s[64:67], s43 offen lds
    s_waitcnt lgkmcnt(10)
.p2align 3
    v_pk_fma_f32 v[140:141], v[240:241], v[40:41], v[140:141] op_sel:[0,0,0] op_sel_hi:[1,0,1]
    v_pk_fma_f32 v[140:141], v[240:241], v[40:41], v[140:141] op_sel:[1,1,0] op_sel_hi:[0,1,1] neg_lo:[0,1,0]
    v_pk_fma_f32 v[142:143], v[242:243], v[42:43], v[142:143] op_sel:[0,0,0] op_sel_hi:[1,0,1]
    v_pk_fma_f32 v[142:143], v[242:243], v[42:43], v[142:143] op_sel:[1,1,0] op_sel_hi:[0,1,1] neg_lo:[0,1,0]
    v_pk_fma_f32 v[144:145], v[244:245], v[44:45], v[144:145] op_sel:[0,0,0] op_sel_hi:[1,0,1]
    v_pk_fma_f32 v[144:145], v[244:245], v[44:45], v[144:145] op_sel:[1,1,0] op_sel_hi:[0,1,1] neg_lo:[0,1,0]
    v_pk_fma_f32 v[146:147], v[246:247], v[46:47], v[146:147] op_sel:[0,0,0] op_sel_hi:[1,0,1]
    v_pk_fma_f32 v[146:147], v[246:247], v[46:47], v[146:147] op_sel:[1,1,0] op_sel_hi:[0,1,1] neg_lo:[0,1,0]
    v_pk_fma_f32 v[148:149], v[248:249], v[48:49], v[148:149] op_sel:[0,0,0] op_sel_hi:[1,0,1]
    v_pk_fma_f32 v[148:149], v[248:249], v[48:49], v[148:149] op_sel:[1,1,0] op_sel_hi:[0,1,1] neg_lo:[0,1,0]
    v_pk_fma_f32 v[150:151], v[250:251], v[50:51], v[150:151] op_sel:[0,0,0] op_sel_hi:[1,0,1]
    v_pk_fma_f32 v[150:151], v[250:251], v[50:51], v[150:151] op_sel:[1,1,0] op_sel_hi:[0,1,1] neg_lo:[0,1,0]
    v_pk_fma_f32 v[152:153], v[252:253], v[52:53], v[152:153] op_sel:[0,0,0] op_sel_hi:[1,0,1]
    v_pk_fma_f32 v[152:153], v[252:253], v[52:53], v[152:153] op_sel:[1,1,0] op_sel_hi:[0,1,1] neg_lo:[0,1,0]
    v_pk_fma_f32 v[154:155], v[254:255], v[54:55], v[154:155] op_sel:[0,0,0] op_sel_hi:[1,0,1]
    v_pk_fma_f32 v[154:155], v[254:255], v[54:55], v[154:155] op_sel:[1,1,0] op_sel_hi:[0,1,1] neg_lo:[0,1,0]
    v_pk_fma_f32 v[156:157], v[88:89], v[56:57], v[156:157] op_sel:[0,0,0] op_sel_hi:[1,0,1]
    v_pk_fma_f32 v[156:157], v[88:89], v[56:57], v[156:157] op_sel:[1,1,0] op_sel_hi:[0,1,1] neg_lo:[0,1,0]
    v_pk_fma_f32 v[158:159], v[90:91], v[58:59], v[158:159] op_sel:[0,0,0] op_sel_hi:[1,0,1]
    v_pk_fma_f32 v[158:159], v[90:91], v[58:59], v[158:159] op_sel:[1,1,0] op_sel_hi:[0,1,1] neg_lo:[0,1,0]
    ds_read_b64 v[40:41], v28 offset:2080
    ds_read_b64 v[42:43], v28 offset:2144
    ds_read_b64 v[44:45], v28 offset:2208
    ds_read_b64 v[46:47], v28 offset:2272
    ds_read_b64 v[48:49], v28 offset:2336
    ds_read_b64 v[50:51], v28 offset:2400
    ds_read_b64 v[52:53], v28 offset:2464
    ds_read_b64 v[54:55], v28 offset:2528
    ds_read_b64 v[56:57], v29 offset:2080
    ds_read_b64 v[58:59], v29 offset:2144
.p2align 3
    v_mov_b32_dpp v240, v140 row_shr:2 row_mask:0xf bank_mask:0xf bound_ctrl:0
    v_mov_b32_dpp v241, v141 row_shr:2 row_mask:0xf bank_mask:0xf bound_ctrl:0
    v_mov_b32_dpp v242, v142 row_shr:2 row_mask:0xf bank_mask:0xf bound_ctrl:0
    v_mov_b32_dpp v243, v143 row_shr:2 row_mask:0xf bank_mask:0xf bound_ctrl:0
    v_mov_b32_dpp v244, v144 row_shr:2 row_mask:0xf bank_mask:0xf bound_ctrl:0
    v_mov_b32_dpp v245, v145 row_shr:2 row_mask:0xf bank_mask:0xf bound_ctrl:0
    v_mov_b32_dpp v246, v146 row_shr:2 row_mask:0xf bank_mask:0xf bound_ctrl:0
    v_mov_b32_dpp v247, v147 row_shr:2 row_mask:0xf bank_mask:0xf bound_ctrl:0
    v_mov_b32_dpp v248, v148 row_shr:2 row_mask:0xf bank_mask:0xf bound_ctrl:0
    v_mov_b32_dpp v249, v149 row_shr:2 row_mask:0xf bank_mask:0xf bound_ctrl:0
    v_mov_b32_dpp v250, v150 row_shr:2 row_mask:0xf bank_mask:0xf bound_ctrl:0
    v_mov_b32_dpp v251, v151 row_shr:2 row_mask:0xf bank_mask:0xf bound_ctrl:0
    v_mov_b32_dpp v252, v152 row_shr:2 row_mask:0xf bank_mask:0xf bound_ctrl:0
    v_mov_b32_dpp v253, v153 row_shr:2 row_mask:0xf bank_mask:0xf bound_ctrl:0
    v_mov_b32_dpp v254, v154 row_shr:2 row_mask:0xf bank_mask:0xf bound_ctrl:0
    v_mov_b32_dpp v255, v155 row_shr:2 row_mask:0xf bank_mask:0xf bound_ctrl:0
    v_mov_b32_dpp v88, v156 row_shr:2 row_mask:0xf bank_mask:0xf bound_ctrl:0
    v_mov_b32_dpp v89, v157 row_shr:2 row_mask:0xf bank_mask:0xf bound_ctrl:0
    v_mov_b32_dpp v90, v158 row_shr:2 row_mask:0xf bank_mask:0xf bound_ctrl:0
    v_mov_b32_dpp v91, v159 row_shr:2 row_mask:0xf bank_mask:0xf bound_ctrl:0
    s_add_u32 m0, s35, 4096
    s_nop 0
    buffer_load_dwordx4 v24, s[64:67], s43 offen lds
    s_waitcnt lgkmcnt(10)
.p2align 3
    v_pk_fma_f32 v[140:141], v[240:241], v[60:61], v[140:141] op_sel:[0,0,0] op_sel_hi:[1,0,1]
    v_pk_fma_f32 v[140:141], v[240:241], v[60:61], v[140:141] op_sel:[1,1,0] op_sel_hi:[0,1,1] neg_lo:[0,1,0]
    v_pk_fma_f32 v[142:143], v[242:243], v[62:63], v[142:143] op_sel:[0,0,0] op_sel_hi:[1,0,1]
    v_pk_fma_f32 v[142:143], v[242:243], v[62:63], v[142:143] op_sel:[1,1,0] op_sel_hi:[0,1,1] neg_lo:[0,1,0]
    v_pk_fma_f32 v[144:145], v[244:245], v[64:65], v[144:145] op_sel:[0,0,0] op_sel_hi:[1,0,1]
    v_pk_fma_f32 v[144:145], v[244:245], v[64:65], v[144:145] op_sel:[1,1,0] op_sel_hi:[0,1,1] neg_lo:[0,1,0]
    v_pk_fma_f32 v[146:147], v[246:247], v[66:67], v[146:147] op_sel:[0,0,0] op_sel_hi:[1,0,1]
    v_pk_fma_f32 v[146:147], v[246:247], v[66:67], v[146:147] op_sel:[1,1,0] op_sel_hi:[0,1,1] neg_lo:[0,1,0]
    v_pk_fma_f32 v[148:149], v[248:249], v[68:69], v[148:149] op_sel:[0,0,0] op_sel_hi:[1,0,1]
    v_pk_fma_f32 v[148:149], v[248:249], v[68:69], v[148:149] op_sel:[1,1,0] op_sel_hi:[0,1,1] neg_lo:[0,1,0]
    v_pk_fma_f32 v[150:151], v[250:251], v[70:71], v[150:151] op_sel:[0,0,0] op_sel_hi:[1,0,1]
    v_pk_fma_f32 v[150:151], v[250:251], v[70:71], v[150:151] op_sel:[1,1,0] op_sel_hi:[0,1,1] neg_lo:[0,1,0]
    v_pk_fma_f32 v[152:153], v[252:253], v[72:73], v[152:153] op_sel:[0,0,0] op_sel_hi:[1,0,1]
    v_pk_fma_f32 v[152:153], v[252:253], v[72:73], v[152:153] op_sel:[1,1,0] op_sel_hi:[0,1,1] neg_lo:[0,1,0]
    v_pk_fma_f32 v[154:155], v[254:255], v[74:75], v[154:155] op_sel:[0,0,0] op_sel_hi:[1,0,1]
    v_pk_fma_f32 v[154:155], v[254:255], v[74:75], v[154:155] op_sel:[1,1,0] op_sel_hi:[0,1,1] neg_lo:[0,1,0]
    v_pk_fma_f32 v[156:157], v[88:89], v[76:77], v[156:157] op_sel:[0,0,0] op_sel_hi:[1,0,1]
    v_pk_fma_f32 v[156:157], v[88:89], v[76:77], v[156:157] op_sel:[1,1,0] op_sel_hi:[0,1,1] neg_lo:[0,1,0]
    v_pk_fma_f32 v[158:159], v[90:91], v[78:79], v[158:159] op_sel:[0,0,0] op_sel_hi:[1,0,1]
    v_pk_fma_f32 v[158:159], v[90:91], v[78:79], v[158:159] op_sel:[1,1,0] op_sel_hi:[0,1,1] neg_lo:[0,1,0]
    ds_read_b64 v[60:61], v28 offset:2088
    ds_read_b64 v[62:63], v28 offset:2152
    ds_read_b64 v[64:65], v28 offset:2216
    ds_read_b64 v[66:67], v28 offset:2280
    ds_read_b64 v[68:69], v28 offset:2344
    ds_read_b64 v[70:71], v28 offset:2408
    ds_read_b64 v[72:73], v28 offset:2472
    ds_read_b64 v[74:75], v28 offset:2536
    ds_read_b64 v[76:77], v29 offset:2088
    ds_read_b64 v[78:79], v29 offset:2152
.p2align 3
    v_mov_b32_dpp v240, v140 row_shr:4 row_mask:0xf bank_mask:0xf bound_ctrl:0
    v_mov_b32_dpp v241, v141 row_shr:4 row_mask:0xf bank_mask:0xf bound_ctrl:0
    v_mov_b32_dpp v242, v142 row_shr:4 row_mask:0xf bank_mask:0xf bound_ctrl:0
    v_mov_b32_dpp v243, v143 row_shr:4 row_mask:0xf bank_mask:0xf bound_ctrl:0
    v_mov_b32_dpp v244, v144 row_shr:4 row_mask:0xf bank_mask:0xf bound_ctrl:0
    v_mov_b32_dpp v245, v145 row_shr:4 row_mask:0xf bank_mask:0xf bound_ctrl:0
    v_mov_b32_dpp v246, v146 row_shr:4 row_mask:0xf bank_mask:0xf bound_ctrl:0
    v_mov_b32_dpp v247, v147 row_shr:4 row_mask:0xf bank_mask:0xf bound_ctrl:0
    v_mov_b32_dpp v248, v148 row_shr:4 row_mask:0xf bank_mask:0xf bound_ctrl:0
    v_mov_b32_dpp v249, v149 row_shr:4 row_mask:0xf bank_mask:0xf bound_ctrl:0
    v_mov_b32_dpp v250, v150 row_shr:4 row_mask:0xf bank_mask:0xf bound_ctrl:0
    v_mov_b32_dpp v251, v151 row_shr:4 row_mask:0xf bank_mask:0xf bound_ctrl:0
    v_mov_b32_dpp v252, v152 row_shr:4 row_mask:0xf bank_mask:0xf bound_ctrl:0
    v_mov_b32_dpp v253, v153 row_shr:4 row_mask:0xf bank_mask:0xf bound_ctrl:0
    v_mov_b32_dpp v254, v154 row_shr:4 row_mask:0xf bank_mask:0xf bound_ctrl:0
    v_mov_b32_dpp v255, v155 row_shr:4 row_mask:0xf bank_mask:0xf bound_ctrl:0
    v_mov_b32_dpp v88, v156 row_shr:4 row_mask:0xf bank_mask:0xf bound_ctrl:0
    v_mov_b32_dpp v89, v157 row_shr:4 row_mask:0xf bank_mask:0xf bound_ctrl:0
    v_mov_b32_dpp v90, v158 row_shr:4 row_mask:0xf bank_mask:0xf bound_ctrl:0
    v_mov_b32_dpp v91, v159 row_shr:4 row_mask:0xf bank_mask:0xf bound_ctrl:0
    s_waitcnt lgkmcnt(10)
.p2align 3
    v_pk_fma_f32 v[140:141], v[240:241], v[40:41], v[140:141] op_sel:[0,0,0] op_sel_hi:[1,0,1]
    v_pk_fma_f32 v[140:141], v[240:241], v[40:41], v[140:141] op_sel:[1,1,0] op_sel_hi:[0,1,1] neg_lo:[0,1,0]
    v_pk_fma_f32 v[142:143], v[242:243], v[42:43], v[142:143] op_sel:[0,0,0] op_sel_hi:[1,0,1]
    v_pk_fma_f32 v[142:143], v[242:243], v[42:43], v[142:143] op_sel:[1,1,0] op_sel_hi:[0,1,1] neg_lo:[0,1,0]
    v_pk_fma_f32 v[144:145], v[244:245], v[44:45], v[144:145] op_sel:[0,0,0] op_sel_hi:[1,0,1]
    v_pk_fma_f32 v[144:145], v[244:245], v[44:45], v[144:145] op_sel:[1,1,0] op_sel_hi:[0,1,1] neg_lo:[0,1,0]
    v_pk_fma_f32 v[146:147], v[246:247], v[46:47], v[146:147] op_sel:[0,0,0] op_sel_hi:[1,0,1]
    v_pk_fma_f32 v[146:147], v[246:247], v[46:47], v[146:147] op_sel:[1,1,0] op_sel_hi:[0,1,1] neg_lo:[0,1,0]
    v_pk_fma_f32 v[148:149], v[248:249], v[48:49], v[148:149] op_sel:[0,0,0] op_sel_hi:[1,0,1]
    v_pk_fma_f32 v[148:149], v[248:249], v[48:49], v[148:149] op_sel:[1,1,0] op_sel_hi:[0,1,1] neg_lo:[0,1,0]
    v_pk_fma_f32 v[150:151], v[250:251], v[50:51], v[150:151] op_sel:[0,0,0] op_sel_hi:[1,0,1]
    v_pk_fma_f32 v[150:151], v[250:251], v[50:51], v[150:151] op_sel:[1,1,0] op_sel_hi:[0,1,1] neg_lo:[0,1,0]
    v_pk_fma_f32 v[152:153], v[252:253], v[52:53], v[152:153] op_sel:[0,0,0] op_sel_hi:[1,0,1]
    v_pk_fma_f32 v[152:153], v[252:253], v[52:53], v[152:153] op_sel:[1,1,0] op_sel_hi:[0,1,1] neg_lo:[0,1,0]
    v_pk_fma_f32 v[154:155], v[254:255], v[54:55], v[154:155] op_sel:[0,0,0] op_sel_hi:[1,0,1]
    v_pk_fma_f32 v[154:155], v[254:255], v[54:55], v[154:155] op_sel:[1,1,0] op_sel_hi:[0,1,1] neg_lo:[0,1,0]
    v_pk_fma_f32 v[156:157], v[88:89], v[56:57], v[156:157] op_sel:[0,0,0] op_sel_hi:[1,0,1]
    v_pk_fma_f32 v[156:157], v[88:89], v[56:57], v[156:157] op_sel:[1,1,0] op_sel_hi:[0,1,1] neg_lo:[0,1,0]
    v_pk_fma_f32 v[158:159], v[90:91], v[58:59], v[158:159] op_sel:[0,0,0] op_sel_hi:[1,0,1]
    v_pk_fma_f32 v[158:159], v[90:91], v[58:59], v[158:159] op_sel:[1,1,0] op_sel_hi:[0,1,1] neg_lo:[0,1,0]
    ds_read_b64 v[40:41], v30 offset:7168
    ds_read_b64 v[42:43], v30 offset:7296
    ds_read_b64 v[44:45], v30 offset:7424
    ds_read_b64 v[46:47], v30 offset:7552
    ds_read_b64 v[48:49], v30 offset:7680
    ds_read_b64 v[50:51], v30 offset:7808
    ds_read_b64 v[52:53], v30 offset:7936
    ds_read_b64 v[54:55], v30 offset:8064
    ds_read_b64 v[56:57], v31 offset:7168
    ds_read_b64 v[58:59], v31 offset:7296
.p2align 3
    v_mov_b32_dpp v240, v140 row_shr:8 row_mask:0xf bank_mask:0xf bound_ctrl:0
    v_mov_b32_dpp v241, v141 row_shr:8 row_mask:0xf bank_mask:0xf bound_ctrl:0
    v_mov_b32_dpp v242, v142 row_shr:8 row_mask:0xf bank_mask:0xf bound_ctrl:0
    v_mov_b32_dpp v243, v143 row_shr:8 row_mask:0xf bank_mask:0xf bound_ctrl:0
    v_mov_b32_dpp v244, v144 row_shr:8 row_mask:0xf bank_mask:0xf bound_ctrl:0
    v_mov_b32_dpp v245, v145 row_shr:8 row_mask:0xf bank_mask:0xf bound_ctrl:0
    v_mov_b32_dpp v246, v146 row_shr:8 row_mask:0xf bank_mask:0xf bound_ctrl:0
    v_mov_b32_dpp v247, v147 row_shr:8 row_mask:0xf bank_mask:0xf bound_ctrl:0
    v_mov_b32_dpp v248, v148 row_shr:8 row_mask:0xf bank_mask:0xf bound_ctrl:0
    v_mov_b32_dpp v249, v149 row_shr:8 row_mask:0xf bank_mask:0xf bound_ctrl:0
    v_mov_b32_dpp v250, v150 row_shr:8 row_mask:0xf bank_mask:0xf bound_ctrl:0
    v_mov_b32_dpp v251, v151 row_shr:8 row_mask:0xf bank_mask:0xf bound_ctrl:0
    v_mov_b32_dpp v252, v152 row_shr:8 row_mask:0xf bank_mask:0xf bound_ctrl:0
    v_mov_b32_dpp v253, v153 row_shr:8 row_mask:0xf bank_mask:0xf bound_ctrl:0
    v_mov_b32_dpp v254, v154 row_shr:8 row_mask:0xf bank_mask:0xf bound_ctrl:0
    v_mov_b32_dpp v255, v155 row_shr:8 row_mask:0xf bank_mask:0xf bound_ctrl:0
    v_mov_b32_dpp v88, v156 row_shr:8 row_mask:0xf bank_mask:0xf bound_ctrl:0
    v_mov_b32_dpp v89, v157 row_shr:8 row_mask:0xf bank_mask:0xf bound_ctrl:0
    v_mov_b32_dpp v90, v158 row_shr:8 row_mask:0xf bank_mask:0xf bound_ctrl:0
    v_mov_b32_dpp v91, v159 row_shr:8 row_mask:0xf bank_mask:0xf bound_ctrl:0
    s_waitcnt lgkmcnt(10)
.p2align 3
    v_pk_fma_f32 v[140:141], v[240:241], v[60:61], v[140:141] op_sel:[0,0,0] op_sel_hi:[1,0,1]
    v_pk_fma_f32 v[140:141], v[240:241], v[60:61], v[140:141] op_sel:[1,1,0] op_sel_hi:[0,1,1] neg_lo:[0,1,0]
    v_pk_fma_f32 v[142:143], v[242:243], v[62:63], v[142:143] op_sel:[0,0,0] op_sel_hi:[1,0,1]
    v_pk_fma_f32 v[142:143], v[242:243], v[62:63], v[142:143] op_sel:[1,1,0] op_sel_hi:[0,1,1] neg_lo:[0,1,0]
    v_pk_fma_f32 v[144:145], v[244:245], v[64:65], v[144:145] op_sel:[0,0,0] op_sel_hi:[1,0,1]
    v_pk_fma_f32 v[144:145], v[244:245], v[64:65], v[144:145] op_sel:[1,1,0] op_sel_hi:[0,1,1] neg_lo:[0,1,0]
    v_pk_fma_f32 v[146:147], v[246:247], v[66:67], v[146:147] op_sel:[0,0,0] op_sel_hi:[1,0,1]
    v_pk_fma_f32 v[146:147], v[246:247], v[66:67], v[146:147] op_sel:[1,1,0] op_sel_hi:[0,1,1] neg_lo:[0,1,0]
    v_pk_fma_f32 v[148:149], v[248:249], v[68:69], v[148:149] op_sel:[0,0,0] op_sel_hi:[1,0,1]
    v_pk_fma_f32 v[148:149], v[248:249], v[68:69], v[148:149] op_sel:[1,1,0] op_sel_hi:[0,1,1] neg_lo:[0,1,0]
    v_pk_fma_f32 v[150:151], v[250:251], v[70:71], v[150:151] op_sel:[0,0,0] op_sel_hi:[1,0,1]
    v_pk_fma_f32 v[150:151], v[250:251], v[70:71], v[150:151] op_sel:[1,1,0] op_sel_hi:[0,1,1] neg_lo:[0,1,0]
    v_pk_fma_f32 v[152:153], v[252:253], v[72:73], v[152:153] op_sel:[0,0,0] op_sel_hi:[1,0,1]
    v_pk_fma_f32 v[152:153], v[252:253], v[72:73], v[152:153] op_sel:[1,1,0] op_sel_hi:[0,1,1] neg_lo:[0,1,0]
    v_pk_fma_f32 v[154:155], v[254:255], v[74:75], v[154:155] op_sel:[0,0,0] op_sel_hi:[1,0,1]
    v_pk_fma_f32 v[154:155], v[254:255], v[74:75], v[154:155] op_sel:[1,1,0] op_sel_hi:[0,1,1] neg_lo:[0,1,0]
    v_pk_fma_f32 v[156:157], v[88:89], v[76:77], v[156:157] op_sel:[0,0,0] op_sel_hi:[1,0,1]
    v_pk_fma_f32 v[156:157], v[88:89], v[76:77], v[156:157] op_sel:[1,1,0] op_sel_hi:[0,1,1] neg_lo:[0,1,0]
    v_pk_fma_f32 v[158:159], v[90:91], v[78:79], v[158:159] op_sel:[0,0,0] op_sel_hi:[1,0,1]
    v_pk_fma_f32 v[158:159], v[90:91], v[78:79], v[158:159] op_sel:[1,1,0] op_sel_hi:[0,1,1] neg_lo:[0,1,0]
    ds_write_b128 v37, v[140:143] offset:17408
    ds_write_b128 v37, v[144:147] offset:17424
    ds_write_b128 v37, v[148:151] offset:17440
    ds_write_b128 v37, v[152:155] offset:17456
    ds_write_b128 v13, v[156:159] offset:17408
    ds_read_b128 v[64:67], v35 offset:2096
    v_mov_b32 v69, s11
    v_mov_b32 v71, s11
    s_waitcnt lgkmcnt(0)
    s_barrier
    ds_read_b64 v[60:61], v34 offset:17408
    ds_read_b64 v[62:63], v34 offset:18048
    s_waitcnt lgkmcnt(0)
    v_pk_fma_f32 v[62:63], v[60:61], v[64:65], v[62:63] op_sel:[0,0,0] op_sel_hi:[1,0,1]
    v_pk_fma_f32 v[62:63], v[60:61], v[64:65], v[62:63] op_sel:[1,1,0] op_sel_hi:[0,1,1] neg_lo:[0,1,0]
    v_mov_b32 v68, v62
    v_mov_b32 v70, v63
    buffer_store_dwordx4 v[68:71], v36, s[60:63], s86 offen sc1
    s_nop 1
    s_waitcnt vmcnt(1)
    v_mul_u32_u24 v93, 320, v2
    v_lshl_add_u32 v6, v3, 4, v93
    v_lshrrev_b32 v92, 1, v3
    v_mul_u32_u24 v92, 80, v92
    v_add_u32 v93, v93, v92
    v_add_u32 v4, s18, v6
    v_add_u32 v5, s19, v6
    v_add_u32 v6, s35, v6
    v_add_u32 v7, s18, v93
    v_add_u32 v92, s19, v93
    v_add_u32 v93, s35, v93
    ds_read_b128 a[108:111], v4 offset:0
    ds_read_b128 a[112:115], v5 offset:0
    ds_read_b128 a[116:119], v4 offset:36864
    ds_read_b128 a[120:123], v5 offset:20480
    ds_read_b128 a[124:127], v6 offset:0
    ds_read_b128 a[148:151], v4 offset:80
    ds_read_b128 a[152:155], v5 offset:80
    ds_read_b128 a[156:159], v4 offset:36944
    ds_read_b128 a[160:163], v5 offset:20560
    ds_read_b128 a[164:167], v6 offset:80
    ds_read_b128 a[208:211], v4 offset:160
    ds_read_b128 a[212:215], v5 offset:160
    ds_read_b128 a[216:219], v4 offset:37024
    ds_read_b128 a[220:223], v5 offset:20640
    ds_read_b128 a[224:227], v6 offset:160
    ds_read_b128 a[0:3], v4 offset:240
    ds_read_b128 a[4:7], v5 offset:240
    ds_read_b128 a[8:11], v4 offset:37104
    ds_read_b128 a[12:15], v5 offset:20720
    ds_read_b128 a[16:19], v6 offset:240
    s_mov_b32 exec_lo, 0x0000ffff
    s_mov_b32 exec_hi, 0x0000ffff
    ds_read_b128 a[188:191], v7 offset:64
    ds_read_b128 a[192:195], v92 offset:64
    ds_read_b128 a[196:199], v7 offset:36928
    ds_read_b128 a[200:203], v92 offset:20544
    ds_read_b128 a[204:207], v93 offset:64
    ds_read_b128 a[40:43], v7 offset:224
    ds_read_b128 a[44:47], v92 offset:224
    ds_read_b128 a[48:51], v7 offset:37088
    ds_read_b128 a[52:55], v92 offset:20704
    ds_read_b128 a[56:59], v93 offset:224
    s_mov_b64 exec, -1
    v_mov_b32_dpp v240, v140 row_shr:1 row_mask:0xf bank_mask:0xf bound_ctrl:0
    v_mov_b32_dpp v241, v141 row_shr:1 row_mask:0xf bank_mask:0xf bound_ctrl:0
    v_mov_b32_dpp v242, v142 row_shr:1 row_mask:0xf bank_mask:0xf bound_ctrl:0
    v_mov_b32_dpp v243, v143 row_shr:1 row_mask:0xf bank_mask:0xf bound_ctrl:0
    v_mov_b32_dpp v244, v144 row_shr:1 row_mask:0xf bank_mask:0xf bound_ctrl:0
    v_mov_b32_dpp v245, v145 row_shr:1 row_mask:0xf bank_mask:0xf bound_ctrl:0
    v_mov_b32_dpp v246, v146 row_shr:1 row_mask:0xf bank_mask:0xf bound_ctrl:0
    v_mov_b32_dpp v247, v147 row_shr:1 row_mask:0xf bank_mask:0xf bound_ctrl:0
    v_mov_b32_dpp v248, v148 row_shr:1 row_mask:0xf bank_mask:0xf bound_ctrl:0
    v_mov_b32_dpp v249, v149 row_shr:1 row_mask:0xf bank_mask:0xf bound_ctrl:0
    v_mov_b32_dpp v250, v150 row_shr:1 row_mask:0xf bank_mask:0xf bound_ctrl:0
    v_mov_b32_dpp v251, v151 row_shr:1 row_mask:0xf bank_mask:0xf bound_ctrl:0
    v_mov_b32_dpp v252, v152 row_shr:1 row_mask:0xf bank_mask:0xf bound_ctrl:0
    v_mov_b32_dpp v253, v153 row_shr:1 row_mask:0xf bank_mask:0xf bound_ctrl:0
    v_mov_b32_dpp v254, v154 row_shr:1 row_mask:0xf bank_mask:0xf bound_ctrl:0
    v_mov_b32_dpp v255, v155 row_shr:1 row_mask:0xf bank_mask:0xf bound_ctrl:0
    v_mov_b32_dpp v88, v156 row_shr:1 row_mask:0xf bank_mask:0xf bound_ctrl:0
    v_mov_b32_dpp v89, v157 row_shr:1 row_mask:0xf bank_mask:0xf bound_ctrl:0
    v_mov_b32_dpp v90, v158 row_shr:1 row_mask:0xf bank_mask:0xf bound_ctrl:0
    v_mov_b32_dpp v91, v159 row_shr:1 row_mask:0xf bank_mask:0xf bound_ctrl:0
    v_pk_mul_f32 v[140:141], v[240:241], v[102:103] op_sel:[0,0] op_sel_hi:[1,0]
    v_pk_fma_f32 v[240:241], v[240:241], v[102:103], v[140:141] op_sel:[1,1,0] op_sel_hi:[0,1,1] neg_lo:[0,1,0]
    v_pk_mul_f32 v[142:143], v[242:243], v[106:107] op_sel:[0,0] op_sel_hi:[1,0]
    v_pk_fma_f32 v[242:243], v[242:243], v[106:107], v[142:143] op_sel:[1,1,0] op_sel_hi:[0,1,1] neg_lo:[0,1,0]
    v_pk_mul_f32 v[144:145], v[244:245], v[110:111] op_sel:[0,0] op_sel_hi:[1,0]
    v_pk_fma_f32 v[244:245], v[244:245], v[110:111], v[144:145] op_sel:[1,1,0] op_sel_hi:[0,1,1] neg_lo:[0,1,0]
    v_pk_mul_f32 v[146:147], v[246:247], v[114:115] op_sel:[0,0] op_sel_hi:[1,0]
    v_pk_fma_f32 v[246:247], v[246:247], v[114:115], v[146:147] op_sel:[1,1,0] op_sel_hi:[0,1,1] neg_lo:[0,1,0]
    v_pk_mul_f32 v[148:149], v[248:249], v[118:119] op_sel:[0,0] op_sel_hi:[1,0]
    v_pk_fma_f32 v[248:249], v[248:249], v[118:119], v[148:149] op_sel:[1,1,0] op_sel_hi:[0,1,1] neg_lo:[0,1,0]
    v_pk_mul_f32 v[150:151], v[250:251], v[122:123] op_sel:[0,0] op_sel_hi:[1,0]
    v_pk_fma_f32 v[250:251], v[250:251], v[122:123], v[150:151] op_sel:[1,1,0] op_sel_hi:[0,1,1] neg_lo:[0,1,0]
    v_pk_mul_f32 v[152:153], v[252:253], v[126:127] op_sel:[0,0] op_sel_hi:[1,0]
    v_pk_fma_f32 v[252:253], v[252:253], v[126:127], v[152:153] op_sel:[1,1,0] op_sel_hi:[0,1,1] neg_lo:[0,1,0]
    v_pk_mul_f32 v[154:155], v[254:255], v[130:131] op_sel:[0,0] op_sel_hi:[1,0]
    v_pk_fma_f32 v[254:255], v[254:255], v[130:131], v[154:155] op_sel:[1,1,0] op_sel_hi:[0,1,1] neg_lo:[0,1,0]
    v_pk_mul_f32 v[156:157], v[88:89], v[134:135] op_sel:[0,0] op_sel_hi:[1,0]
    v_pk_fma_f32 v[88:89], v[88:89], v[134:135], v[156:157] op_sel:[1,1,0] op_sel_hi:[0,1,1] neg_lo:[0,1,0]
    v_pk_mul_f32 v[158:159], v[90:91], v[138:139] op_sel:[0,0] op_sel_hi:[1,0]
    v_pk_fma_f32 v[90:91], v[90:91], v[138:139], v[158:159] op_sel:[1,1,0] op_sel_hi:[0,1,1] neg_lo:[0,1,0]
    s_waitcnt lgkmcnt(0)
    s_add_u32 s43, s42, 0
    s_add_u32 m0, s18, 0
    s_nop 0
    buffer_load_dwordx4 v20, s[68:71], s43 offen lds
    s_add_u32 m0, s18, 1024
    s_nop 0
    buffer_load_dwordx4 v21, s[68:71], s43 offen lds
.p2align 3
    v_pk_mul_f32 v[140:141], v[40:41], v[102:103] op_sel:[0,0] op_sel_hi:[1,0]
    v_pk_fma_f32 v[40:41], v[40:41], v[102:103], v[140:141] op_sel:[1,1,0] op_sel_hi:[0,1,1] neg_lo:[0,1,0]
    v_pk_mul_f32 v[142:143], v[42:43], v[106:107] op_sel:[0,0] op_sel_hi:[1,0]
    v_pk_fma_f32 v[42:43], v[42:43], v[106:107], v[142:143] op_sel:[1,1,0] op_sel_hi:[0,1,1] neg_lo:[0,1,0]
    v_pk_mul_f32 v[144:145], v[44:45], v[110:111] op_sel:[0,0] op_sel_hi:[1,0]
    v_pk_fma_f32 v[44:45], v[44:45], v[110:111], v[144:145] op_sel:[1,1,0] op_sel_hi:[0,1,1] neg_lo:[0,1,0]
    v_pk_mul_f32 v[146:147], v[46:47], v[114:115] op_sel:[0,0] op_sel_hi:[1,0]
    v_pk_fma_f32 v[46:47], v[46:47], v[114:115], v[146:147] op_sel:[1,1,0] op_sel_hi:[0,1,1] neg_lo:[0,1,0]
    v_pk_mul_f32 v[148:149], v[48:49], v[118:119] op_sel:[0,0] op_sel_hi:[1,0]
    v_pk_fma_f32 v[48:49], v[48:49], v[118:119], v[148:149] op_sel:[1,1,0] op_sel_hi:[0,1,1] neg_lo:[0,1,0]
    v_pk_mul_f32 v[150:151], v[50:51], v[122:123] op_sel:[0,0] op_sel_hi:[1,0]
    v_pk_fma_f32 v[50:51], v[50:51], v[122:123], v[150:151] op_sel:[1,1,0] op_sel_hi:[0,1,1] neg_lo:[0,1,0]
    v_pk_mul_f32 v[152:153], v[52:53], v[126:127] op_sel:[0,0] op_sel_hi:[1,0]
    v_pk_fma_f32 v[52:53], v[52:53], v[126:127], v[152:153] op_sel:[1,1,0] op_sel_hi:[0,1,1] neg_lo:[0,1,0]
    v_pk_mul_f32 v[154:155], v[54:55], v[130:131] op_sel:[0,0] op_sel_hi:[1,0]
    v_pk_fma_f32 v[54:55], v[54:55], v[130:131], v[154:155] op_sel:[1,1,0] op_sel_hi:[0,1,1] neg_lo:[0,1,0]
    v_pk_mul_f32 v[156:157], v[56:57], v[134:135] op_sel:[0,0] op_sel_hi:[1,0]
    v_pk_fma_f32 v[56:57], v[56:57], v[134:135], v[156:157] op_sel:[1,1,0] op_sel_hi:[0,1,1] neg_lo:[0,1,0]
    v_pk_mul_f32 v[158:159], v[58:59], v[138:139] op_sel:[0,0] op_sel_hi:[1,0]
    v_pk_fma_f32 v[58:59], v[58:59], v[138:139], v[158:159] op_sel:[1,1,0] op_sel_hi:[0,1,1] neg_lo:[0,1,0]
    s_add_u32 m0, s18, 2048
    s_nop 0
    buffer_load_dwordx4 v22, s[68:71], s43 offen lds
    s_add_u32 m0, s18, 3072
    s_nop 0
    buffer_load_dwordx4 v23, s[68:71], s43 offen lds
.p2align 3
    v_pk_mul_f32 v[140:141], v[160:161], v[102:103] op_sel:[0,0] op_sel_hi:[1,0]
    v_pk_fma_f32 v[160:161], v[160:161], v[102:103], v[140:141] op_sel:[1,1,0] op_sel_hi:[0,1,1] neg_lo:[0,1,0]
    v_pk_mul_f32 v[142:143], v[164:165], v[102:103] op_sel:[0,0] op_sel_hi:[1,0]
    v_pk_fma_f32 v[164:165], v[164:165], v[102:103], v[142:143] op_sel:[1,1,0] op_sel_hi:[0,1,1] neg_lo:[0,1,0]
    v_pk_mul_f32 v[144:145], v[168:169], v[102:103] op_sel:[0,0] op_sel_hi:[1,0]
    v_pk_fma_f32 v[168:169], v[168:169], v[102:103], v[144:145] op_sel:[1,1,0] op_sel_hi:[0,1,1] neg_lo:[0,1,0]
    v_pk_mul_f32 v[146:147], v[172:173], v[102:103] op_sel:[0,0] op_sel_hi:[1,0]
    v_pk_fma_f32 v[172:173], v[172:173], v[102:103], v[146:147] op_sel:[1,1,0] op_sel_hi:[0,1,1] neg_lo:[0,1,0]
    s_add_u32 m0, s18, 4096
    s_nop 0
    buffer_load_dwordx4 v24, s[68:71], s43 offen lds
    s_add_u32 s43, s42, 20480
    s_add_u32 m0, s19, 0
    s_nop 0
    buffer_load_dwordx4 v20, s[68:71], s43 offen lds
.p2align 3
    v_pk_mul_f32 v[140:141], v[162:163], v[106:107] op_sel:[0,0] op_sel_hi:[1,0]
    v_pk_fma_f32 v[162:163], v[162:163], v[106:107], v[140:141] op_sel:[1,1,0] op_sel_hi:[0,1,1] neg_lo:[0,1,0]
    v_pk_mul_f32 v[142:143], v[166:167], v[106:107] op_sel:[0,0] op_sel_hi:[1,0]
    v_pk_fma_f32 v[166:167], v[166:167], v[106:107], v[142:143] op_sel:[1,1,0] op_sel_hi:[0,1,1] neg_lo:[0,1,0]
    v_pk_mul_f32 v[144:145], v[170:171], v[106:107] op_sel:[0,0] op_sel_hi:[1,0]
    v_pk_fma_f32 v[170:171], v[170:171], v[106:107], v[144:145] op_sel:[1,1,0] op_sel_hi:[0,1,1] neg_lo:[0,1,0]
    v_pk_mul_f32 v[146:147], v[174:175], v[106:107] op_sel:[0,0] op_sel_hi:[1,0]
    v_pk_fma_f32 v[174:175], v[174:175], v[106:107], v[146:147] op_sel:[1,1,0] op_sel_hi:[0,1,1] neg_lo:[0,1,0]
    s_add_u32 m0, s19, 1024
    s_nop 0
    buffer_load_dwordx4 v21, s[68:71], s43 offen lds
    s_add_u32 m0, s19, 2048
    s_nop 0
    buffer_load_dwordx4 v22, s[68:71], s43 offen lds
.p2align 3
    v_pk_mul_f32 v[140:141], v[176:177], v[110:111] op_sel:[0,0] op_sel_hi:[1,0]
    v_pk_fma_f32 v[176:177], v[176:177], v[110:111], v[140:141] op_sel:[1,1,0] op_sel_hi:[0,1,1] neg_lo:[0,1,0]
    v_pk_mul_f32 v[142:143], v[180:181], v[110:111] op_sel:[0,0] op_sel_hi:[1,0]
    v_pk_fma_f32 v[180:181], v[180:181], v[110:111], v[142:143] op_sel:[1,1,0] op_sel_hi:[0,1,1] neg_lo:[0,1,0]
    v_pk_mul_f32 v[144:145], v[184:185], v[110:111] op_sel:[0,0] op_sel_hi:[1,0]
    v_pk_fma_f32 v[184:185], v[184:185], v[110:111], v[144:145] op_sel:[1,1,0] op_sel_hi:[0,1,1] neg_lo:[0,1,0]
    v_pk_mul_f32 v[146:147], v[188:189], v[110:111] op_sel:[0,0] op_sel_hi:[1,0]
    v_pk_fma_f32 v[188:189], v[188:189], v[110:111], v[146:147] op_sel:[1,1,0] op_sel_hi:[0,1,1] neg_lo:[0,1,0]
    s_add_u32 m0, s19, 3072
    s_nop 0
    buffer_load_dwordx4 v23, s[68:71], s43 offen lds
    s_add_u32 m0, s19, 4096
    s_nop 0
    buffer_load_dwordx4 v24, s[68:71], s43 offen lds
.p2align 3
    v_pk_mul_f32 v[140:141], v[178:179], v[114:115] op_sel:[0,0] op_sel_hi:[1,0]
    v_pk_fma_f32 v[178:179], v[178:179], v[114:115], v[140:141] op_sel:[1,1,0] op_sel_hi:[0,1,1] neg_lo:[0,1,0]
    v_pk_mul_f32 v[142:143], v[182:183], v[114:115] op_sel:[0,0] op_sel_hi:[1,0]
    v_pk_fma_f32 v[182:183], v[182:183], v[114:115], v[142:143] op_sel:[1,1,0] op_sel_hi:[0,1,1] neg_lo:[0,1,0]
    v_pk_mul_f32 v[144:145], v[186:187], v[114:115] op_sel:[0,0] op_sel_hi:[1,0]
    v_pk_fma_f32 v[186:187], v[186:187], v[114:115], v[144:145] op_sel:[1,1,0] op_sel_hi:[0,1,1] neg_lo:[0,1,0]
    v_pk_mul_f32 v[146:147], v[190:191], v[114:115] op_sel:[0,0] op_sel_hi:[1,0]
    v_pk_fma_f32 v[190:191], v[190:191], v[114:115], v[146:147] op_sel:[1,1,0] op_sel_hi:[0,1,1] neg_lo:[0,1,0]
    s_add_u32 s43, s42, 40960
    s_add_u32 m0, s20, 0
    s_nop 0
    buffer_load_dwordx4 v20, s[68:71], s43 offen lds
    s_add_u32 m0, s20, 1024
    s_nop 0
    buffer_load_dwordx4 v21, s[68:71], s43 offen lds
.p2align 3
    v_pk_mul_f32 v[140:141], v[192:193], v[118:119] op_sel:[0,0] op_sel_hi:[1,0]
    v_pk_fma_f32 v[192:193], v[192:193], v[118:119], v[140:141] op_sel:[1,1,0] op_sel_hi:[0,1,1] neg_lo:[0,1,0]
    v_pk_mul_f32 v[142:143], v[196:197], v[118:119] op_sel:[0,0] op_sel_hi:[1,0]
    v_pk_fma_f32 v[196:197], v[196:197], v[118:119], v[142:143] op_sel:[1,1,0] op_sel_hi:[0,1,1] neg_lo:[0,1,0]
    v_pk_mul_f32 v[144:145], v[200:201], v[118:119] op_sel:[0,0] op_sel_hi:[1,0]
    v_pk_fma_f32 v[200:201], v[200:201], v[118:119], v[144:145] op_sel:[1,1,0] op_sel_hi:[0,1,1] neg_lo:[0,1,0]
    v_pk_mul_f32 v[146:147], v[204:205], v[118:119] op_sel:[0,0] op_sel_hi:[1,0]
    v_pk_fma_f32 v[204:205], v[204:205], v[118:119], v[146:147] op_sel:[1,1,0] op_sel_hi:[0,1,1] neg_lo:[0,1,0]
    buffer_load_dwordx4 v[68:71], v8, s[60:63], s87 offen sc1
    buffer_load_dwordx4 v[72:75], v9, s[60:63], s87 offen sc1
    buffer_load_dwordx4 v[76:79], v10, s[60:63], s87 offen sc1
    buffer_load_dwordx4 v[80:83], v11, s[60:63], s87 offen sc1
    buffer_load_dwordx4 v[84:87], v12, s[60:63], s87 offen sc1
    s_add_u32 m0, s20, 2048
    s_nop 0
    buffer_load_dwordx4 v22, s[68:71], s43 offen lds
    s_add_u32 m0, s20, 3072
    s_nop 0
    buffer_load_dwordx4 v23, s[68:71], s43 offen lds
.p2align 3
    v_pk_mul_f32 v[140:141], v[194:195], v[122:123] op_sel:[0,0] op_sel_hi:[1,0]
    v_pk_fma_f32 v[194:195], v[194:195], v[122:123], v[140:141] op_sel:[1,1,0] op_sel_hi:[0,1,1] neg_lo:[0,1,0]
    v_pk_mul_f32 v[142:143], v[198:199], v[122:123] op_sel:[0,0] op_sel_hi:[1,0]
    v_pk_fma_f32 v[198:199], v[198:199], v[122:123], v[142:143] op_sel:[1,1,0] op_sel_hi:[0,1,1] neg_lo:[0,1,0]
    v_pk_mul_f32 v[144:145], v[202:203], v[122:123] op_sel:[0,0] op_sel_hi:[1,0]
    v_pk_fma_f32 v[202:203], v[202:203], v[122:123], v[144:145] op_sel:[1,1,0] op_sel_hi:[0,1,1] neg_lo:[0,1,0]
    v_pk_mul_f32 v[146:147], v[206:207], v[122:123] op_sel:[0,0] op_sel_hi:[1,0]
    v_pk_fma_f32 v[206:207], v[206:207], v[122:123], v[146:147] op_sel:[1,1,0] op_sel_hi:[0,1,1] neg_lo:[0,1,0]
    s_add_u32 m0, s20, 4096
    s_nop 0
    buffer_load_dwordx4 v24, s[68:71], s43 offen lds
    s_add_u32 s43, s42, 61440
    s_add_u32 m0, s21, 0
    s_nop 0
    buffer_load_dwordx4 v20, s[68:71], s43 offen lds
.p2align 3
    v_pk_mul_f32 v[140:141], v[208:209], v[126:127] op_sel:[0,0] op_sel_hi:[1,0]
    v_pk_fma_f32 v[208:209], v[208:209], v[126:127], v[140:141] op_sel:[1,1,0] op_sel_hi:[0,1,1] neg_lo:[0,1,0]
    v_pk_mul_f32 v[142:143], v[212:213], v[126:127] op_sel:[0,0] op_sel_hi:[1,0]
    v_pk_fma_f32 v[212:213], v[212:213], v[126:127], v[142:143] op_sel:[1,1,0] op_sel_hi:[0,1,1] neg_lo:[0,1,0]
    v_pk_mul_f32 v[144:145], v[216:217], v[126:127] op_sel:[0,0] op_sel_hi:[1,0]
    v_pk_fma_f32 v[216:217], v[216:217], v[126:127], v[144:145] op_sel:[1,1,0] op_sel_hi:[0,1,1] neg_lo:[0,1,0]
    v_pk_mul_f32 v[146:147], v[220:221], v[126:127] op_sel:[0,0] op_sel_hi:[1,0]
    v_pk_fma_f32 v[220:221], v[220:221], v[126:127], v[146:147] op_sel:[1,1,0] op_sel_hi:[0,1,1] neg_lo:[0,1,0]
    s_add_u32 m0, s21, 1024
    s_nop 0
    buffer_load_dwordx4 v21, s[68:71], s43 offen lds
    s_add_u32 m0, s21, 2048
    s_nop 0
    buffer_load_dwordx4 v22, s[68:71], s43 offen lds
.p2align 3
    v_pk_mul_f32 v[140:141], v[210:211], v[130:131] op_sel:[0,0] op_sel_hi:[1,0]
    v_pk_fma_f32 v[210:211], v[210:211], v[130:131], v[140:141] op_sel:[1,1,0] op_sel_hi:[0,1,1] neg_lo:[0,1,0]
    v_pk_mul_f32 v[142:143], v[214:215], v[130:131] op_sel:[0,0] op_sel_hi:[1,0]
    v_pk_fma_f32 v[214:215], v[214:215], v[130:131], v[142:143] op_sel:[1,1,0] op_sel_hi:[0,1,1] neg_lo:[0,1,0]
    v_pk_mul_f32 v[144:145], v[218:219], v[130:131] op_sel:[0,0] op_sel_hi:[1,0]
    v_pk_fma_f32 v[218:219], v[218:219], v[130:131], v[144:145] op_sel:[1,1,0] op_sel_hi:[0,1,1] neg_lo:[0,1,0]
    v_pk_mul_f32 v[146:147], v[222:223], v[130:131] op_sel:[0,0] op_sel_hi:[1,0]
    v_pk_fma_f32 v[222:223], v[222:223], v[130:131], v[146:147] op_sel:[1,1,0] op_sel_hi:[0,1,1] neg_lo:[0,1,0]
    s_add_u32 m0, s21, 3072
    s_nop 0
    buffer_load_dwordx4 v23, s[68:71], s43 offen lds
    s_add_u32 m0, s21, 4096
    s_nop 0
    buffer_load_dwordx4 v24, s[68:71], s43 offen lds
.p2align 3
    v_pk_mul_f32 v[140:141], v[224:225], v[134:135] op_sel:[0,0] op_sel_hi:[1,0]
    v_pk_fma_f32 v[224:225], v[224:225], v[134:135], v[140:141] op_sel:[1,1,0] op_sel_hi:[0,1,1] neg_lo:[0,1,0]
    v_pk_mul_f32 v[142:143], v[228:229], v[134:135] op_sel:[0,0] op_sel_hi:[1,0]
    v_pk_fma_f32 v[228:229], v[228:229], v[134:135], v[142:143] op_sel:[1,1,0] op_sel_hi:[0,1,1] neg_lo:[0,1,0]
    v_pk_mul_f32 v[144:145], v[232:233], v[134:135] op_sel:[0,0] op_sel_hi:[1,0]
    v_pk_fma_f32 v[232:233], v[232:233], v[134:135], v[144:145] op_sel:[1,1,0] op_sel_hi:[0,1,1] neg_lo:[0,1,0]
    v_pk_mul_f32 v[146:147], v[236:237], v[134:135] op_sel:[0,0] op_sel_hi:[1,0]
    v_pk_fma_f32 v[236:237], v[236:237], v[134:135], v[146:147] op_sel:[1,1,0] op_sel_hi:[0,1,1] neg_lo:[0,1,0]
    s_add_u32 s43, s42, 81920
    s_add_u32 m0, s35, 0
    s_nop 0
    buffer_load_dwordx4 v20, s[68:71], s43 offen lds
    s_add_u32 m0, s35, 1024
    s_nop 0
    buffer_load_dwordx4 v21, s[68:71], s43 offen lds
.p2align 3
    v_pk_mul_f32 v[140:141], v[226:227], v[138:139] op_sel:[0,0] op_sel_hi:[1,0]
    v_pk_fma_f32 v[226:227], v[226:227], v[138:139], v[140:141] op_sel:[1,1,0] op_sel_hi:[0,1,1] neg_lo:[0,1,0]
    v_pk_mul_f32 v[142:143], v[230:231], v[138:139] op_sel:[0,0] op_sel_hi:[1,0]
    v_pk_fma_f32 v[230:231], v[230:231], v[138:139], v[142:143] op_sel:[1,1,0] op_sel_hi:[0,1,1] neg_lo:[0,1,0]
    v_pk_mul_f32 v[144:145], v[234:235], v[138:139] op_sel:[0,0] op_sel_hi:[1,0]
    v_pk_fma_f32 v[234:235], v[234:235], v[138:139], v[144:145] op_sel:[1,1,0] op_sel_hi:[0,1,1] neg_lo:[0,1,0]
    v_pk_mul_f32 v[146:147], v[238:239], v[138:139] op_sel:[0,0] op_sel_hi:[1,0]
    v_pk_fma_f32 v[238:239], v[238:239], v[138:139], v[146:147] op_sel:[1,1,0] op_sel_hi:[0,1,1] neg_lo:[0,1,0]
    s_add_u32 m0, s35, 2048
    s_nop 0
    buffer_load_dwordx4 v22, s[68:71], s43 offen lds
    s_add_u32 m0, s35, 3072
    s_nop 0
    buffer_load_dwordx4 v23, s[68:71], s43 offen lds
    s_add_u32 m0, s35, 4096
    s_nop 0
    buffer_load_dwordx4 v24, s[68:71], s43 offen lds
.p2align 3
    v_pk_mul_f32 v[16:17], v[66:67], v[66:67] op_sel:[0,0] op_sel_hi:[1,0]
    v_pk_fma_f32 v[14:15], v[66:67], v[66:67], v[16:17] op_sel:[1,1,0] op_sel_hi:[0,1,1] neg_lo:[0,1,0]
    v_pk_mul_f32 v[16:17], v[14:15], v[14:15] op_sel:[0,0] op_sel_hi:[1,0]
    v_pk_fma_f32 v[14:15], v[14:15], v[14:15], v[16:17] op_sel:[1,1,0] op_sel_hi:[0,1,1] neg_lo:[0,1,0]
    v_pk_mul_f32 v[16:17], v[14:15], v[66:67] op_sel:[0,0] op_sel_hi:[1,0]
    v_pk_fma_f32 v[14:15], v[14:15], v[66:67], v[16:17] op_sel:[1,1,0] op_sel_hi:[0,1,1] neg_lo:[0,1,0]
    v_pk_mul_f32 v[16:17], v[14:15], v[14:15] op_sel:[0,0] op_sel_hi:[1,0]
    v_pk_fma_f32 v[18:19], v[14:15], v[14:15], v[16:17] op_sel:[1,1,0] op_sel_hi:[0,1,1] neg_lo:[0,1,0]
    v_cmp_eq_u32 vcc, 2, v39
    v_mov_b32 v16, 1.0
    v_mov_b32 v17, 0
    v_cndmask_b32 v14, v14, v18, vcc
    v_cndmask_b32 v15, v15, v19, vcc
    v_cmp_eq_u32 vcc, 0, v39
    v_mul_u32_u24 v18, 640, v39
    v_add_u32 v34, v34, v18
    v_cndmask_b32 v14, v14, v16, vcc
    v_cndmask_b32 v15, v15, v17, vcc
    v_cndmask_b32 v60, v17, v60, vcc
    v_cndmask_b32 v61, v17, v61, vcc
    s_mul_i32 s12, s5, 1280
    v_add_u32 v32, s12, v32
    v_add_u32 v33, s12, v33
    s_mul_i32 s86, s6, 720896
    s_lshl_b32 s12, s5, 11
    s_add_u32 s86, s86, s12
    s_add_u32 s86, s86, 4096
    s_lshr_b32 s12, s7, 1
    s_mul_i32 s12, s12, 22
    s_and_b32 s13, s7, 1
    s_mul_i32 s13, s13, 5
    s_add_u32 s12, s12, s13
    s_add_u32 s12, s12, 12
    s_lshl_b32 s12, s12, 12
    s_add_u32 s86, s86, s12
    s_add_u32 s76, s86, 16384
    s_lshl_b32 s12, s4, 9
    s_add_u32 s76, s76, s12
    v_lshrrev_b32 v27, 1, v3
    v_lshlrev_b32 v27, 10, v27
    v_and_b32 v98, 31, v1
    v_lshl_add_u32 v27, v98, 4, v27
    s_lshl_b32 s12, s4, 13
    s_add_u32 s86, s86, s12
    s_add_u32 s75, s86, 4096
    s_waitcnt vmcnt(13)
L_carry_chk:
    s_mov_b64 s[84:85], 0
    v_cmp_ne_u32 vcc, s11, v69
    v_cmp_ne_u32 s[12:13], s11, v71
    s_or_b64 vcc, vcc, s[12:13]
    s_and_b64 vcc, vcc, s[28:29]
    s_or_b64 s[84:85], s[84:85], vcc
    v_cmp_ne_u32 vcc, s11, v73
    v_cmp_ne_u32 s[12:13], s11, v75
    s_or_b64 vcc, vcc, s[12:13]
    s_and_b64 vcc, vcc, s[30:31]
    s_or_b64 s[84:85], s[84:85], vcc
    v_cmp_ne_u32 vcc, s11, v77
    v_cmp_ne_u32 s[12:13], s11, v79
    s_or_b64 vcc, vcc, s[12:13]
    s_and_b64 vcc, vcc, s[36:37]
    s_or_b64 s[84:85], s[84:85], vcc
    v_cmp_ne_u32 vcc, s11, v81
    v_cmp_ne_u32 s[12:13], s11, v83
    s_or_b64 vcc, vcc, s[12:13]
    s_and_b64 vcc, vcc, s[38:39]
    s_or_b64 s[84:85], s[84:85], vcc
    v_cmp_ne_u32 vcc, s11, v85
    v_cmp_ne_u32 s[12:13], s11, v87
    s_or_b64 vcc, vcc, s[12:13]
    s_and_b64 vcc, vcc, s[40:41]
    s_or_b64 s[84:85], s[84:85], vcc
    s_cmp_eq_u64 s[84:85], 0
    s_cbranch_scc1 L_carry_done
    s_sub_u32 s81, s81, 1
    s_cbranch_scc1 L_end
    buffer_load_dwordx4 v[68:71], v8, s[60:63], s87 offen sc1
    buffer_load_dwordx4 v[72:75], v9, s[60:63], s87 offen sc1
    buffer_load_dwordx4 v[76:79], v10, s[60:63], s87 offen sc1
    buffer_load_dwordx4 v[80:83], v11, s[60:63], s87 offen sc1
    buffer_load_dwordx4 v[84:87], v12, s[60:63], s87 offen sc1
    s_waitcnt vmcnt(0)
    s_branch L_carry_chk
L_carry_done:
    v_mov_b32 v69, v70
    v_mov_b32 v73, v74
    v_mov_b32 v77, v78
    v_mov_b32 v81, v82
    v_mov_b32 v85, v86
    v_pk_fma_f32 v[80:81], v[84:85], v[66:67], v[80:81] op_sel:[0,0,0] op_sel_hi:[1,0,1]
    v_pk_fma_f32 v[80:81], v[84:85], v[66:67], v[80:81] op_sel:[1,1,0] op_sel_hi:[0,1,1] neg_lo:[0,1,0]
    v_pk_fma_f32 v[76:77], v[80:81], v[66:67], v[76:77] op_sel:[0,0,0] op_sel_hi:[1,0,1]
    v_pk_fma_f32 v[76:77], v[80:81], v[66:67], v[76:77] op_sel:[1,1,0] op_sel_hi:[0,1,1] neg_lo:[0,1,0]
    v_pk_fma_f32 v[72:73], v[76:77], v[66:67], v[72:73] op_sel:[0,0,0] op_sel_hi:[1,0,1]
    v_pk_fma_f32 v[72:73], v[76:77], v[66:67], v[72:73] op_sel:[1,1,0] op_sel_hi:[0,1,1] neg_lo:[0,1,0]
    v_pk_fma_f32 v[68:69], v[72:73], v[66:67], v[68:69] op_sel:[0,0,0] op_sel_hi:[1,0,1]
    v_pk_fma_f32 v[68:69], v[72:73], v[66:67], v[68:69] op_sel:[1,1,0] op_sel_hi:[0,1,1] neg_lo:[0,1,0]
    v_pk_mul_f32 v[16:17], v[68:69], v[14:15] op_sel:[0,0] op_sel_hi:[1,0]
    v_pk_fma_f32 v[68:69], v[68:69], v[14:15], v[16:17] op_sel:[1,1,0] op_sel_hi:[0,1,1] neg_lo:[0,1,0]
    v_pk_fma_f32 v[60:61], v[68:69], v[64:65], v[60:61] op_sel:[0,0,0] op_sel_hi:[1,0,1]
    v_pk_fma_f32 v[60:61], v[68:69], v[64:65], v[60:61] op_sel:[1,1,0] op_sel_hi:[0,1,1] neg_lo:[0,1,0]
    ds_write_b64 v34, v[68:69] offset:7168
    ds_write_b64 v34, v[60:61] offset:9088
    s_waitcnt lgkmcnt(0)
    s_barrier
    s_lshl_b32 s12, s4, 6
    s_add_u32 s12, s12, s5
    s_lshl_b32 s13, s88, 1
    s_add_u32 s12, s12, s13
    s_lshl_b32 s13, s6, 7
    s_add_u32 s13, s13, s12
    s_mul_i32 s72, s13, 1280
    s_mul_i32 s13, s7, 160
    s_add_u32 s72, s72, s13
    s_lshl_b32 s12, s12, 4
    v_lshrrev_b32 v94, 2, v1
    v_and_b32 v39, 3, v1
    v_lshlrev_b32 v95, 3, v39
    v_mul_u32_u24 v38, 5120, v94
    v_add_u32 v38, v38, v95
    v_bfe_u32 v30, v94, 1, 2
    v_xor_b32 v39, v39, v30
    v_lshlrev_b32 v39, 4, v39
    s_movk_i32 s13, 320
    v_mad_u32_u24 v39, v94, s13, v39
    v_lshlrev_b32 v94, 6, v94
    v_add_u32 v94, s12, v94
    buffer_load_dwordx2 v[80:81], v38, s[52:55], s72 offen offset:0
    buffer_load_dwordx2 v[82:83], v38, s[52:55], s72 offen offset:32
    buffer_load_dwordx2 v[84:85], v38, s[52:55], s72 offen offset:64
    buffer_load_dwordx2 v[86:87], v38, s[52:55], s72 offen offset:96
    buffer_load_dwordx2 v[92:93], v38, s[52:55], s72 offen offset:128
    ds_read_b128 v[140:143], v32 offset:7168
    ds_read_b128 v[60:63], v32 offset:7808
    ds_read_b128 v[4:7], v32 offset:8448
    ds_read_b128 v[144:147], v32 offset:7184
    ds_read_b128 v[64:67], v32 offset:7824
    ds_read_b128 v[8:11], v32 offset:8464
    ds_read_b128 v[148:151], v32 offset:7200
    ds_read_b128 v[68:71], v32 offset:7840
    ds_read_b128 v[12:15], v32 offset:8480
    ds_read_b128 v[152:155], v32 offset:7216
    ds_read_b128 v[72:75], v32 offset:7856
    ds_read_b128 v[16:19], v32 offset:8496
    ds_read_b128 v[156:159], v33 offset:7168
    ds_read_b128 v[76:79], v33 offset:7808
    ds_read_b128 v[96:99], v33 offset:8448
.p2align 3
    s_waitcnt lgkmcnt(12)
.p2align 3
    v_pk_add_f32 v[140:141], v[140:141], v[60:61]
    v_pk_add_f32 v[140:141], v[140:141], v[4:5]
    v_pk_fma_f32 v[240:241], v[140:141], v[40:41], v[240:241] op_sel:[0,0,0] op_sel_hi:[1,0,1]
    v_pk_fma_f32 v[240:241], v[140:141], v[40:41], v[240:241] op_sel:[1,1,0] op_sel_hi:[0,1,1] neg_lo:[0,1,0]
    v_pk_add_f32 v[142:143], v[142:143], v[62:63]
    v_pk_add_f32 v[142:143], v[142:143], v[6:7]
    v_pk_fma_f32 v[242:243], v[142:143], v[42:43], v[242:243] op_sel:[0,0,0] op_sel_hi:[1,0,1]
    v_pk_fma_f32 v[242:243], v[142:143], v[42:43], v[242:243] op_sel:[1,1,0] op_sel_hi:[0,1,1] neg_lo:[0,1,0]
    s_waitcnt lgkmcnt(9)
.p2align 3
    v_pk_add_f32 v[144:145], v[144:145], v[64:65]
    v_pk_add_f32 v[144:145], v[144:145], v[8:9]
    v_pk_fma_f32 v[244:245], v[144:145], v[44:45], v[244:245] op_sel:[0,0,0] op_sel_hi:[1,0,1]
    v_pk_fma_f32 v[244:245], v[144:145], v[44:45], v[244:245] op_sel:[1,1,0] op_sel_hi:[0,1,1] neg_lo:[0,1,0]
    v_pk_add_f32 v[146:147], v[146:147], v[66:67]
    v_pk_add_f32 v[146:147], v[146:147], v[10:11]
    v_pk_fma_f32 v[246:247], v[146:147], v[46:47], v[246:247] op_sel:[0,0,0] op_sel_hi:[1,0,1]
    v_pk_fma_f32 v[246:247], v[146:147], v[46:47], v[246:247] op_sel:[1,1,0] op_sel_hi:[0,1,1] neg_lo:[0,1,0]
    s_waitcnt lgkmcnt(6)
.p2align 3
    v_pk_add_f32 v[148:149], v[148:149], v[68:69]
    v_pk_add_f32 v[148:149], v[148:149], v[12:13]
    v_pk_fma_f32 v[248:249], v[148:149], v[48:49], v[248:249] op_sel:[0,0,0] op_sel_hi:[1,0,1]
    v_pk_fma_f32 v[248:249], v[148:149], v[48:49], v[248:249] op_sel:[1,1,0] op_sel_hi:[0,1,1] neg_lo:[0,1,0]
    v_pk_add_f32 v[150:151], v[150:151], v[70:71]
    v_pk_add_f32 v[150:151], v[150:151], v[14:15]
    v_pk_fma_f32 v[250:251], v[150:151], v[50:51], v[250:251] op_sel:[0,0,0] op_sel_hi:[1,0,1]
    v_pk_fma_f32 v[250:251], v[150:151], v[50:51], v[250:251] op_sel:[1,1,0] op_sel_hi:[0,1,1] neg_lo:[0,1,0]
    s_waitcnt lgkmcnt(3)
.p2align 3
    v_pk_add_f32 v[152:153], v[152:153], v[72:73]
    v_pk_add_f32 v[152:153], v[152:153], v[16:17]
    v_pk_fma_f32 v[252:253], v[152:153], v[52:53], v[252:253] op_sel:[0,0,0] op_sel_hi:[1,0,1]
    v_pk_fma_f32 v[252:253], v[152:153], v[52:53], v[252:253] op_sel:[1,1,0] op_sel_hi:[0,1,1] neg_lo:[0,1,0]
    v_pk_add_f32 v[154:155], v[154:155], v[74:75]
    v_pk_add_f32 v[154:155], v[154:155], v[18:19]
    v_pk_fma_f32 v[254:255], v[154:155], v[54:55], v[254:255] op_sel:[0,0,0] op_sel_hi:[1,0,1]
    v_pk_fma_f32 v[254:255], v[154:155], v[54:55], v[254:255] op_sel:[1,1,0] op_sel_hi:[0,1,1] neg_lo:[0,1,0]
    s_waitcnt lgkmcnt(0)
.p2align 3
    v_pk_add_f32 v[156:157], v[156:157], v[76:77]
    v_pk_add_f32 v[156:157], v[156:157], v[96:97]
    v_pk_fma_f32 v[88:89], v[156:157], v[56:57], v[88:89] op_sel:[0,0,0] op_sel_hi:[1,0,1]
    v_pk_fma_f32 v[88:89], v[156:157], v[56:57], v[88:89] op_sel:[1,1,0] op_sel_hi:[0,1,1] neg_lo:[0,1,0]
    v_pk_add_f32 v[158:159], v[158:159], v[78:79]
    v_pk_add_f32 v[158:159], v[158:159], v[98:99]
    v_pk_fma_f32 v[90:91], v[158:159], v[58:59], v[90:91] op_sel:[0,0,0] op_sel_hi:[1,0,1]
    v_pk_fma_f32 v[90:91], v[158:159], v[58:59], v[90:91] op_sel:[1,1,0] op_sel_hi:[0,1,1] neg_lo:[0,1,0]
.p2align 3
    v_pk_fma_f32 v[160:161], v[240:241], v[100:101], v[160:161] op_sel:[0,0,0] op_sel_hi:[1,0,1]
    v_pk_fma_f32 v[160:161], v[240:241], v[100:101], v[160:161] op_sel:[1,1,0] op_sel_hi:[0,1,1] neg_lo:[0,1,0]
    v_pk_fma_f32 v[162:163], v[242:243], v[104:105], v[162:163] op_sel:[0,0,0] op_sel_hi:[1,0,1]
    v_pk_fma_f32 v[162:163], v[242:243], v[104:105], v[162:163] op_sel:[1,1,0] op_sel_hi:[0,1,1] neg_lo:[0,1,0]
    v_pk_fma_f32 v[176:177], v[244:245], v[108:109], v[176:177] op_sel:[0,0,0] op_sel_hi:[1,0,1]
    v_pk_fma_f32 v[176:177], v[244:245], v[108:109], v[176:177] op_sel:[1,1,0] op_sel_hi:[0,1,1] neg_lo:[0,1,0]
    v_pk_fma_f32 v[178:179], v[246:247], v[112:113], v[178:179] op_sel:[0,0,0] op_sel_hi:[1,0,1]
    v_pk_fma_f32 v[178:179], v[246:247], v[112:113], v[178:179] op_sel:[1,1,0] op_sel_hi:[0,1,1] neg_lo:[0,1,0]
    v_pk_fma_f32 v[192:193], v[248:249], v[116:117], v[192:193] op_sel:[0,0,0] op_sel_hi:[1,0,1]
    v_pk_fma_f32 v[192:193], v[248:249], v[116:117], v[192:193] op_sel:[1,1,0] op_sel_hi:[0,1,1] neg_lo:[0,1,0]
    v_pk_fma_f32 v[194:195], v[250:251], v[120:121], v[194:195] op_sel:[0,0,0] op_sel_hi:[1,0,1]
    v_pk_fma_f32 v[194:195], v[250:251], v[120:121], v[194:195] op_sel:[1,1,0] op_sel_hi:[0,1,1] neg_lo:[0,1,0]
    v_pk_fma_f32 v[208:209], v[252:253], v[124:125], v[208:209] op_sel:[0,0,0] op_sel_hi:[1,0,1]
    v_pk_fma_f32 v[208:209], v[252:253], v[124:125], v[208:209] op_sel:[1,1,0] op_sel_hi:[0,1,1] neg_lo:[0,1,0]
    v_pk_fma_f32 v[210:211], v[254:255], v[128:129], v[210:211] op_sel:[0,0,0] op_sel_hi:[1,0,1]
    v_pk_fma_f32 v[210:211], v[254:255], v[128:129], v[210:211] op_sel:[1,1,0] op_sel_hi:[0,1,1] neg_lo:[0,1,0]
    v_pk_fma_f32 v[224:225], v[88:89], v[132:133], v[224:225] op_sel:[0,0,0] op_sel_hi:[1,0,1]
    v_pk_fma_f32 v[224:225], v[88:89], v[132:133], v[224:225] op_sel:[1,1,0] op_sel_hi:[0,1,1] neg_lo:[0,1,0]
    v_pk_fma_f32 v[226:227], v[90:91], v[136:137], v[226:227] op_sel:[0,0,0] op_sel_hi:[1,0,1]
    v_pk_fma_f32 v[226:227], v[90:91], v[136:137], v[226:227] op_sel:[1,1,0] op_sel_hi:[0,1,1] neg_lo:[0,1,0]
    v_cvt_pk_bf16_f32 v60, v160, v162
    v_cvt_pk_bf16_f32 v61, v176, v178
    v_cvt_pk_bf16_f32 v62, v192, v194
    v_cvt_pk_bf16_f32 v63, v208, v210
    v_cvt_pk_bf16_f32 v64, -v161, -v163
    v_cvt_pk_bf16_f32 v65, -v177, -v179
    v_cvt_pk_bf16_f32 v66, -v193, -v195
    v_cvt_pk_bf16_f32 v67, -v209, -v211
    v_cvt_pk_bf16_f32 v76, v224, v226
    v_cvt_pk_bf16_f32 v77, -v225, -v227
    buffer_store_dwordx4 v[60:63], v26, s[60:63], s86 offen offset:0 sc1
    buffer_store_dwordx4 v[64:67], v26, s[60:63], s75 offen offset:0 sc1
.p2align 3
    v_pk_fma_f32 v[164:165], v[160:161], v[100:101], v[164:165] op_sel:[0,0,0] op_sel_hi:[1,0,1]
    v_pk_fma_f32 v[164:165], v[160:161], v[100:101], v[164:165] op_sel:[1,1,0] op_sel_hi:[0,1,1] neg_lo:[0,1,0]
    v_pk_fma_f32 v[166:167], v[162:163], v[104:105], v[166:167] op_sel:[0,0,0] op_sel_hi:[1,0,1]
    v_pk_fma_f32 v[166:167], v[162:163], v[104:105], v[166:167] op_sel:[1,1,0] op_sel_hi:[0,1,1] neg_lo:[0,1,0]
    v_pk_fma_f32 v[180:181], v[176:177], v[108:109], v[180:181] op_sel:[0,0,0] op_sel_hi:[1,0,1]
    v_pk_fma_f32 v[180:181], v[176:177], v[108:109], v[180:181] op_sel:[1,1,0] op_sel_hi:[0,1,1] neg_lo:[0,1,0]
    v_pk_fma_f32 v[182:183], v[178:179], v[112:113], v[182:183] op_sel:[0,0,0] op_sel_hi:[1,0,1]
    v_pk_fma_f32 v[182:183], v[178:179], v[112:113], v[182:183] op_sel:[1,1,0] op_sel_hi:[0,1,1] neg_lo:[0,1,0]
    v_pk_fma_f32 v[196:197], v[192:193], v[116:117], v[196:197] op_sel:[0,0,0] op_sel_hi:[1,0,1]
    v_pk_fma_f32 v[196:197], v[192:193], v[116:117], v[196:197] op_sel:[1,1,0] op_sel_hi:[0,1,1] neg_lo:[0,1,0]
    v_pk_fma_f32 v[198:199], v[194:195], v[120:121], v[198:199] op_sel:[0,0,0] op_sel_hi:[1,0,1]
    v_pk_fma_f32 v[198:199], v[194:195], v[120:121], v[198:199] op_sel:[1,1,0] op_sel_hi:[0,1,1] neg_lo:[0,1,0]
    v_pk_fma_f32 v[212:213], v[208:209], v[124:125], v[212:213] op_sel:[0,0,0] op_sel_hi:[1,0,1]
    v_pk_fma_f32 v[212:213], v[208:209], v[124:125], v[212:213] op_sel:[1,1,0] op_sel_hi:[0,1,1] neg_lo:[0,1,0]
    v_pk_fma_f32 v[214:215], v[210:211], v[128:129], v[214:215] op_sel:[0,0,0] op_sel_hi:[1,0,1]
    v_pk_fma_f32 v[214:215], v[210:211], v[128:129], v[214:215] op_sel:[1,1,0] op_sel_hi:[0,1,1] neg_lo:[0,1,0]
    v_pk_fma_f32 v[228:229], v[224:225], v[132:133], v[228:229] op_sel:[0,0,0] op_sel_hi:[1,0,1]
    v_pk_fma_f32 v[228:229], v[224:225], v[132:133], v[228:229] op_sel:[1,1,0] op_sel_hi:[0,1,1] neg_lo:[0,1,0]
    v_pk_fma_f32 v[230:231], v[226:227], v[136:137], v[230:231] op_sel:[0,0,0] op_sel_hi:[1,0,1]
    v_pk_fma_f32 v[230:231], v[226:227], v[136:137], v[230:231] op_sel:[1,1,0] op_sel_hi:[0,1,1] neg_lo:[0,1,0]
    v_cvt_pk_bf16_f32 v68, v164, v166
    v_cvt_pk_bf16_f32 v69, v180, v182
    v_cvt_pk_bf16_f32 v70, v196, v198
    v_cvt_pk_bf16_f32 v71, v212, v214
    v_cvt_pk_bf16_f32 v72, -v165, -v167
    v_cvt_pk_bf16_f32 v73, -v181, -v183
    v_cvt_pk_bf16_f32 v74, -v197, -v199
    v_cvt_pk_bf16_f32 v75, -v213, -v215
    v_cvt_pk_bf16_f32 v78, v228, v230
    v_cvt_pk_bf16_f32 v79, -v229, -v231
    buffer_store_dwordx4 v[68:71], v26, s[60:63], s86 offen offset:1024 sc1
    buffer_store_dwordx4 v[72:75], v26, s[60:63], s75 offen offset:1024 sc1
    s_nop 1
    v_permlane32_swap_b32 v76, v78
    v_permlane32_swap_b32 v77, v79
    s_nop 1
    v_permlane16_swap_b32 v76, v77
    v_permlane16_swap_b32 v78, v79
    buffer_store_dwordx4 v[76:79], v27, s[60:63], s76 offen sc1
    s_add_u32 s86, s86, 360448
    s_add_u32 s75, s75, 360448
    s_add_u32 s76, s76, 360448
.p2align 3
    v_pk_fma_f32 v[168:169], v[164:165], v[100:101], v[168:169] op_sel:[0,0,0] op_sel_hi:[1,0,1]
    v_pk_fma_f32 v[168:169], v[164:165], v[100:101], v[168:169] op_sel:[1,1,0] op_sel_hi:[0,1,1] neg_lo:[0,1,0]
    v_pk_fma_f32 v[170:171], v[166:167], v[104:105], v[170:171] op_sel:[0,0,0] op_sel_hi:[1,0,1]
    v_pk_fma_f32 v[170:171], v[166:167], v[104:105], v[170:171] op_sel:[1,1,0] op_sel_hi:[0,1,1] neg_lo:[0,1,0]
    v_pk_fma_f32 v[184:185], v[180:181], v[108:109], v[184:185] op_sel:[0,0,0] op_sel_hi:[1,0,1]
    v_pk_fma_f32 v[184:185], v[180:181], v[108:109], v[184:185] op_sel:[1,1,0] op_sel_hi:[0,1,1] neg_lo:[0,1,0]
    v_pk_fma_f32 v[186:187], v[182:183], v[112:113], v[186:187] op_sel:[0,0,0] op_sel_hi:[1,0,1]
    v_pk_fma_f32 v[186:187], v[182:183], v[112:113], v[186:187] op_sel:[1,1,0] op_sel_hi:[0,1,1] neg_lo:[0,1,0]
    v_pk_fma_f32 v[200:201], v[196:197], v[116:117], v[200:201] op_sel:[0,0,0] op_sel_hi:[1,0,1]
    v_pk_fma_f32 v[200:201], v[196:197], v[116:117], v[200:201] op_sel:[1,1,0] op_sel_hi:[0,1,1] neg_lo:[0,1,0]
    v_pk_fma_f32 v[202:203], v[198:199], v[120:121], v[202:203] op_sel:[0,0,0] op_sel_hi:[1,0,1]
    v_pk_fma_f32 v[202:203], v[198:199], v[120:121], v[202:203] op_sel:[1,1,0] op_sel_hi:[0,1,1] neg_lo:[0,1,0]
    v_pk_fma_f32 v[216:217], v[212:213], v[124:125], v[216:217] op_sel:[0,0,0] op_sel_hi:[1,0,1]
    v_pk_fma_f32 v[216:217], v[212:213], v[124:125], v[216:217] op_sel:[1,1,0] op_sel_hi:[0,1,1] neg_lo:[0,1,0]
    v_pk_fma_f32 v[218:219], v[214:215], v[128:129], v[218:219] op_sel:[0,0,0] op_sel_hi:[1,0,1]
    v_pk_fma_f32 v[218:219], v[214:215], v[128:129], v[218:219] op_sel:[1,1,0] op_sel_hi:[0,1,1] neg_lo:[0,1,0]
    v_pk_fma_f32 v[232:233], v[228:229], v[132:133], v[232:233] op_sel:[0,0,0] op_sel_hi:[1,0,1]
    v_pk_fma_f32 v[232:233], v[228:229], v[132:133], v[232:233] op_sel:[1,1,0] op_sel_hi:[0,1,1] neg_lo:[0,1,0]
    v_pk_fma_f32 v[234:235], v[230:231], v[136:137], v[234:235] op_sel:[0,0,0] op_sel_hi:[1,0,1]
    v_pk_fma_f32 v[234:235], v[230:231], v[136:137], v[234:235] op_sel:[1,1,0] op_sel_hi:[0,1,1] neg_lo:[0,1,0]
    v_cvt_pk_bf16_f32 v40, v168, v170
    v_cvt_pk_bf16_f32 v41, v184, v186
    v_cvt_pk_bf16_f32 v42, v200, v202
    v_cvt_pk_bf16_f32 v43, v216, v218
    v_cvt_pk_bf16_f32 v44, -v169, -v171
    v_cvt_pk_bf16_f32 v45, -v185, -v187
    v_cvt_pk_bf16_f32 v46, -v201, -v203
    v_cvt_pk_bf16_f32 v47, -v217, -v219
    v_cvt_pk_bf16_f32 v56, v232, v234
    v_cvt_pk_bf16_f32 v57, -v233, -v235
    buffer_store_dwordx4 v[40:43], v26, s[60:63], s86 offen offset:0 sc1
    buffer_store_dwordx4 v[44:47], v26, s[60:63], s75 offen offset:0 sc1
.p2align 3
    v_pk_fma_f32 v[172:173], v[168:169], v[100:101], v[172:173] op_sel:[0,0,0] op_sel_hi:[1,0,1]
    v_pk_fma_f32 v[172:173], v[168:169], v[100:101], v[172:173] op_sel:[1,1,0] op_sel_hi:[0,1,1] neg_lo:[0,1,0]
    v_pk_fma_f32 v[174:175], v[170:171], v[104:105], v[174:175] op_sel:[0,0,0] op_sel_hi:[1,0,1]
    v_pk_fma_f32 v[174:175], v[170:171], v[104:105], v[174:175] op_sel:[1,1,0] op_sel_hi:[0,1,1] neg_lo:[0,1,0]
    v_pk_fma_f32 v[188:189], v[184:185], v[108:109], v[188:189] op_sel:[0,0,0] op_sel_hi:[1,0,1]
    v_pk_fma_f32 v[188:189], v[184:185], v[108:109], v[188:189] op_sel:[1,1,0] op_sel_hi:[0,1,1] neg_lo:[0,1,0]
    v_pk_fma_f32 v[190:191], v[186:187], v[112:113], v[190:191] op_sel:[0,0,0] op_sel_hi:[1,0,1]
    v_pk_fma_f32 v[190:191], v[186:187], v[112:113], v[190:191] op_sel:[1,1,0] op_sel_hi:[0,1,1] neg_lo:[0,1,0]
    v_pk_fma_f32 v[204:205], v[200:201], v[116:117], v[204:205] op_sel:[0,0,0] op_sel_hi:[1,0,1]
    v_pk_fma_f32 v[204:205], v[200:201], v[116:117], v[204:205] op_sel:[1,1,0] op_sel_hi:[0,1,1] neg_lo:[0,1,0]
    v_pk_fma_f32 v[206:207], v[202:203], v[120:121], v[206:207] op_sel:[0,0,0] op_sel_hi:[1,0,1]
    v_pk_fma_f32 v[206:207], v[202:203], v[120:121], v[206:207] op_sel:[1,1,0] op_sel_hi:[0,1,1] neg_lo:[0,1,0]
    v_pk_fma_f32 v[220:221], v[216:217], v[124:125], v[220:221] op_sel:[0,0,0] op_sel_hi:[1,0,1]
    v_pk_fma_f32 v[220:221], v[216:217], v[124:125], v[220:221] op_sel:[1,1,0] op_sel_hi:[0,1,1] neg_lo:[0,1,0]
    v_pk_fma_f32 v[222:223], v[218:219], v[128:129], v[222:223] op_sel:[0,0,0] op_sel_hi:[1,0,1]
    v_pk_fma_f32 v[222:223], v[218:219], v[128:129], v[222:223] op_sel:[1,1,0] op_sel_hi:[0,1,1] neg_lo:[0,1,0]
    v_pk_fma_f32 v[236:237], v[232:233], v[132:133], v[236:237] op_sel:[0,0,0] op_sel_hi:[1,0,1]
    v_pk_fma_f32 v[236:237], v[232:233], v[132:133], v[236:237] op_sel:[1,1,0] op_sel_hi:[0,1,1] neg_lo:[0,1,0]
    v_pk_fma_f32 v[238:239], v[234:235], v[136:137], v[238:239] op_sel:[0,0,0] op_sel_hi:[1,0,1]
    v_pk_fma_f32 v[238:239], v[234:235], v[136:137], v[238:239] op_sel:[1,1,0] op_sel_hi:[0,1,1] neg_lo:[0,1,0]
    v_cvt_pk_bf16_f32 v48, v172, v174
    v_cvt_pk_bf16_f32 v49, v188, v190
    v_cvt_pk_bf16_f32 v50, v204, v206
    v_cvt_pk_bf16_f32 v51, v220, v222
    v_cvt_pk_bf16_f32 v52, -v173, -v175
    v_cvt_pk_bf16_f32 v53, -v189, -v191
    v_cvt_pk_bf16_f32 v54, -v205, -v207
    v_cvt_pk_bf16_f32 v55, -v221, -v223
    v_cvt_pk_bf16_f32 v58, v236, v238
    v_cvt_pk_bf16_f32 v59, -v237, -v239
    buffer_store_dwordx4 v[48:51], v26, s[60:63], s86 offen offset:1024 sc1
    buffer_store_dwordx4 v[52:55], v26, s[60:63], s75 offen offset:1024 sc1
    s_nop 1
    v_permlane32_swap_b32 v56, v58
    v_permlane32_swap_b32 v57, v59
    s_nop 1
    v_permlane16_swap_b32 v56, v57
    v_permlane16_swap_b32 v58, v59
    buffer_store_dwordx4 v[56:59], v27, s[60:63], s76 offen sc1
    s_lshl_b32 s12, s6, 4
    s_lshl_b32 s13, s8, 3
    s_add_u32 s12, s12, s13
    s_lshl_b32 s13, s3, 1
    s_add_u32 s13, s12, s13
    s_lshl_b32 s13, s13, 7
    s_lshl_b32 s15, s8, 5
    s_add_u32 s15, s15, 17891328
    s_add_u32 s32, s13, s15
    s_xor_b32 s33, s32, 32
    s_add_u32 s12, s12, s7
    s_lshl_b32 s12, s12, 7
    s_lshl_b32 s13, s3, 3
    s_add_u32 s12, s12, s13
    s_add_u32 s74, s12, s15
    s_mov_b32 s74, s74
    s_xor_b32 s73, s74, 32
    s_mov_b32 s84, s11
    s_mov_b32 s85, s11
    v_mov_b32 v36, s11
    v_mov_b32 v37, s11
    v_lshlrev_b32 v24, 26, v1
    s_xor_b32 s12, s3, 0
    s_lshl_b32 s12, s12, 10
    v_add_u32 v32, s12, v26
    s_xor_b32 s12, s3, 1
    s_lshl_b32 s12, s12, 10
    v_add_u32 v33, s12, v26
    s_xor_b32 s12, s3, 2
    s_lshl_b32 s12, s12, 10
    v_add_u32 v34, s12, v26
    s_xor_b32 s12, s3, 3
    s_lshl_b32 s12, s12, 10
    v_add_u32 v35, s12, v26
    s_waitcnt vmcnt(15)
    v_mul_u32_u24 v155, 320, v2
    v_lshl_add_u32 v152, v3, 4, v155
    v_lshrrev_b32 v154, 1, v3
    v_mul_u32_u24 v154, 80, v154
    v_add_u32 v155, v155, v154
    v_add_u32 v150, s18, v152
    v_add_u32 v151, s19, v152
    v_add_u32 v152, s35, v152
    v_add_u32 v153, s18, v155
    v_add_u32 v154, s19, v155
    v_add_u32 v155, s35, v155
    ds_read_b128 a[128:131], v150 offset:0
    ds_read_b128 a[132:135], v151 offset:0
    ds_read_b128 a[136:139], v150 offset:36864
    ds_read_b128 a[140:143], v151 offset:20480
    ds_read_b128 a[144:147], v152 offset:0
    ds_read_b128 a[168:171], v150 offset:80
    ds_read_b128 a[172:175], v151 offset:80
    ds_read_b128 a[176:179], v150 offset:36944
    ds_read_b128 a[180:183], v151 offset:20560
    ds_read_b128 a[184:187], v152 offset:80
    ds_read_b128 a[228:231], v150 offset:160
    ds_read_b128 a[232:235], v151 offset:160
    ds_read_b128 a[236:239], v150 offset:37024
    ds_read_b128 a[240:243], v151 offset:20640
    ds_read_b128 a[244:247], v152 offset:160
    ds_read_b128 a[20:23], v150 offset:240
    ds_read_b128 a[24:27], v151 offset:240
    ds_read_b128 a[28:31], v150 offset:37104
    ds_read_b128 a[32:35], v151 offset:20720
    ds_read_b128 a[36:39], v152 offset:240
    s_mov_b32 exec_lo, 0xffff0000
    s_mov_b32 exec_hi, 0xffff0000
    ds_read_b128 a[188:191], v153 offset:64
    ds_read_b128 a[192:195], v154 offset:64
    ds_read_b128 a[196:199], v153 offset:36928
    ds_read_b128 a[200:203], v154 offset:20544
    ds_read_b128 a[204:207], v155 offset:64
    ds_read_b128 a[40:43], v153 offset:224
    ds_read_b128 a[44:47], v154 offset:224
    ds_read_b128 a[48:51], v153 offset:37088
    ds_read_b128 a[52:55], v154 offset:20704
    ds_read_b128 a[56:59], v155 offset:224
    s_mov_b64 exec, -1
    s_waitcnt vmcnt(5)
    buffer_store_dwordx2 v[36:37], v24, s[60:63], s74 offen sc1
    ds_read_b64 v[120:121], v94 offset:0
    ds_read_b64 v[100:101], v95 offset:20160
    ds_read_b64 v[102:103], v95 offset:20192
    ds_read_b64 v[104:105], v95 offset:20224
    ds_read_b64 v[106:107], v95 offset:20256
    ds_read_b64 v[108:109], v95 offset:20288
    ds_read_b64 v[110:111], v95 offset:20320
    ds_read_b64 v[112:113], v95 offset:20352
    ds_read_b64 v[114:115], v95 offset:20384
    ds_read_b64 v[116:117], v95 offset:20416
    ds_read_b64 v[118:119], v95 offset:20448
    s_waitcnt lgkmcnt(0)
    v_lshlrev_b32 v122, 16, v80
    v_and_b32 v123, 0xffff0000, v80
    v_lshlrev_b32 v124, 16, v81
    v_and_b32 v125, 0xffff0000, v81
    v_lshlrev_b32 v126, 16, v100
    v_and_b32 v127, 0xffff0000, v100
    v_lshlrev_b32 v128, 16, v101
    v_and_b32 v129, 0xffff0000, v101
    v_lshlrev_b32 v130, 16, v110
    v_and_b32 v131, 0xffff0000, v110
    v_lshlrev_b32 v132, 16, v111
    v_and_b32 v133, 0xffff0000, v111
    v_pk_add_f32 v[4:5], v[122:123], v[120:121] op_sel:[0,0] op_sel_hi:[1,0] neg_lo:[0,1] neg_hi:[0,1]
    v_pk_add_f32 v[6:7], v[124:125], v[120:121] op_sel:[0,0] op_sel_hi:[1,0] neg_lo:[0,1] neg_hi:[0,1]
    v_cvt_pk_bf16_f32 v5, v4, v5
    v_cvt_pk_bf16_f32 v7, v6, v7
    v_lshlrev_b32 v4, 16, v5
    v_and_b32 v5, 0xffff0000, v5
    v_lshlrev_b32 v6, 16, v7
    v_and_b32 v7, 0xffff0000, v7
    v_pk_mul_f32 v[4:5], v[4:5], v[120:121] op_sel:[0,1] op_sel_hi:[1,1]
    v_pk_mul_f32 v[6:7], v[6:7], v[120:121] op_sel:[0,1] op_sel_hi:[1,1]
    v_cvt_pk_bf16_f32 v5, v4, v5
    v_cvt_pk_bf16_f32 v7, v6, v7
    v_lshlrev_b32 v4, 16, v5
    v_and_b32 v5, 0xffff0000, v5
    v_lshlrev_b32 v6, 16, v7
    v_and_b32 v7, 0xffff0000, v7
    v_pk_mul_f32 v[4:5], v[4:5], v[126:127]
    v_pk_mul_f32 v[6:7], v[6:7], v[128:129]
    v_cvt_pk_bf16_f32 v5, v4, v5
    v_cvt_pk_bf16_f32 v7, v6, v7
    v_lshlrev_b32 v4, 16, v5
    v_and_b32 v5, 0xffff0000, v5
    v_lshlrev_b32 v6, 16, v7
    v_and_b32 v7, 0xffff0000, v7
    v_pk_add_f32 v[4:5], v[4:5], v[122:123]
    v_pk_add_f32 v[6:7], v[6:7], v[124:125]
    v_pk_add_f32 v[4:5], v[4:5], v[130:131]
    v_pk_add_f32 v[6:7], v[6:7], v[132:133]
    v_lshlrev_b32 v122, 16, v82
    v_and_b32 v123, 0xffff0000, v82
    v_lshlrev_b32 v124, 16, v83
    v_and_b32 v125, 0xffff0000, v83
    v_lshlrev_b32 v126, 16, v102
    v_and_b32 v127, 0xffff0000, v102
    v_lshlrev_b32 v128, 16, v103
    v_and_b32 v129, 0xffff0000, v103
    v_lshlrev_b32 v130, 16, v112
    v_and_b32 v131, 0xffff0000, v112
    v_lshlrev_b32 v132, 16, v113
    v_and_b32 v133, 0xffff0000, v113
    v_pk_add_f32 v[8:9], v[122:123], v[120:121] op_sel:[0,0] op_sel_hi:[1,0] neg_lo:[0,1] neg_hi:[0,1]
    v_pk_add_f32 v[10:11], v[124:125], v[120:121] op_sel:[0,0] op_sel_hi:[1,0] neg_lo:[0,1] neg_hi:[0,1]
    v_cvt_pk_bf16_f32 v9, v8, v9
    v_cvt_pk_bf16_f32 v11, v10, v11
    v_lshlrev_b32 v8, 16, v9
    v_and_b32 v9, 0xffff0000, v9
    v_lshlrev_b32 v10, 16, v11
    v_and_b32 v11, 0xffff0000, v11
    v_pk_mul_f32 v[8:9], v[8:9], v[120:121] op_sel:[0,1] op_sel_hi:[1,1]
    v_pk_mul_f32 v[10:11], v[10:11], v[120:121] op_sel:[0,1] op_sel_hi:[1,1]
    v_cvt_pk_bf16_f32 v9, v8, v9
    v_cvt_pk_bf16_f32 v11, v10, v11
    v_lshlrev_b32 v8, 16, v9
    v_and_b32 v9, 0xffff0000, v9
    v_lshlrev_b32 v10, 16, v11
    v_and_b32 v11, 0xffff0000, v11
    v_pk_mul_f32 v[8:9], v[8:9], v[126:127]
    v_pk_mul_f32 v[10:11], v[10:11], v[128:129]
    v_cvt_pk_bf16_f32 v9, v8, v9
    v_cvt_pk_bf16_f32 v11, v10, v11
    v_lshlrev_b32 v8, 16, v9
    v_and_b32 v9, 0xffff0000, v9
    v_lshlrev_b32 v10, 16, v11
    v_and_b32 v11, 0xffff0000, v11
    v_pk_add_f32 v[8:9], v[8:9], v[122:123]
    v_pk_add_f32 v[10:11], v[10:11], v[124:125]
    v_pk_add_f32 v[8:9], v[8:9], v[130:131]
    v_pk_add_f32 v[10:11], v[10:11], v[132:133]
    v_lshlrev_b32 v122, 16, v84
    v_and_b32 v123, 0xffff0000, v84
    v_lshlrev_b32 v124, 16, v85
    v_and_b32 v125, 0xffff0000, v85
    v_lshlrev_b32 v126, 16, v104
    v_and_b32 v127, 0xffff0000, v104
    v_lshlrev_b32 v128, 16, v105
    v_and_b32 v129, 0xffff0000, v105
    v_lshlrev_b32 v130, 16, v114
    v_and_b32 v131, 0xffff0000, v114
    v_lshlrev_b32 v132, 16, v115
    v_and_b32 v133, 0xffff0000, v115
    v_pk_add_f32 v[12:13], v[122:123], v[120:121] op_sel:[0,0] op_sel_hi:[1,0] neg_lo:[0,1] neg_hi:[0,1]
    v_pk_add_f32 v[14:15], v[124:125], v[120:121] op_sel:[0,0] op_sel_hi:[1,0] neg_lo:[0,1] neg_hi:[0,1]
    v_cvt_pk_bf16_f32 v13, v12, v13
    v_cvt_pk_bf16_f32 v15, v14, v15
    v_lshlrev_b32 v12, 16, v13
    v_and_b32 v13, 0xffff0000, v13
    v_lshlrev_b32 v14, 16, v15
    v_and_b32 v15, 0xffff0000, v15
    v_pk_mul_f32 v[12:13], v[12:13], v[120:121] op_sel:[0,1] op_sel_hi:[1,1]
    v_pk_mul_f32 v[14:15], v[14:15], v[120:121] op_sel:[0,1] op_sel_hi:[1,1]
    v_cvt_pk_bf16_f32 v13, v12, v13
    v_cvt_pk_bf16_f32 v15, v14, v15
    v_lshlrev_b32 v12, 16, v13
    v_and_b32 v13, 0xffff0000, v13
    v_lshlrev_b32 v14, 16, v15
    v_and_b32 v15, 0xffff0000, v15
    v_pk_mul_f32 v[12:13], v[12:13], v[126:127]
    v_pk_mul_f32 v[14:15], v[14:15], v[128:129]
    v_cvt_pk_bf16_f32 v13, v12, v13
    v_cvt_pk_bf16_f32 v15, v14, v15
    v_lshlrev_b32 v12, 16, v13
    v_and_b32 v13, 0xffff0000, v13
    v_lshlrev_b32 v14, 16, v15
    v_and_b32 v15, 0xffff0000, v15
    v_pk_add_f32 v[12:13], v[12:13], v[122:123]
    v_pk_add_f32 v[14:15], v[14:15], v[124:125]
    v_pk_add_f32 v[12:13], v[12:13], v[130:131]
    v_pk_add_f32 v[14:15], v[14:15], v[132:133]
    v_lshlrev_b32 v122, 16, v86
    v_and_b32 v123, 0xffff0000, v86
    v_lshlrev_b32 v124, 16, v87
    v_and_b32 v125, 0xffff0000, v87
    v_lshlrev_b32 v126, 16, v106
    v_and_b32 v127, 0xffff0000, v106
    v_lshlrev_b32 v128, 16, v107
    v_and_b32 v129, 0xffff0000, v107
    v_lshlrev_b32 v130, 16, v116
    v_and_b32 v131, 0xffff0000, v116
    v_lshlrev_b32 v132, 16, v117
    v_and_b32 v133, 0xffff0000, v117
    v_pk_add_f32 v[16:17], v[122:123], v[120:121] op_sel:[0,0] op_sel_hi:[1,0] neg_lo:[0,1] neg_hi:[0,1]
    v_pk_add_f32 v[18:19], v[124:125], v[120:121] op_sel:[0,0] op_sel_hi:[1,0] neg_lo:[0,1] neg_hi:[0,1]
    v_cvt_pk_bf16_f32 v17, v16, v17
    v_cvt_pk_bf16_f32 v19, v18, v19
    v_lshlrev_b32 v16, 16, v17
    v_and_b32 v17, 0xffff0000, v17
    v_lshlrev_b32 v18, 16, v19
    v_and_b32 v19, 0xffff0000, v19
    v_pk_mul_f32 v[16:17], v[16:17], v[120:121] op_sel:[0,1] op_sel_hi:[1,1]
    v_pk_mul_f32 v[18:19], v[18:19], v[120:121] op_sel:[0,1] op_sel_hi:[1,1]
    v_cvt_pk_bf16_f32 v17, v16, v17
    v_cvt_pk_bf16_f32 v19, v18, v19
    v_lshlrev_b32 v16, 16, v17
    v_and_b32 v17, 0xffff0000, v17
    v_lshlrev_b32 v18, 16, v19
    v_and_b32 v19, 0xffff0000, v19
    v_pk_mul_f32 v[16:17], v[16:17], v[126:127]
    v_pk_mul_f32 v[18:19], v[18:19], v[128:129]
    v_cvt_pk_bf16_f32 v17, v16, v17
    v_cvt_pk_bf16_f32 v19, v18, v19
    v_lshlrev_b32 v16, 16, v17
    v_and_b32 v17, 0xffff0000, v17
    v_lshlrev_b32 v18, 16, v19
    v_and_b32 v19, 0xffff0000, v19
    v_pk_add_f32 v[16:17], v[16:17], v[122:123]
    v_pk_add_f32 v[18:19], v[18:19], v[124:125]
    v_pk_add_f32 v[16:17], v[16:17], v[130:131]
    v_pk_add_f32 v[18:19], v[18:19], v[132:133]
    v_lshlrev_b32 v122, 16, v92
    v_and_b32 v123, 0xffff0000, v92
    v_lshlrev_b32 v124, 16, v93
    v_and_b32 v125, 0xffff0000, v93
    v_lshlrev_b32 v126, 16, v108
    v_and_b32 v127, 0xffff0000, v108
    v_lshlrev_b32 v128, 16, v109
    v_and_b32 v129, 0xffff0000, v109
    v_lshlrev_b32 v130, 16, v118
    v_and_b32 v131, 0xffff0000, v118
    v_lshlrev_b32 v132, 16, v119
    v_and_b32 v133, 0xffff0000, v119
    v_pk_add_f32 v[20:21], v[122:123], v[120:121] op_sel:[0,0] op_sel_hi:[1,0] neg_lo:[0,1] neg_hi:[0,1]
    v_pk_add_f32 v[22:23], v[124:125], v[120:121] op_sel:[0,0] op_sel_hi:[1,0] neg_lo:[0,1] neg_hi:[0,1]
    v_cvt_pk_bf16_f32 v21, v20, v21
    v_cvt_pk_bf16_f32 v23, v22, v23
    v_lshlrev_b32 v20, 16, v21
    v_and_b32 v21, 0xffff0000, v21
    v_lshlrev_b32 v22, 16, v23
    v_and_b32 v23, 0xffff0000, v23
    v_pk_mul_f32 v[20:21], v[20:21], v[120:121] op_sel:[0,1] op_sel_hi:[1,1]
    v_pk_mul_f32 v[22:23], v[22:23], v[120:121] op_sel:[0,1] op_sel_hi:[1,1]
    v_cvt_pk_bf16_f32 v21, v20, v21
    v_cvt_pk_bf16_f32 v23, v22, v23
    v_lshlrev_b32 v20, 16, v21
    v_and_b32 v21, 0xffff0000, v21
    v_lshlrev_b32 v22, 16, v23
    v_and_b32 v23, 0xffff0000, v23
    v_pk_mul_f32 v[20:21], v[20:21], v[126:127]
    v_pk_mul_f32 v[22:23], v[22:23], v[128:129]
    v_cvt_pk_bf16_f32 v21, v20, v21
    v_cvt_pk_bf16_f32 v23, v22, v23
    v_lshlrev_b32 v20, 16, v21
    v_and_b32 v21, 0xffff0000, v21
    v_lshlrev_b32 v22, 16, v23
    v_and_b32 v23, 0xffff0000, v23
    v_pk_add_f32 v[20:21], v[20:21], v[122:123]
    v_pk_add_f32 v[22:23], v[22:23], v[124:125]
    v_pk_add_f32 v[20:21], v[20:21], v[130:131]
    v_pk_add_f32 v[22:23], v[22:23], v[132:133]
    s_add_u32 s12, s32, 128
    s_load_dwordx8 s[36:43], s[48:49], s32 glc
    s_load_dwordx8 s[64:71], s[48:49], s12 glc
    s_waitcnt lgkmcnt(0)
    s_cmp_eq_u64 s[36:37], s[84:85]
    s_cbranch_scc0 L_sslow
    s_cmp_eq_u64 s[38:39], s[84:85]
    s_cbranch_scc0 L_sslow
    s_cmp_eq_u64 s[40:41], s[84:85]
    s_cbranch_scc0 L_sslow
    s_cmp_eq_u64 s[42:43], s[84:85]
    s_cbranch_scc0 L_sslow
    s_cmp_eq_u64 s[64:65], s[84:85]
    s_cbranch_scc0 L_sslow
    s_cmp_eq_u64 s[66:67], s[84:85]
    s_cbranch_scc0 L_sslow
    s_cmp_eq_u64 s[68:69], s[84:85]
    s_cbranch_scc0 L_sslow
    s_cmp_eq_u64 s[70:71], s[84:85]
    s_cbranch_scc0 L_sslow
    s_cmp_gt_u32 s26, 0
    s_cselect_b32 s15, s22, s23
    s_add_u32 s15, s15, 0
    buffer_load_dwordx4 v[40:43], v32, s[60:63], s15 offen sc1
    buffer_load_dwordx4 v[44:47], v33, s[60:63], s15 offen sc1
    buffer_load_dwordx4 v[48:51], v34, s[60:63], s15 offen sc1
    buffer_load_dwordx4 v[52:55], v35, s[60:63], s15 offen sc1
    s_cmp_gt_u32 s26, 1
    s_cselect_b32 s15, s22, s23
    s_add_u32 s15, s15, 4096
    buffer_load_dwordx4 v[56:59], v32, s[60:63], s15 offen sc1
    buffer_load_dwordx4 v[60:63], v33, s[60:63], s15 offen sc1
    buffer_load_dwordx4 v[64:67], v34, s[60:63], s15 offen sc1
    buffer_load_dwordx4 v[68:71], v35, s[60:63], s15 offen sc1
    s_cmp_gt_u32 s26, 2
    s_cselect_b32 s15, s22, s23
    s_add_u32 s15, s15, 8192
    buffer_load_dwordx4 v[72:75], v32, s[60:63], s15 offen sc1
    buffer_load_dwordx4 v[76:79], v33, s[60:63], s15 offen sc1
    buffer_load_dwordx4 v[80:83], v34, s[60:63], s15 offen sc1
    buffer_load_dwordx4 v[84:87], v35, s[60:63], s15 offen sc1
    s_cmp_gt_u32 s26, 3
    s_cselect_b32 s15, s22, s23
    s_add_u32 s15, s15, 12288
    buffer_load_dwordx4 a[100:103], v32, s[60:63], s15 offen sc1
    buffer_load_dwordx4 a[104:107], v33, s[60:63], s15 offen sc1
    buffer_load_dwordx4 a[248:251], v34, s[60:63], s15 offen sc1
    buffer_load_dwordx4 a[252:255], v35, s[60:63], s15 offen sc1
    s_waitcnt vmcnt(17)
    buffer_store_dwordx2 v[36:37], v24, s[60:63], s73 offen sc1
    s_branch L_sjoin
L_sslow:
    s_add_u32 s12, s32, 128
    s_load_dwordx8 s[36:43], s[48:49], s32 glc
    s_load_dwordx8 s[64:71], s[48:49], s12 glc
    s_waitcnt vmcnt(1)
    buffer_store_dwordx2 v[36:37], v24, s[60:63], s73 offen sc1
    s_branch L_sc1_hmssm
L_sc0_hmssm:
    s_sub_u32 s81, s81, 1
    s_cbranch_scc1 L_end
    s_add_u32 s12, s32, 128
    s_load_dwordx8 s[36:43], s[48:49], s32 glc
    s_load_dwordx8 s[64:71], s[48:49], s12 glc
L_sc1_hmssm:
    s_waitcnt lgkmcnt(0)
    s_cmp_eq_u64 s[36:37], s[84:85]
    s_cbranch_scc0 L_sc0_hmssm
    s_cmp_eq_u64 s[38:39], s[84:85]
    s_cbranch_scc0 L_sc0_hmssm
    s_cmp_eq_u64 s[40:41], s[84:85]
    s_cbranch_scc0 L_sc0_hmssm
    s_cmp_eq_u64 s[42:43], s[84:85]
    s_cbranch_scc0 L_sc0_hmssm
    s_cmp_eq_u64 s[64:65], s[84:85]
    s_cbranch_scc0 L_sc0_hmssm
    s_cmp_eq_u64 s[66:67], s[84:85]
    s_cbranch_scc0 L_sc0_hmssm
    s_cmp_eq_u64 s[68:69], s[84:85]
    s_cbranch_scc0 L_sc0_hmssm
    s_cmp_eq_u64 s[70:71], s[84:85]
    s_cbranch_scc0 L_sc0_hmssm
    s_cmp_gt_u32 s26, 0
    s_cselect_b32 s15, s22, s23
    s_add_u32 s15, s15, 0
    buffer_load_dwordx4 v[40:43], v32, s[60:63], s15 offen sc1
    buffer_load_dwordx4 v[44:47], v33, s[60:63], s15 offen sc1
    buffer_load_dwordx4 v[48:51], v34, s[60:63], s15 offen sc1
    buffer_load_dwordx4 v[52:55], v35, s[60:63], s15 offen sc1
    s_cmp_gt_u32 s26, 1
    s_cselect_b32 s15, s22, s23
    s_add_u32 s15, s15, 4096
    buffer_load_dwordx4 v[56:59], v32, s[60:63], s15 offen sc1
    buffer_load_dwordx4 v[60:63], v33, s[60:63], s15 offen sc1
    buffer_load_dwordx4 v[64:67], v34, s[60:63], s15 offen sc1
    buffer_load_dwordx4 v[68:71], v35, s[60:63], s15 offen sc1
    s_cmp_gt_u32 s26, 2
    s_cselect_b32 s15, s22, s23
    s_add_u32 s15, s15, 8192
    buffer_load_dwordx4 v[72:75], v32, s[60:63], s15 offen sc1
    buffer_load_dwordx4 v[76:79], v33, s[60:63], s15 offen sc1
    buffer_load_dwordx4 v[80:83], v34, s[60:63], s15 offen sc1
    buffer_load_dwordx4 v[84:87], v35, s[60:63], s15 offen sc1
    s_cmp_gt_u32 s26, 3
    s_cselect_b32 s15, s22, s23
    s_add_u32 s15, s15, 12288
    buffer_load_dwordx4 a[100:103], v32, s[60:63], s15 offen sc1
    buffer_load_dwordx4 a[104:107], v33, s[60:63], s15 offen sc1
    buffer_load_dwordx4 a[248:251], v34, s[60:63], s15 offen sc1
    buffer_load_dwordx4 a[252:255], v35, s[60:63], s15 offen sc1
L_sjoin:
    s_barrier
    s_waitcnt vmcnt(12)
    v_mfma_f32_16x16x32_bf16 v[96:99], a[108:111], v[40:43], 0
    s_cmp_gt_u32 s26, 4
    s_cselect_b32 s15, s22, s23
    v_mfma_f32_16x16x32_bf16 v[112:115], a[112:115], v[40:43], 0
    v_bfe_u32 v88, v2, 1, 2
    v_mul_u32_u24 v27, 320, v2
    v_mfma_f32_16x16x32_bf16 v[128:131], a[116:119], v[40:43], 0
    s_add_u32 s15, s15, 16384
    v_xor_b32 v88, v88, v3
    v_mfma_f32_16x16x32_bf16 v[144:147], a[120:123], v[40:43], 0
    v_lshl_add_u32 v27, v88, 4, v27
    v_mfma_f32_16x16x32_bf16 v[160:163], a[124:127], v[40:43], 0
    buffer_load_dwordx4 v[40:43], v32, s[60:63], s15 offen sc1
    v_mfma_f32_16x16x32_bf16 v[100:103], a[108:111], v[44:47], 0
    v_add_u32 v27, s34, v27
    v_lshlrev_b32 v38, 1, v38
    v_mfma_f32_16x16x32_bf16 v[116:119], a[112:115], v[44:47], 0
    s_lshl_b32 s76, s72, 1
    s_mov_b32 s56, s44
    v_mfma_f32_16x16x32_bf16 v[132:135], a[116:119], v[44:47], 0
    s_mov_b32 s57, s45
    s_mov_b32 s58, 5242880
    v_mfma_f32_16x16x32_bf16 v[148:151], a[120:123], v[44:47], 0
    s_mov_b32 s59, 0x20000
    s_lshl_b32 s86, s6, 3
    v_mfma_f32_16x16x32_bf16 v[164:167], a[124:127], v[44:47], 0
    buffer_load_dwordx4 v[44:47], v33, s[60:63], s15 offen sc1
    v_mfma_f32_16x16x32_bf16 v[104:107], a[108:111], v[48:51], 0
    s_add_u32 s86, s86, s7
    s_lshl_b32 s86, s86, 1
    v_mfma_f32_16x16x32_bf16 v[120:123], a[112:115], v[48:51], 0
    s_add_u32 s86, s86, s88
    s_xor_b32 s75, s86, 1
    v_mfma_f32_16x16x32_bf16 v[136:139], a[116:119], v[48:51], 0
    s_lshl_b32 s87, s75, 6
    s_lshl_b32 s74, s3, 4
    v_mfma_f32_16x16x32_bf16 v[152:155], a[120:123], v[48:51], 0
    s_add_u32 s74, s74, 17956864
    s_add_u32 s87, s87, s74
    v_mfma_f32_16x16x32_bf16 v[168:171], a[124:127], v[48:51], 0
    buffer_load_dwordx4 v[48:51], v34, s[60:63], s15 offen sc1
    v_mfma_f32_16x16x32_bf16 v[108:111], a[108:111], v[52:55], 0
    s_lshl_b32 s78, s86, 6
    s_add_u32 s78, s78, s74
    v_mfma_f32_16x16x32_bf16 v[124:127], a[112:115], v[52:55], 0
    s_mul_i32 s74, s3, 5120
    s_add_u32 s74, s74, 25165824
    v_mfma_f32_16x16x32_bf16 v[140:143], a[116:119], v[52:55], 0
    s_mul_i32 s86, s86, 20480
    s_add_u32 s86, s86, s74
    v_mfma_f32_16x16x32_bf16 v[156:159], a[120:123], v[52:55], 0
    s_mul_i32 s75, s75, 20480
    s_add_u32 s75, s75, s74
    v_mfma_f32_16x16x32_bf16 v[172:175], a[124:127], v[52:55], 0
    buffer_load_dwordx4 v[52:55], v35, s[60:63], s15 offen sc1
    s_waitcnt vmcnt(12)
    v_mfma_f32_16x16x32_bf16 v[96:99], a[128:131], v[56:59], v[96:99]
    s_cmp_gt_u32 s26, 5
    s_cselect_b32 s15, s22, s23
    v_mfma_f32_16x16x32_bf16 v[112:115], a[132:135], v[56:59], v[112:115]
    s_add_u32 s77, s86, 4096
    s_add_u32 s51, s75, 4096
    v_mfma_f32_16x16x32_bf16 v[128:131], a[136:139], v[56:59], v[128:131]
    s_add_u32 s15, s15, 20480
    s_xor_b32 s74, s3, 0
    v_mfma_f32_16x16x32_bf16 v[144:147], a[140:143], v[56:59], v[144:147]
    s_mul_i32 s74, s74, 20480
    s_add_u32 s74, s74, 20480
    v_mfma_f32_16x16x32_bf16 v[160:163], a[144:147], v[56:59], v[160:163]
    buffer_load_dwordx4 v[56:59], v32, s[60:63], s15 offen sc1
    v_mfma_f32_16x16x32_bf16 v[100:103], a[128:131], v[60:63], v[100:103]
    v_add_u32 v88, s74, v39
    s_xor_b32 s74, s3, 1
    v_mfma_f32_16x16x32_bf16 v[116:119], a[132:135], v[60:63], v[116:119]
    s_mul_i32 s74, s74, 20480
    s_add_u32 s74, s74, 25600
    v_mfma_f32_16x16x32_bf16 v[132:135], a[136:139], v[60:63], v[132:135]
    v_add_u32 v89, s74, v39
    s_xor_b32 s74, s3, 2
    v_mfma_f32_16x16x32_bf16 v[148:151], a[140:143], v[60:63], v[148:151]
    s_mul_i32 s74, s74, 20480
    s_add_u32 s74, s74, 30720
    v_mfma_f32_16x16x32_bf16 v[164:167], a[144:147], v[60:63], v[164:167]
    buffer_load_dwordx4 v[60:63], v33, s[60:63], s15 offen sc1
    v_mfma_f32_16x16x32_bf16 v[104:107], a[128:131], v[64:67], v[104:107]
    v_add_u32 v90, s74, v39
    s_xor_b32 s74, s3, 3
    v_mfma_f32_16x16x32_bf16 v[120:123], a[132:135], v[64:67], v[120:123]
    s_mul_i32 s74, s74, 20480
    s_add_u32 s74, s74, 35840
    v_mfma_f32_16x16x32_bf16 v[136:139], a[136:139], v[64:67], v[136:139]
    v_add_u32 v91, s74, v39
    v_mfma_f32_16x16x32_bf16 v[152:155], a[140:143], v[64:67], v[152:155]
    v_mfma_f32_16x16x32_bf16 v[168:171], a[144:147], v[64:67], v[168:171]
    buffer_load_dwordx4 v[64:67], v34, s[60:63], s15 offen sc1
    v_mfma_f32_16x16x32_bf16 v[108:111], a[128:131], v[68:71], v[108:111]
    v_mfma_f32_16x16x32_bf16 v[124:127], a[132:135], v[68:71], v[124:127]
    v_mfma_f32_16x16x32_bf16 v[140:143], a[136:139], v[68:71], v[140:143]
    v_mfma_f32_16x16x32_bf16 v[156:159], a[140:143], v[68:71], v[156:159]
    v_mfma_f32_16x16x32_bf16 v[172:175], a[144:147], v[68:71], v[172:175]
    buffer_load_dwordx4 v[68:71], v35, s[60:63], s15 offen sc1
    s_waitcnt vmcnt(12)
    v_mfma_f32_16x16x32_bf16 v[96:99], a[148:151], v[72:75], v[96:99]
    s_cmp_gt_u32 s26, 6
    s_cselect_b32 s15, s22, s23
    v_mfma_f32_16x16x32_bf16 v[112:115], a[152:155], v[72:75], v[112:115]
    v_mfma_f32_16x16x32_bf16 v[128:131], a[156:159], v[72:75], v[128:131]
    s_add_u32 s15, s15, 24576
    v_mfma_f32_16x16x32_bf16 v[144:147], a[160:163], v[72:75], v[144:147]
    v_mfma_f32_16x16x32_bf16 v[160:163], a[164:167], v[72:75], v[160:163]
    buffer_load_dwordx4 v[72:75], v32, s[60:63], s15 offen sc1
    v_mfma_f32_16x16x32_bf16 v[100:103], a[148:151], v[76:79], v[100:103]
    v_mfma_f32_16x16x32_bf16 v[116:119], a[152:155], v[76:79], v[116:119]
    v_mfma_f32_16x16x32_bf16 v[132:135], a[156:159], v[76:79], v[132:135]
    v_mfma_f32_16x16x32_bf16 v[148:151], a[160:163], v[76:79], v[148:151]
    v_mfma_f32_16x16x32_bf16 v[164:167], a[164:167], v[76:79], v[164:167]
    buffer_load_dwordx4 v[76:79], v33, s[60:63], s15 offen sc1
    v_mfma_f32_16x16x32_bf16 v[104:107], a[148:151], v[80:83], v[104:107]
    v_mfma_f32_16x16x32_bf16 v[120:123], a[152:155], v[80:83], v[120:123]
    v_mfma_f32_16x16x32_bf16 v[136:139], a[156:159], v[80:83], v[136:139]
    v_mfma_f32_16x16x32_bf16 v[152:155], a[160:163], v[80:83], v[152:155]
    v_mfma_f32_16x16x32_bf16 v[168:171], a[164:167], v[80:83], v[168:171]
    buffer_load_dwordx4 v[80:83], v34, s[60:63], s15 offen sc1
    v_mfma_f32_16x16x32_bf16 v[108:111], a[148:151], v[84:87], v[108:111]
    v_mfma_f32_16x16x32_bf16 v[124:127], a[152:155], v[84:87], v[124:127]
    v_mfma_f32_16x16x32_bf16 v[140:143], a[156:159], v[84:87], v[140:143]
    v_mfma_f32_16x16x32_bf16 v[156:159], a[160:163], v[84:87], v[156:159]
    v_mfma_f32_16x16x32_bf16 v[172:175], a[164:167], v[84:87], v[172:175]
    buffer_load_dwordx4 v[84:87], v35, s[60:63], s15 offen sc1
    s_waitcnt vmcnt(12)
    v_mfma_f32_16x16x32_bf16 v[96:99], a[168:171], a[100:103], v[96:99]
    s_cmp_gt_u32 s26, 7
    s_cselect_b32 s15, s22, s23
    v_mfma_f32_16x16x32_bf16 v[112:115], a[172:175], a[100:103], v[112:115]
    v_mfma_f32_16x16x32_bf16 v[128:131], a[176:179], a[100:103], v[128:131]
    s_add_u32 s15, s15, 28672
    v_mfma_f32_16x16x32_bf16 v[144:147], a[180:183], a[100:103], v[144:147]
    v_mfma_f32_16x16x32_bf16 v[160:163], a[184:187], a[100:103], v[160:163]
    buffer_load_dwordx4 a[100:103], v32, s[60:63], s15 offen sc1
    v_mfma_f32_16x16x32_bf16 v[100:103], a[168:171], a[104:107], v[100:103]
    v_mfma_f32_16x16x32_bf16 v[116:119], a[172:175], a[104:107], v[116:119]
    v_mfma_f32_16x16x32_bf16 v[132:135], a[176:179], a[104:107], v[132:135]
    v_mfma_f32_16x16x32_bf16 v[148:151], a[180:183], a[104:107], v[148:151]
    v_mfma_f32_16x16x32_bf16 v[164:167], a[184:187], a[104:107], v[164:167]
    buffer_load_dwordx4 a[104:107], v33, s[60:63], s15 offen sc1
    v_mfma_f32_16x16x32_bf16 v[104:107], a[168:171], a[248:251], v[104:107]
    v_mfma_f32_16x16x32_bf16 v[120:123], a[172:175], a[248:251], v[120:123]
    v_mfma_f32_16x16x32_bf16 v[136:139], a[176:179], a[248:251], v[136:139]
    v_mfma_f32_16x16x32_bf16 v[152:155], a[180:183], a[248:251], v[152:155]
    v_mfma_f32_16x16x32_bf16 v[168:171], a[184:187], a[248:251], v[168:171]
    buffer_load_dwordx4 a[248:251], v34, s[60:63], s15 offen sc1
    v_mfma_f32_16x16x32_bf16 v[108:111], a[168:171], a[252:255], v[108:111]
    v_mfma_f32_16x16x32_bf16 v[124:127], a[172:175], a[252:255], v[124:127]
    v_mfma_f32_16x16x32_bf16 v[140:143], a[176:179], a[252:255], v[140:143]
    v_mfma_f32_16x16x32_bf16 v[156:159], a[180:183], a[252:255], v[156:159]
    v_mfma_f32_16x16x32_bf16 v[172:175], a[184:187], a[252:255], v[172:175]
    buffer_load_dwordx4 a[252:255], v35, s[60:63], s15 offen sc1
    s_waitcnt vmcnt(12)
    s_add_u32 s12, s33, 128
    s_load_dwordx8 s[36:43], s[48:49], s33 glc
    s_load_dwordx8 s[64:71], s[48:49], s12 glc
    v_mfma_f32_16x16x32_bf16 v[96:99], a[188:191], v[40:43], v[96:99]
    s_cmp_gt_u32 s26, 8
    s_cselect_b32 s15, s22, s23
    v_mfma_f32_16x16x32_bf16 v[112:115], a[192:195], v[40:43], v[112:115]
    v_mfma_f32_16x16x32_bf16 v[128:131], a[196:199], v[40:43], v[128:131]
    s_add_u32 s15, s15, 32768
    v_mfma_f32_16x16x32_bf16 v[144:147], a[200:203], v[40:43], v[144:147]
    v_mfma_f32_16x16x32_bf16 v[160:163], a[204:207], v[40:43], v[160:163]
    buffer_load_dwordx4 v[40:43], v32, s[60:63], s15 offen sc1
    v_mfma_f32_16x16x32_bf16 v[100:103], a[188:191], v[44:47], v[100:103]
    v_mfma_f32_16x16x32_bf16 v[116:119], a[192:195], v[44:47], v[116:119]
    v_mfma_f32_16x16x32_bf16 v[132:135], a[196:199], v[44:47], v[132:135]
    v_mfma_f32_16x16x32_bf16 v[148:151], a[200:203], v[44:47], v[148:151]
    v_mfma_f32_16x16x32_bf16 v[164:167], a[204:207], v[44:47], v[164:167]
    buffer_load_dwordx4 v[44:47], v33, s[60:63], s15 offen sc1
    v_mfma_f32_16x16x32_bf16 v[104:107], a[188:191], v[48:51], v[104:107]
    v_mfma_f32_16x16x32_bf16 v[120:123], a[192:195], v[48:51], v[120:123]
    v_mfma_f32_16x16x32_bf16 v[136:139], a[196:199], v[48:51], v[136:139]
    v_mfma_f32_16x16x32_bf16 v[152:155], a[200:203], v[48:51], v[152:155]
    v_mfma_f32_16x16x32_bf16 v[168:171], a[204:207], v[48:51], v[168:171]
    buffer_load_dwordx4 v[48:51], v34, s[60:63], s15 offen sc1
    v_mfma_f32_16x16x32_bf16 v[108:111], a[188:191], v[52:55], v[108:111]
    v_mfma_f32_16x16x32_bf16 v[124:127], a[192:195], v[52:55], v[124:127]
    v_mfma_f32_16x16x32_bf16 v[140:143], a[196:199], v[52:55], v[140:143]
    v_mfma_f32_16x16x32_bf16 v[156:159], a[200:203], v[52:55], v[156:159]
    v_mfma_f32_16x16x32_bf16 v[172:175], a[204:207], v[52:55], v[172:175]
    buffer_load_dwordx4 v[52:55], v35, s[60:63], s15 offen sc1
    s_waitcnt vmcnt(12)
    v_mfma_f32_16x16x32_bf16 v[96:99], a[208:211], v[56:59], v[96:99]
    s_cmp_gt_u32 s26, 9
    s_cselect_b32 s15, s22, s23
    v_mfma_f32_16x16x32_bf16 v[112:115], a[212:215], v[56:59], v[112:115]
    v_mfma_f32_16x16x32_bf16 v[128:131], a[216:219], v[56:59], v[128:131]
    s_add_u32 s15, s15, 36864
    v_mfma_f32_16x16x32_bf16 v[144:147], a[220:223], v[56:59], v[144:147]
    v_mfma_f32_16x16x32_bf16 v[160:163], a[224:227], v[56:59], v[160:163]
    buffer_load_dwordx4 v[56:59], v32, s[60:63], s15 offen sc1
    v_mfma_f32_16x16x32_bf16 v[100:103], a[208:211], v[60:63], v[100:103]
    v_mfma_f32_16x16x32_bf16 v[116:119], a[212:215], v[60:63], v[116:119]
    v_mfma_f32_16x16x32_bf16 v[132:135], a[216:219], v[60:63], v[132:135]
    v_mfma_f32_16x16x32_bf16 v[148:151], a[220:223], v[60:63], v[148:151]
    v_mfma_f32_16x16x32_bf16 v[164:167], a[224:227], v[60:63], v[164:167]
    buffer_load_dwordx4 v[60:63], v33, s[60:63], s15 offen sc1
    v_mfma_f32_16x16x32_bf16 v[104:107], a[208:211], v[64:67], v[104:107]
    v_mfma_f32_16x16x32_bf16 v[120:123], a[212:215], v[64:67], v[120:123]
    v_mfma_f32_16x16x32_bf16 v[136:139], a[216:219], v[64:67], v[136:139]
    v_mfma_f32_16x16x32_bf16 v[152:155], a[220:223], v[64:67], v[152:155]
    v_mfma_f32_16x16x32_bf16 v[168:171], a[224:227], v[64:67], v[168:171]
    buffer_load_dwordx4 v[64:67], v34, s[60:63], s15 offen sc1
    v_mfma_f32_16x16x32_bf16 v[108:111], a[208:211], v[68:71], v[108:111]
    v_mfma_f32_16x16x32_bf16 v[124:127], a[212:215], v[68:71], v[124:127]
    v_mfma_f32_16x16x32_bf16 v[140:143], a[216:219], v[68:71], v[140:143]
    v_mfma_f32_16x16x32_bf16 v[156:159], a[220:223], v[68:71], v[156:159]
    v_mfma_f32_16x16x32_bf16 v[172:175], a[224:227], v[68:71], v[172:175]
    buffer_load_dwordx4 v[68:71], v35, s[60:63], s15 offen sc1
    s_waitcnt vmcnt(12)
    s_branch L_sc1_hbssm
L_sc0_hbssm:
    s_sub_u32 s81, s81, 1
    s_cbranch_scc1 L_end
    s_add_u32 s12, s33, 128
    s_load_dwordx8 s[36:43], s[48:49], s33 glc
    s_load_dwordx8 s[64:71], s[48:49], s12 glc
L_sc1_hbssm:
    s_waitcnt lgkmcnt(0)
    s_cmp_eq_u64 s[36:37], s[84:85]
    s_cbranch_scc0 L_sc0_hbssm
    s_cmp_eq_u64 s[38:39], s[84:85]
    s_cbranch_scc0 L_sc0_hbssm
    s_cmp_eq_u64 s[40:41], s[84:85]
    s_cbranch_scc0 L_sc0_hbssm
    s_cmp_eq_u64 s[42:43], s[84:85]
    s_cbranch_scc0 L_sc0_hbssm
    s_cmp_eq_u64 s[64:65], s[84:85]
    s_cbranch_scc0 L_sc0_hbssm
    s_cmp_eq_u64 s[66:67], s[84:85]
    s_cbranch_scc0 L_sc0_hbssm
    s_cmp_eq_u64 s[68:69], s[84:85]
    s_cbranch_scc0 L_sc0_hbssm
    s_cmp_eq_u64 s[70:71], s[84:85]
    s_cbranch_scc0 L_sc0_hbssm
    v_mfma_f32_16x16x32_bf16 v[96:99], a[228:231], v[72:75], v[96:99]
    s_cmp_gt_u32 s26, 0
    s_cselect_b32 s15, s24, s25
    v_mfma_f32_16x16x32_bf16 v[112:115], a[232:235], v[72:75], v[112:115]
    v_mfma_f32_16x16x32_bf16 v[128:131], a[236:239], v[72:75], v[128:131]
    s_add_u32 s15, s15, 0
    v_mfma_f32_16x16x32_bf16 v[144:147], a[240:243], v[72:75], v[144:147]
    v_mfma_f32_16x16x32_bf16 v[160:163], a[244:247], v[72:75], v[160:163]
    buffer_load_dwordx4 v[72:75], v32, s[60:63], s15 offen sc1
    v_mfma_f32_16x16x32_bf16 v[100:103], a[228:231], v[76:79], v[100:103]
    v_mfma_f32_16x16x32_bf16 v[116:119], a[232:235], v[76:79], v[116:119]
    v_mfma_f32_16x16x32_bf16 v[132:135], a[236:239], v[76:79], v[132:135]
    v_mfma_f32_16x16x32_bf16 v[148:151], a[240:243], v[76:79], v[148:151]
    v_mfma_f32_16x16x32_bf16 v[164:167], a[244:247], v[76:79], v[164:167]
    buffer_load_dwordx4 v[76:79], v33, s[60:63], s15 offen sc1
    v_mfma_f32_16x16x32_bf16 v[104:107], a[228:231], v[80:83], v[104:107]
    v_mfma_f32_16x16x32_bf16 v[120:123], a[232:235], v[80:83], v[120:123]
    v_mfma_f32_16x16x32_bf16 v[136:139], a[236:239], v[80:83], v[136:139]
    v_mfma_f32_16x16x32_bf16 v[152:155], a[240:243], v[80:83], v[152:155]
    v_mfma_f32_16x16x32_bf16 v[168:171], a[244:247], v[80:83], v[168:171]
    buffer_load_dwordx4 v[80:83], v34, s[60:63], s15 offen sc1
    v_mfma_f32_16x16x32_bf16 v[108:111], a[228:231], v[84:87], v[108:111]
    v_mfma_f32_16x16x32_bf16 v[124:127], a[232:235], v[84:87], v[124:127]
    v_mfma_f32_16x16x32_bf16 v[140:143], a[236:239], v[84:87], v[140:143]
    v_mfma_f32_16x16x32_bf16 v[156:159], a[240:243], v[84:87], v[156:159]
    v_mfma_f32_16x16x32_bf16 v[172:175], a[244:247], v[84:87], v[172:175]
    buffer_load_dwordx4 v[84:87], v35, s[60:63], s15 offen sc1
    s_waitcnt vmcnt(12)
    v_mfma_f32_16x16x32_bf16 v[96:99], a[0:3], a[100:103], v[96:99]
    s_cmp_gt_u32 s26, 1
    s_cselect_b32 s15, s24, s25
    v_mfma_f32_16x16x32_bf16 v[112:115], a[4:7], a[100:103], v[112:115]
    v_mfma_f32_16x16x32_bf16 v[128:131], a[8:11], a[100:103], v[128:131]
    s_add_u32 s15, s15, 4096
    v_mfma_f32_16x16x32_bf16 v[144:147], a[12:15], a[100:103], v[144:147]
    v_mfma_f32_16x16x32_bf16 v[160:163], a[16:19], a[100:103], v[160:163]
    buffer_load_dwordx4 a[100:103], v32, s[60:63], s15 offen sc1
    v_mfma_f32_16x16x32_bf16 v[100:103], a[0:3], a[104:107], v[100:103]
    v_mfma_f32_16x16x32_bf16 v[116:119], a[4:7], a[104:107], v[116:119]
    v_mfma_f32_16x16x32_bf16 v[132:135], a[8:11], a[104:107], v[132:135]
    v_mfma_f32_16x16x32_bf16 v[148:151], a[12:15], a[104:107], v[148:151]
    v_mfma_f32_16x16x32_bf16 v[164:167], a[16:19], a[104:107], v[164:167]
    buffer_load_dwordx4 a[104:107], v33, s[60:63], s15 offen sc1
    v_mfma_f32_16x16x32_bf16 v[104:107], a[0:3], a[248:251], v[104:107]
    v_mfma_f32_16x16x32_bf16 v[120:123], a[4:7], a[248:251], v[120:123]
    v_mfma_f32_16x16x32_bf16 v[136:139], a[8:11], a[248:251], v[136:139]
    v_mfma_f32_16x16x32_bf16 v[152:155], a[12:15], a[248:251], v[152:155]
    v_mfma_f32_16x16x32_bf16 v[168:171], a[16:19], a[248:251], v[168:171]
    buffer_load_dwordx4 a[248:251], v34, s[60:63], s15 offen sc1
    v_mfma_f32_16x16x32_bf16 v[108:111], a[0:3], a[252:255], v[108:111]
    v_mfma_f32_16x16x32_bf16 v[124:127], a[4:7], a[252:255], v[124:127]
    v_mfma_f32_16x16x32_bf16 v[140:143], a[8:11], a[252:255], v[140:143]
    v_mfma_f32_16x16x32_bf16 v[156:159], a[12:15], a[252:255], v[156:159]
    v_mfma_f32_16x16x32_bf16 v[172:175], a[16:19], a[252:255], v[172:175]
    buffer_load_dwordx4 a[252:255], v35, s[60:63], s15 offen sc1
    s_waitcnt vmcnt(12)
    v_mfma_f32_16x16x32_bf16 v[96:99], a[20:23], v[40:43], v[96:99]
    s_cmp_gt_u32 s26, 2
    s_cselect_b32 s15, s24, s25
    v_mfma_f32_16x16x32_bf16 v[112:115], a[24:27], v[40:43], v[112:115]
    v_mfma_f32_16x16x32_bf16 v[128:131], a[28:31], v[40:43], v[128:131]
    s_add_u32 s15, s15, 8192
    v_mfma_f32_16x16x32_bf16 v[144:147], a[32:35], v[40:43], v[144:147]
    v_mfma_f32_16x16x32_bf16 v[160:163], a[36:39], v[40:43], v[160:163]
    buffer_load_dwordx4 v[40:43], v32, s[60:63], s15 offen sc1
    v_mfma_f32_16x16x32_bf16 v[100:103], a[20:23], v[44:47], v[100:103]
    v_mfma_f32_16x16x32_bf16 v[116:119], a[24:27], v[44:47], v[116:119]
    v_mfma_f32_16x16x32_bf16 v[132:135], a[28:31], v[44:47], v[132:135]
    v_mfma_f32_16x16x32_bf16 v[148:151], a[32:35], v[44:47], v[148:151]
    v_mfma_f32_16x16x32_bf16 v[164:167], a[36:39], v[44:47], v[164:167]
    buffer_load_dwordx4 v[44:47], v33, s[60:63], s15 offen sc1
    v_mfma_f32_16x16x32_bf16 v[104:107], a[20:23], v[48:51], v[104:107]
    v_mfma_f32_16x16x32_bf16 v[120:123], a[24:27], v[48:51], v[120:123]
    v_mfma_f32_16x16x32_bf16 v[136:139], a[28:31], v[48:51], v[136:139]
    v_mfma_f32_16x16x32_bf16 v[152:155], a[32:35], v[48:51], v[152:155]
    v_mfma_f32_16x16x32_bf16 v[168:171], a[36:39], v[48:51], v[168:171]
    buffer_load_dwordx4 v[48:51], v34, s[60:63], s15 offen sc1
    v_mfma_f32_16x16x32_bf16 v[108:111], a[20:23], v[52:55], v[108:111]
    v_mfma_f32_16x16x32_bf16 v[124:127], a[24:27], v[52:55], v[124:127]
    v_mfma_f32_16x16x32_bf16 v[140:143], a[28:31], v[52:55], v[140:143]
    v_mfma_f32_16x16x32_bf16 v[156:159], a[32:35], v[52:55], v[156:159]
    v_mfma_f32_16x16x32_bf16 v[172:175], a[36:39], v[52:55], v[172:175]
    buffer_load_dwordx4 v[52:55], v35, s[60:63], s15 offen sc1
    s_waitcnt vmcnt(12)
    v_mfma_f32_16x16x32_bf16 v[96:99], a[40:43], v[56:59], v[96:99]
    s_cmp_gt_u32 s26, 3
    s_cselect_b32 s15, s24, s25
    v_mfma_f32_16x16x32_bf16 v[112:115], a[44:47], v[56:59], v[112:115]
    v_mfma_f32_16x16x32_bf16 v[128:131], a[48:51], v[56:59], v[128:131]
    s_add_u32 s15, s15, 12288
    v_mfma_f32_16x16x32_bf16 v[144:147], a[52:55], v[56:59], v[144:147]
    v_mfma_f32_16x16x32_bf16 v[160:163], a[56:59], v[56:59], v[160:163]
    buffer_load_dwordx4 v[56:59], v32, s[60:63], s15 offen sc1
    v_mfma_f32_16x16x32_bf16 v[100:103], a[40:43], v[60:63], v[100:103]
    v_mfma_f32_16x16x32_bf16 v[116:119], a[44:47], v[60:63], v[116:119]
    v_mfma_f32_16x16x32_bf16 v[132:135], a[48:51], v[60:63], v[132:135]
    v_mfma_f32_16x16x32_bf16 v[148:151], a[52:55], v[60:63], v[148:151]
    v_mfma_f32_16x16x32_bf16 v[164:167], a[56:59], v[60:63], v[164:167]
    buffer_load_dwordx4 v[60:63], v33, s[60:63], s15 offen sc1
    v_mfma_f32_16x16x32_bf16 v[104:107], a[40:43], v[64:67], v[104:107]
    v_mfma_f32_16x16x32_bf16 v[120:123], a[44:47], v[64:67], v[120:123]
    v_mfma_f32_16x16x32_bf16 v[136:139], a[48:51], v[64:67], v[136:139]
    v_mfma_f32_16x16x32_bf16 v[152:155], a[52:55], v[64:67], v[152:155]
    v_mfma_f32_16x16x32_bf16 v[168:171], a[56:59], v[64:67], v[168:171]
    buffer_load_dwordx4 v[64:67], v34, s[60:63], s15 offen sc1
    v_mfma_f32_16x16x32_bf16 v[108:111], a[40:43], v[68:71], v[108:111]
    v_mfma_f32_16x16x32_bf16 v[124:127], a[44:47], v[68:71], v[124:127]
    v_mfma_f32_16x16x32_bf16 v[140:143], a[48:51], v[68:71], v[140:143]
    v_mfma_f32_16x16x32_bf16 v[156:159], a[52:55], v[68:71], v[156:159]
    v_mfma_f32_16x16x32_bf16 v[172:175], a[56:59], v[68:71], v[172:175]
    buffer_load_dwordx4 v[68:71], v35, s[60:63], s15 offen sc1
    s_waitcnt vmcnt(12)
    v_mfma_f32_16x16x32_bf16 v[176:179], a[108:111], v[72:75], 0
    s_cmp_gt_u32 s26, 4
    s_cselect_b32 s15, s24, s25
    v_mfma_f32_16x16x32_bf16 v[192:195], a[112:115], v[72:75], 0
    v_mfma_f32_16x16x32_bf16 v[208:211], a[116:119], v[72:75], 0
    s_add_u32 s15, s15, 16384
    ds_write_b128 v27, v[96:99] offset:0
    v_mfma_f32_16x16x32_bf16 v[224:227], a[120:123], v[72:75], 0
    v_mfma_f32_16x16x32_bf16 v[240:243], a[124:127], v[72:75], 0
    buffer_load_dwordx4 v[72:75], v32, s[60:63], s15 offen sc1
    v_mfma_f32_16x16x32_bf16 v[180:183], a[108:111], v[76:79], 0
    ds_write_b128 v27, v[112:115] offset:64
    v_mfma_f32_16x16x32_bf16 v[196:199], a[112:115], v[76:79], 0
    v_mfma_f32_16x16x32_bf16 v[212:215], a[116:119], v[76:79], 0
    ds_write_b128 v27, v[128:131] offset:128
    v_mfma_f32_16x16x32_bf16 v[228:231], a[120:123], v[76:79], 0
    v_mfma_f32_16x16x32_bf16 v[244:247], a[124:127], v[76:79], 0
    buffer_load_dwordx4 v[76:79], v33, s[60:63], s15 offen sc1
    v_mfma_f32_16x16x32_bf16 v[184:187], a[108:111], v[80:83], 0
    ds_write_b128 v27, v[144:147] offset:192
    v_mfma_f32_16x16x32_bf16 v[200:203], a[112:115], v[80:83], 0
    v_mfma_f32_16x16x32_bf16 v[216:219], a[116:119], v[80:83], 0
    ds_write_b128 v27, v[160:163] offset:256
    v_mfma_f32_16x16x32_bf16 v[232:235], a[120:123], v[80:83], 0
    v_mfma_f32_16x16x32_bf16 v[248:251], a[124:127], v[80:83], 0
    buffer_load_dwordx4 v[80:83], v34, s[60:63], s15 offen sc1
    v_mfma_f32_16x16x32_bf16 v[188:191], a[108:111], v[84:87], 0
    ds_write_b128 v27, v[100:103] offset:5120
    v_mfma_f32_16x16x32_bf16 v[204:207], a[112:115], v[84:87], 0
    ds_write_b128 v27, v[116:119] offset:5184
    v_mfma_f32_16x16x32_bf16 v[220:223], a[116:119], v[84:87], 0
    v_mfma_f32_16x16x32_bf16 v[236:239], a[120:123], v[84:87], 0
    v_mfma_f32_16x16x32_bf16 v[252:255], a[124:127], v[84:87], 0
    buffer_load_dwordx4 v[84:87], v35, s[60:63], s15 offen sc1
    s_waitcnt vmcnt(12)
    v_mfma_f32_16x16x32_bf16 v[176:179], a[128:131], a[100:103], v[176:179]
    s_cmp_gt_u32 s26, 5
    s_cselect_b32 s15, s24, s25
    v_mfma_f32_16x16x32_bf16 v[192:195], a[132:135], a[100:103], v[192:195]
    v_mfma_f32_16x16x32_bf16 v[208:211], a[136:139], a[100:103], v[208:211]
    s_add_u32 s15, s15, 20480
    ds_write_b128 v27, v[132:135] offset:5248
    v_mfma_f32_16x16x32_bf16 v[224:227], a[140:143], a[100:103], v[224:227]
    v_mfma_f32_16x16x32_bf16 v[240:243], a[144:147], a[100:103], v[240:243]
    buffer_load_dwordx4 a[100:103], v32, s[60:63], s15 offen sc1
    v_mfma_f32_16x16x32_bf16 v[180:183], a[128:131], a[104:107], v[180:183]
    ds_write_b128 v27, v[148:151] offset:5312
    v_mfma_f32_16x16x32_bf16 v[196:199], a[132:135], a[104:107], v[196:199]
    v_mfma_f32_16x16x32_bf16 v[212:215], a[136:139], a[104:107], v[212:215]
    ds_write_b128 v27, v[164:167] offset:5376
    v_mfma_f32_16x16x32_bf16 v[228:231], a[140:143], a[104:107], v[228:231]
    v_mfma_f32_16x16x32_bf16 v[244:247], a[144:147], a[104:107], v[244:247]
    buffer_load_dwordx4 a[104:107], v33, s[60:63], s15 offen sc1
    v_mfma_f32_16x16x32_bf16 v[184:187], a[128:131], a[248:251], v[184:187]
    ds_write_b128 v27, v[104:107] offset:10240
    v_mfma_f32_16x16x32_bf16 v[200:203], a[132:135], a[248:251], v[200:203]
    v_mfma_f32_16x16x32_bf16 v[216:219], a[136:139], a[248:251], v[216:219]
    ds_write_b128 v27, v[120:123] offset:10304
    v_mfma_f32_16x16x32_bf16 v[232:235], a[140:143], a[248:251], v[232:235]
    v_mfma_f32_16x16x32_bf16 v[248:251], a[144:147], a[248:251], v[248:251]
    buffer_load_dwordx4 a[248:251], v34, s[60:63], s15 offen sc1
    v_mfma_f32_16x16x32_bf16 v[188:191], a[128:131], a[252:255], v[188:191]
    ds_write_b128 v27, v[136:139] offset:10368
    v_mfma_f32_16x16x32_bf16 v[204:207], a[132:135], a[252:255], v[204:207]
    ds_write_b128 v27, v[152:155] offset:10432
    v_mfma_f32_16x16x32_bf16 v[220:223], a[136:139], a[252:255], v[220:223]
    v_mfma_f32_16x16x32_bf16 v[236:239], a[140:143], a[252:255], v[236:239]
    v_mfma_f32_16x16x32_bf16 v[252:255], a[144:147], a[252:255], v[252:255]
    buffer_load_dwordx4 a[252:255], v35, s[60:63], s15 offen sc1
    s_waitcnt vmcnt(12)
    v_mfma_f32_16x16x32_bf16 v[176:179], a[148:151], v[40:43], v[176:179]
    s_cmp_gt_u32 s26, 6
    s_cselect_b32 s15, s24, s25
    v_mfma_f32_16x16x32_bf16 v[192:195], a[152:155], v[40:43], v[192:195]
    v_mfma_f32_16x16x32_bf16 v[208:211], a[156:159], v[40:43], v[208:211]
    s_add_u32 s15, s15, 24576
    ds_write_b128 v27, v[168:171] offset:10496
    v_mfma_f32_16x16x32_bf16 v[224:227], a[160:163], v[40:43], v[224:227]
    v_mfma_f32_16x16x32_bf16 v[240:243], a[164:167], v[40:43], v[240:243]
    buffer_load_dwordx4 v[40:43], v32, s[60:63], s15 offen sc1
    v_mfma_f32_16x16x32_bf16 v[180:183], a[148:151], v[44:47], v[180:183]
    ds_write_b128 v27, v[108:111] offset:15360
    v_mfma_f32_16x16x32_bf16 v[196:199], a[152:155], v[44:47], v[196:199]
    ds_write_b128 v27, v[124:127] offset:15424
    v_mfma_f32_16x16x32_bf16 v[212:215], a[156:159], v[44:47], v[212:215]
    v_mfma_f32_16x16x32_bf16 v[228:231], a[160:163], v[44:47], v[228:231]
    ds_write_b128 v27, v[140:143] offset:15488
    v_mfma_f32_16x16x32_bf16 v[244:247], a[164:167], v[44:47], v[244:247]
    buffer_load_dwordx4 v[44:47], v33, s[60:63], s15 offen sc1
    v_mfma_f32_16x16x32_bf16 v[184:187], a[148:151], v[48:51], v[184:187]
    ds_write_b128 v27, v[156:159] offset:15552
    v_mfma_f32_16x16x32_bf16 v[200:203], a[152:155], v[48:51], v[200:203]
    v_mfma_f32_16x16x32_bf16 v[216:219], a[156:159], v[48:51], v[216:219]
    ds_write_b128 v27, v[172:175] offset:15616
    v_mfma_f32_16x16x32_bf16 v[232:235], a[160:163], v[48:51], v[232:235]
    v_mfma_f32_16x16x32_bf16 v[248:251], a[164:167], v[48:51], v[248:251]
    buffer_load_dwordx4 v[48:51], v34, s[60:63], s15 offen sc1
    v_mfma_f32_16x16x32_bf16 v[188:191], a[148:151], v[52:55], v[188:191]
    v_mfma_f32_16x16x32_bf16 v[204:207], a[152:155], v[52:55], v[204:207]
    v_mfma_f32_16x16x32_bf16 v[220:223], a[156:159], v[52:55], v[220:223]
    v_mfma_f32_16x16x32_bf16 v[236:239], a[160:163], v[52:55], v[236:239]
    v_mfma_f32_16x16x32_bf16 v[252:255], a[164:167], v[52:55], v[252:255]
    buffer_load_dwordx4 v[52:55], v35, s[60:63], s15 offen sc1
    s_waitcnt vmcnt(12)
    s_waitcnt lgkmcnt(0)
    s_barrier
    v_mfma_f32_16x16x32_bf16 v[176:179], a[168:171], v[56:59], v[176:179]
    s_cmp_gt_u32 s26, 7
    s_cselect_b32 s15, s24, s25
    v_mfma_f32_16x16x32_bf16 v[192:195], a[172:175], v[56:59], v[192:195]
    ds_read_b128 v[96:99], v88 offset:0
    v_mfma_f32_16x16x32_bf16 v[208:211], a[176:179], v[56:59], v[208:211]
    s_add_u32 s15, s15, 28672
    ds_read_b128 v[100:103], v89 offset:0
    v_mfma_f32_16x16x32_bf16 v[224:227], a[180:183], v[56:59], v[224:227]
    ds_read_b128 v[104:107], v90 offset:0
    v_mfma_f32_16x16x32_bf16 v[240:243], a[184:187], v[56:59], v[240:243]
    buffer_load_dwordx4 v[56:59], v32, s[60:63], s15 offen sc1
    v_mfma_f32_16x16x32_bf16 v[180:183], a[168:171], v[60:63], v[180:183]
    ds_read_b128 v[108:111], v91 offset:0
    v_mfma_f32_16x16x32_bf16 v[196:199], a[172:175], v[60:63], v[196:199]
    ds_read_b128 v[112:115], v88 offset:64
    v_mfma_f32_16x16x32_bf16 v[212:215], a[176:179], v[60:63], v[212:215]
    ds_read_b128 v[116:119], v89 offset:64
    v_mfma_f32_16x16x32_bf16 v[228:231], a[180:183], v[60:63], v[228:231]
    ds_read_b128 v[120:123], v90 offset:64
    v_mfma_f32_16x16x32_bf16 v[244:247], a[184:187], v[60:63], v[244:247]
    buffer_load_dwordx4 v[60:63], v33, s[60:63], s15 offen sc1
    v_mfma_f32_16x16x32_bf16 v[184:187], a[168:171], v[64:67], v[184:187]
    ds_read_b128 v[124:127], v91 offset:64
    v_mfma_f32_16x16x32_bf16 v[200:203], a[172:175], v[64:67], v[200:203]
    ds_read_b128 v[128:131], v88 offset:128
    v_mfma_f32_16x16x32_bf16 v[216:219], a[176:179], v[64:67], v[216:219]
    ds_read_b128 v[132:135], v89 offset:128
    v_mfma_f32_16x16x32_bf16 v[232:235], a[180:183], v[64:67], v[232:235]
    v_mfma_f32_16x16x32_bf16 v[248:251], a[184:187], v[64:67], v[248:251]
    buffer_load_dwordx4 v[64:67], v34, s[60:63], s15 offen sc1
    v_mfma_f32_16x16x32_bf16 v[188:191], a[168:171], v[68:71], v[188:191]
    ds_read_b128 v[136:139], v90 offset:128
    v_mfma_f32_16x16x32_bf16 v[204:207], a[172:175], v[68:71], v[204:207]
    ds_read_b128 v[140:143], v91 offset:128
    v_mfma_f32_16x16x32_bf16 v[220:223], a[176:179], v[68:71], v[220:223]
    v_mfma_f32_16x16x32_bf16 v[236:239], a[180:183], v[68:71], v[236:239]
    v_mfma_f32_16x16x32_bf16 v[252:255], a[184:187], v[68:71], v[252:255]
    buffer_load_dwordx4 v[68:71], v35, s[60:63], s15 offen sc1
    s_waitcnt vmcnt(12)
    v_mfma_f32_16x16x32_bf16 v[176:179], a[188:191], v[72:75], v[176:179]
    s_cmp_gt_u32 s26, 8
    s_cselect_b32 s15, s24, s25
    v_mfma_f32_16x16x32_bf16 v[192:195], a[192:195], v[72:75], v[192:195]
    ds_read_b128 v[144:147], v88 offset:192
    s_waitcnt lgkmcnt(9)
    v_mfma_f32_16x16x32_bf16 v[208:211], a[196:199], v[72:75], v[208:211]
    s_add_u32 s15, s15, 32768
    ds_read_b128 v[148:151], v89 offset:192
    v_mfma_f32_16x16x32_bf16 v[224:227], a[200:203], v[72:75], v[224:227]
    ds_read_b128 v[152:155], v90 offset:192
    v_add_f32 v96, v96, v100
    v_mfma_f32_16x16x32_bf16 v[240:243], a[204:207], v[72:75], v[240:243]
    buffer_load_dwordx4 v[72:75], v32, s[60:63], s15 offen sc1
    v_mfma_f32_16x16x32_bf16 v[180:183], a[188:191], v[76:79], v[180:183]
    ds_read_b128 v[156:159], v91 offset:192
    v_add_f32 v97, v97, v101
    v_mfma_f32_16x16x32_bf16 v[196:199], a[192:195], v[76:79], v[196:199]
    ds_read_b128 v[160:163], v88 offset:256
    v_add_f32 v98, v98, v102
    v_mfma_f32_16x16x32_bf16 v[212:215], a[196:199], v[76:79], v[212:215]
    v_add_f32 v99, v99, v103
    v_add_f32 v104, v104, v108
    v_mfma_f32_16x16x32_bf16 v[228:231], a[200:203], v[76:79], v[228:231]
    ds_read_b128 v[164:167], v89 offset:256
    v_add_f32 v105, v105, v109
    v_mfma_f32_16x16x32_bf16 v[244:247], a[204:207], v[76:79], v[244:247]
    buffer_load_dwordx4 v[76:79], v33, s[60:63], s15 offen sc1
    v_mfma_f32_16x16x32_bf16 v[184:187], a[188:191], v[80:83], v[184:187]
    ds_read_b128 v[168:171], v90 offset:256
    v_add_f32 v106, v106, v110
    v_mfma_f32_16x16x32_bf16 v[200:203], a[192:195], v[80:83], v[200:203]
    ds_read_b128 v[172:175], v91 offset:256
    v_add_f32 v107, v107, v111
    v_mfma_f32_16x16x32_bf16 v[216:219], a[196:199], v[80:83], v[216:219]
    v_add_f32 v96, v96, v104
    v_add_f32 v97, v97, v105
    v_mfma_f32_16x16x32_bf16 v[232:235], a[200:203], v[80:83], v[232:235]
    v_add_f32 v98, v98, v106
    v_add_f32 v99, v99, v107
    v_mfma_f32_16x16x32_bf16 v[248:251], a[204:207], v[80:83], v[248:251]
    buffer_load_dwordx4 v[80:83], v34, s[60:63], s15 offen sc1
    v_mfma_f32_16x16x32_bf16 v[188:191], a[188:191], v[84:87], v[188:191]
    buffer_store_dwordx4 v[96:99], v26, s[60:63], s75 offen offset:0 sc1
    v_mfma_f32_16x16x32_bf16 v[204:207], a[192:195], v[84:87], v[204:207]
    s_waitcnt lgkmcnt(12)
    v_add_f32 v112, v112, v116
    v_mfma_f32_16x16x32_bf16 v[220:223], a[196:199], v[84:87], v[220:223]
    v_add_f32 v113, v113, v117
    v_add_f32 v114, v114, v118
    v_mfma_f32_16x16x32_bf16 v[236:239], a[200:203], v[84:87], v[236:239]
    v_add_f32 v115, v115, v119
    v_add_f32 v120, v120, v124
    v_mfma_f32_16x16x32_bf16 v[252:255], a[204:207], v[84:87], v[252:255]
    buffer_load_dwordx4 v[84:87], v35, s[60:63], s15 offen sc1
    s_waitcnt vmcnt(13)
    v_mfma_f32_16x16x32_bf16 v[176:179], a[208:211], a[100:103], v[176:179]
    s_cmp_gt_u32 s26, 9
    s_cselect_b32 s15, s24, s25
    v_mfma_f32_16x16x32_bf16 v[192:195], a[212:215], a[100:103], v[192:195]
    v_add_f32 v121, v121, v125
    v_add_f32 v122, v122, v126
    v_mfma_f32_16x16x32_bf16 v[208:211], a[216:219], a[100:103], v[208:211]
    s_add_u32 s15, s15, 36864
    v_add_f32 v123, v123, v127
    v_mfma_f32_16x16x32_bf16 v[224:227], a[220:223], a[100:103], v[224:227]
    v_add_f32 v112, v112, v120
    v_add_f32 v113, v113, v121
    v_mfma_f32_16x16x32_bf16 v[240:243], a[224:227], a[100:103], v[240:243]
    buffer_load_dwordx4 a[100:103], v32, s[60:63], s15 offen sc1
    v_mfma_f32_16x16x32_bf16 v[180:183], a[208:211], a[104:107], v[180:183]
    v_add_f32 v114, v114, v122
    v_add_f32 v115, v115, v123
    v_mfma_f32_16x16x32_bf16 v[196:199], a[212:215], a[104:107], v[196:199]
    buffer_store_dwordx4 v[112:115], v26, s[60:63], s75 offen offset:1024 sc1
    v_mfma_f32_16x16x32_bf16 v[212:215], a[216:219], a[104:107], v[212:215]
    s_waitcnt lgkmcnt(8)
    v_add_f32 v128, v128, v132
    v_mfma_f32_16x16x32_bf16 v[228:231], a[220:223], a[104:107], v[228:231]
    v_add_f32 v129, v129, v133
    v_add_f32 v130, v130, v134
    v_mfma_f32_16x16x32_bf16 v[244:247], a[224:227], a[104:107], v[244:247]
    buffer_load_dwordx4 a[104:107], v33, s[60:63], s15 offen sc1
    v_mfma_f32_16x16x32_bf16 v[184:187], a[208:211], a[248:251], v[184:187]
    v_add_f32 v131, v131, v135
    v_add_f32 v136, v136, v140
    v_mfma_f32_16x16x32_bf16 v[200:203], a[212:215], a[248:251], v[200:203]
    v_add_f32 v137, v137, v141
    v_add_f32 v138, v138, v142
    v_mfma_f32_16x16x32_bf16 v[216:219], a[216:219], a[248:251], v[216:219]
    v_add_f32 v139, v139, v143
    v_add_f32 v128, v128, v136
    v_mfma_f32_16x16x32_bf16 v[232:235], a[220:223], a[248:251], v[232:235]
    v_add_f32 v129, v129, v137
    v_add_f32 v130, v130, v138
    v_mfma_f32_16x16x32_bf16 v[248:251], a[224:227], a[248:251], v[248:251]
    buffer_load_dwordx4 a[248:251], v34, s[60:63], s15 offen sc1
    v_mfma_f32_16x16x32_bf16 v[188:191], a[208:211], a[252:255], v[188:191]
    v_add_f32 v131, v131, v139
    v_mfma_f32_16x16x32_bf16 v[204:207], a[212:215], a[252:255], v[204:207]
    buffer_store_dwordx4 v[128:131], v26, s[60:63], s75 offen offset:2048 sc1
    v_mfma_f32_16x16x32_bf16 v[220:223], a[216:219], a[252:255], v[220:223]
    s_waitcnt lgkmcnt(4)
    v_add_f32 v144, v144, v148
    v_mfma_f32_16x16x32_bf16 v[236:239], a[220:223], a[252:255], v[236:239]
    v_add_f32 v145, v145, v149
    v_add_f32 v146, v146, v150
    v_mfma_f32_16x16x32_bf16 v[252:255], a[224:227], a[252:255], v[252:255]
    buffer_load_dwordx4 a[252:255], v35, s[60:63], s15 offen sc1
    s_waitcnt vmcnt(15)
    v_mfma_f32_16x16x32_bf16 v[176:179], a[228:231], v[40:43], v[176:179]
    v_add_f32 v147, v147, v151
    v_add_f32 v152, v152, v156
    v_mfma_f32_16x16x32_bf16 v[192:195], a[232:235], v[40:43], v[192:195]
    v_add_f32 v153, v153, v157
    v_add_f32 v154, v154, v158
    v_mfma_f32_16x16x32_bf16 v[208:211], a[236:239], v[40:43], v[208:211]
    v_add_f32 v155, v155, v159
    v_add_f32 v144, v144, v152
    v_mfma_f32_16x16x32_bf16 v[224:227], a[240:243], v[40:43], v[224:227]
    v_add_f32 v145, v145, v153
    v_add_f32 v146, v146, v154
    v_mfma_f32_16x16x32_bf16 v[240:243], a[244:247], v[40:43], v[240:243]
    v_add_f32 v147, v147, v155
    v_mfma_f32_16x16x32_bf16 v[180:183], a[228:231], v[44:47], v[180:183]
    buffer_store_dwordx4 v[144:147], v26, s[60:63], s75 offen offset:3072 sc1
    v_mfma_f32_16x16x32_bf16 v[196:199], a[232:235], v[44:47], v[196:199]
    s_waitcnt lgkmcnt(0)
    v_add_f32 v160, v160, v164
    v_mfma_f32_16x16x32_bf16 v[212:215], a[236:239], v[44:47], v[212:215]
    v_add_f32 v161, v161, v165
    v_add_f32 v162, v162, v166
    v_mfma_f32_16x16x32_bf16 v[228:231], a[240:243], v[44:47], v[228:231]
    v_add_f32 v163, v163, v167
    v_add_f32 v168, v168, v172
    v_mfma_f32_16x16x32_bf16 v[244:247], a[244:247], v[44:47], v[244:247]
    v_add_f32 v169, v169, v173
    v_add_f32 v170, v170, v174
    v_mfma_f32_16x16x32_bf16 v[184:187], a[228:231], v[48:51], v[184:187]
    v_add_f32 v171, v171, v175
    v_add_f32 v160, v160, v168
    v_mfma_f32_16x16x32_bf16 v[200:203], a[232:235], v[48:51], v[200:203]
    v_add_f32 v161, v161, v169
    v_add_f32 v162, v162, v170
    v_mfma_f32_16x16x32_bf16 v[216:219], a[236:239], v[48:51], v[216:219]
    v_add_f32 v163, v163, v171
    v_mfma_f32_16x16x32_bf16 v[232:235], a[240:243], v[48:51], v[232:235]
    buffer_store_dwordx4 v[160:163], v26, s[60:63], s51 offen offset:0 sc1
    v_mfma_f32_16x16x32_bf16 v[248:251], a[244:247], v[48:51], v[248:251]
    v_mfma_f32_16x16x32_bf16 v[188:191], a[228:231], v[52:55], v[188:191]
    v_mfma_f32_16x16x32_bf16 v[204:207], a[232:235], v[52:55], v[204:207]
    v_mfma_f32_16x16x32_bf16 v[220:223], a[236:239], v[52:55], v[220:223]
    v_mfma_f32_16x16x32_bf16 v[236:239], a[240:243], v[52:55], v[236:239]
    v_mfma_f32_16x16x32_bf16 v[252:255], a[244:247], v[52:55], v[252:255]
    s_waitcnt vmcnt(13)
    s_barrier
    v_mfma_f32_16x16x32_bf16 v[176:179], a[0:3], v[56:59], v[176:179]
    v_mfma_f32_16x16x32_bf16 v[192:195], a[4:7], v[56:59], v[192:195]
    v_mfma_f32_16x16x32_bf16 v[208:211], a[8:11], v[56:59], v[208:211]
    v_mfma_f32_16x16x32_bf16 v[224:227], a[12:15], v[56:59], v[224:227]
    v_mfma_f32_16x16x32_bf16 v[240:243], a[16:19], v[56:59], v[240:243]
    v_mfma_f32_16x16x32_bf16 v[180:183], a[0:3], v[60:63], v[180:183]
    v_mfma_f32_16x16x32_bf16 v[196:199], a[4:7], v[60:63], v[196:199]
    v_mfma_f32_16x16x32_bf16 v[212:215], a[8:11], v[60:63], v[212:215]
    v_mfma_f32_16x16x32_bf16 v[228:231], a[12:15], v[60:63], v[228:231]
    v_mfma_f32_16x16x32_bf16 v[244:247], a[16:19], v[60:63], v[244:247]
    v_mfma_f32_16x16x32_bf16 v[184:187], a[0:3], v[64:67], v[184:187]
    v_mfma_f32_16x16x32_bf16 v[200:203], a[4:7], v[64:67], v[200:203]
    v_mfma_f32_16x16x32_bf16 v[216:219], a[8:11], v[64:67], v[216:219]
    v_mfma_f32_16x16x32_bf16 v[232:235], a[12:15], v[64:67], v[232:235]
    v_mfma_f32_16x16x32_bf16 v[248:251], a[16:19], v[64:67], v[248:251]
    v_mfma_f32_16x16x32_bf16 v[188:191], a[0:3], v[68:71], v[188:191]
    v_mfma_f32_16x16x32_bf16 v[204:207], a[4:7], v[68:71], v[204:207]
    v_mfma_f32_16x16x32_bf16 v[220:223], a[8:11], v[68:71], v[220:223]
    v_mfma_f32_16x16x32_bf16 v[236:239], a[12:15], v[68:71], v[236:239]
    v_mfma_f32_16x16x32_bf16 v[252:255], a[16:19], v[68:71], v[252:255]
    s_waitcnt vmcnt(8)
    s_waitcnt vmcnt(0)
    buffer_store_dwordx2 v[36:37], v24, s[60:63], s87 offen sc1
    s_waitcnt lgkmcnt(0)
    s_load_dwordx2 s[36:37], s[48:49], s78 glc
    v_mfma_f32_16x16x32_bf16 v[176:179], a[20:23], v[72:75], v[176:179]
    v_mfma_f32_16x16x32_bf16 v[192:195], a[24:27], v[72:75], v[192:195]
    v_mfma_f32_16x16x32_bf16 v[208:211], a[28:31], v[72:75], v[208:211]
    v_mfma_f32_16x16x32_bf16 v[224:227], a[32:35], v[72:75], v[224:227]
    v_mfma_f32_16x16x32_bf16 v[240:243], a[36:39], v[72:75], v[240:243]
    v_mfma_f32_16x16x32_bf16 v[176:179], a[40:43], a[100:103], v[176:179]
    v_mfma_f32_16x16x32_bf16 v[192:195], a[44:47], a[100:103], v[192:195]
    v_mfma_f32_16x16x32_bf16 v[208:211], a[48:51], a[100:103], v[208:211]
    v_mfma_f32_16x16x32_bf16 v[224:227], a[52:55], a[100:103], v[224:227]
    v_mfma_f32_16x16x32_bf16 v[240:243], a[56:59], a[100:103], v[240:243]
    v_mfma_f32_16x16x32_bf16 v[180:183], a[20:23], v[76:79], v[180:183]
    v_mfma_f32_16x16x32_bf16 v[196:199], a[24:27], v[76:79], v[196:199]
    v_mfma_f32_16x16x32_bf16 v[212:215], a[28:31], v[76:79], v[212:215]
    v_mfma_f32_16x16x32_bf16 v[228:231], a[32:35], v[76:79], v[228:231]
    ds_write_b128 v27, v[176:179] offset:0
    v_mfma_f32_16x16x32_bf16 v[244:247], a[36:39], v[76:79], v[244:247]
    v_mfma_f32_16x16x32_bf16 v[180:183], a[40:43], a[104:107], v[180:183]
    ds_write_b128 v27, v[192:195] offset:64
    v_mfma_f32_16x16x32_bf16 v[196:199], a[44:47], a[104:107], v[196:199]
    ds_write_b128 v27, v[208:211] offset:128
    v_mfma_f32_16x16x32_bf16 v[212:215], a[48:51], a[104:107], v[212:215]
    ds_write_b128 v27, v[224:227] offset:192
    v_mfma_f32_16x16x32_bf16 v[228:231], a[52:55], a[104:107], v[228:231]
    ds_write_b128 v27, v[240:243] offset:256
    v_mfma_f32_16x16x32_bf16 v[244:247], a[56:59], a[104:107], v[244:247]
    v_mfma_f32_16x16x32_bf16 v[184:187], a[20:23], v[80:83], v[184:187]
    v_mfma_f32_16x16x32_bf16 v[200:203], a[24:27], v[80:83], v[200:203]
    v_mfma_f32_16x16x32_bf16 v[216:219], a[28:31], v[80:83], v[216:219]
    s_waitcnt lgkmcnt(0)
    s_cmp_eq_u64 s[36:37], s[84:85]
    s_cbranch_scc0 L_xe_ssm
    buffer_load_dwordx4 v[40:43], v26, s[60:63], s86 offen offset:0 sc1
    buffer_load_dwordx4 v[44:47], v26, s[60:63], s86 offen offset:1024 sc1
    buffer_load_dwordx4 v[48:51], v26, s[60:63], s86 offen offset:2048 sc1
    buffer_load_dwordx4 v[52:55], v26, s[60:63], s86 offen offset:3072 sc1
    buffer_load_dwordx4 v[56:59], v26, s[60:63], s77 offen offset:0 sc1
L_xe_ssm:
    v_mfma_f32_16x16x32_bf16 v[232:235], a[32:35], v[80:83], v[232:235]
    ds_write_b128 v27, v[180:183] offset:5120
    v_mfma_f32_16x16x32_bf16 v[248:251], a[36:39], v[80:83], v[248:251]
    v_mfma_f32_16x16x32_bf16 v[184:187], a[40:43], a[248:251], v[184:187]
    ds_write_b128 v27, v[196:199] offset:5184
    v_mfma_f32_16x16x32_bf16 v[200:203], a[44:47], a[248:251], v[200:203]
    ds_write_b128 v27, v[212:215] offset:5248
    v_mfma_f32_16x16x32_bf16 v[216:219], a[48:51], a[248:251], v[216:219]
    ds_write_b128 v27, v[228:231] offset:5312
    v_mfma_f32_16x16x32_bf16 v[232:235], a[52:55], a[248:251], v[232:235]
    ds_write_b128 v27, v[244:247] offset:5376
    v_mfma_f32_16x16x32_bf16 v[248:251], a[56:59], a[248:251], v[248:251]
    v_mfma_f32_16x16x32_bf16 v[188:191], a[20:23], v[84:87], v[188:191]
    v_mfma_f32_16x16x32_bf16 v[204:207], a[24:27], v[84:87], v[204:207]
    v_mfma_f32_16x16x32_bf16 v[220:223], a[28:31], v[84:87], v[220:223]
    v_mfma_f32_16x16x32_bf16 v[236:239], a[32:35], v[84:87], v[236:239]
    ds_write_b128 v27, v[184:187] offset:10240
    v_mfma_f32_16x16x32_bf16 v[252:255], a[36:39], v[84:87], v[252:255]
    v_mfma_f32_16x16x32_bf16 v[188:191], a[40:43], a[252:255], v[188:191]
    ds_write_b128 v27, v[200:203] offset:10304
    v_mfma_f32_16x16x32_bf16 v[204:207], a[44:47], a[252:255], v[204:207]
    ds_write_b128 v27, v[216:219] offset:10368
    v_mfma_f32_16x16x32_bf16 v[220:223], a[48:51], a[252:255], v[220:223]
    ds_write_b128 v27, v[232:235] offset:10432
    v_mfma_f32_16x16x32_bf16 v[236:239], a[52:55], a[252:255], v[236:239]
    ds_write_b128 v27, v[248:251] offset:10496
    v_mfma_f32_16x16x32_bf16 v[252:255], a[56:59], a[252:255], v[252:255]
    s_cmp_eq_u64 s[36:37], s[84:85]
    s_cbranch_scc1 L_xd_ssm
L_xp_ssm:
    s_sub_u32 s81, s81, 1
    s_cbranch_scc1 L_end
    s_load_dwordx2 s[36:37], s[48:49], s78 glc
    s_waitcnt lgkmcnt(0)
    s_cmp_eq_u64 s[36:37], s[84:85]
    s_cbranch_scc0 L_xp_ssm
    buffer_load_dwordx4 v[40:43], v26, s[60:63], s86 offen offset:0 sc1
    buffer_load_dwordx4 v[44:47], v26, s[60:63], s86 offen offset:1024 sc1
    buffer_load_dwordx4 v[48:51], v26, s[60:63], s86 offen offset:2048 sc1
    buffer_load_dwordx4 v[52:55], v26, s[60:63], s86 offen offset:3072 sc1
    buffer_load_dwordx4 v[56:59], v26, s[60:63], s77 offen offset:0 sc1
L_xd_ssm:
    s_nop 2
    ds_write_b128 v27, v[188:191] offset:15360
    ds_write_b128 v27, v[204:207] offset:15424
    ds_write_b128 v27, v[220:223] offset:15488
    ds_write_b128 v27, v[236:239] offset:15552
    ds_write_b128 v27, v[252:255] offset:15616
    s_waitcnt lgkmcnt(0)
    s_barrier
    ds_read_b128 v[96:99], v88 offset:0
    ds_read_b128 v[100:103], v89 offset:0
    ds_read_b128 v[104:107], v90 offset:0
    ds_read_b128 v[108:111], v91 offset:0
    ds_read_b128 v[112:115], v88 offset:64
    ds_read_b128 v[116:119], v89 offset:64
    ds_read_b128 v[120:123], v90 offset:64
    ds_read_b128 v[124:127], v91 offset:64
    ds_read_b128 v[128:131], v88 offset:128
    ds_read_b128 v[132:135], v89 offset:128
    ds_read_b128 v[136:139], v90 offset:128
    ds_read_b128 v[140:143], v91 offset:128
    ds_read_b128 v[144:147], v88 offset:192
    ds_read_b128 v[148:151], v89 offset:192
    ds_read_b128 v[152:155], v90 offset:192
    ds_read_b128 v[156:159], v91 offset:192
    ds_read_b128 v[160:163], v88 offset:256
    ds_read_b128 v[164:167], v89 offset:256
    ds_read_b128 v[168:171], v90 offset:256
    ds_read_b128 v[172:175], v91 offset:256
    s_waitcnt lgkmcnt(15)
    v_pk_add_f32 v[96:97], v[96:97], v[100:101]
    v_pk_add_f32 v[98:99], v[98:99], v[102:103]
    v_pk_add_f32 v[104:105], v[104:105], v[108:109]
    v_pk_add_f32 v[106:107], v[106:107], v[110:111]
    v_pk_add_f32 v[4:5], v[4:5], v[96:97]
    v_pk_add_f32 v[6:7], v[6:7], v[98:99]
    v_pk_add_f32 v[4:5], v[4:5], v[104:105]
    v_pk_add_f32 v[6:7], v[6:7], v[106:107]
    s_waitcnt lgkmcnt(12)
    v_pk_add_f32 v[112:113], v[112:113], v[116:117]
    v_pk_add_f32 v[114:115], v[114:115], v[118:119]
    v_pk_add_f32 v[120:121], v[120:121], v[124:125]
    v_pk_add_f32 v[122:123], v[122:123], v[126:127]
    v_pk_add_f32 v[8:9], v[8:9], v[112:113]
    v_pk_add_f32 v[10:11], v[10:11], v[114:115]
    v_pk_add_f32 v[8:9], v[8:9], v[120:121]
    v_pk_add_f32 v[10:11], v[10:11], v[122:123]
    s_waitcnt lgkmcnt(8)
    v_pk_add_f32 v[128:129], v[128:129], v[132:133]
    v_pk_add_f32 v[130:131], v[130:131], v[134:135]
    v_pk_add_f32 v[136:137], v[136:137], v[140:141]
    v_pk_add_f32 v[138:139], v[138:139], v[142:143]
    v_pk_add_f32 v[12:13], v[12:13], v[128:129]
    v_pk_add_f32 v[14:15], v[14:15], v[130:131]
    v_pk_add_f32 v[12:13], v[12:13], v[136:137]
    v_pk_add_f32 v[14:15], v[14:15], v[138:139]
    s_waitcnt lgkmcnt(4)
    v_pk_add_f32 v[144:145], v[144:145], v[148:149]
    v_pk_add_f32 v[146:147], v[146:147], v[150:151]
    v_pk_add_f32 v[152:153], v[152:153], v[156:157]
    v_pk_add_f32 v[154:155], v[154:155], v[158:159]
    v_pk_add_f32 v[16:17], v[16:17], v[144:145]
    v_pk_add_f32 v[18:19], v[18:19], v[146:147]
    v_pk_add_f32 v[16:17], v[16:17], v[152:153]
    v_pk_add_f32 v[18:19], v[18:19], v[154:155]
    s_waitcnt lgkmcnt(0)
    v_pk_add_f32 v[160:161], v[160:161], v[164:165]
    v_pk_add_f32 v[162:163], v[162:163], v[166:167]
    v_pk_add_f32 v[168:169], v[168:169], v[172:173]
    v_pk_add_f32 v[170:171], v[170:171], v[174:175]
    v_pk_add_f32 v[20:21], v[20:21], v[160:161]
    v_pk_add_f32 v[22:23], v[22:23], v[162:163]
    v_pk_add_f32 v[20:21], v[20:21], v[168:169]
    v_pk_add_f32 v[22:23], v[22:23], v[170:171]
    s_waitcnt vmcnt(0)
    v_pk_add_f32 v[4:5], v[4:5], v[40:41]
    v_pk_add_f32 v[6:7], v[6:7], v[42:43]
    buffer_store_dwordx4 v[4:7], v38, s[56:59], s76 offen offset:0 nt
    v_pk_add_f32 v[8:9], v[8:9], v[44:45]
    v_pk_add_f32 v[10:11], v[10:11], v[46:47]
    buffer_store_dwordx4 v[8:11], v38, s[56:59], s76 offen offset:64 nt
    v_pk_add_f32 v[12:13], v[12:13], v[48:49]
    v_pk_add_f32 v[14:15], v[14:15], v[50:51]
    buffer_store_dwordx4 v[12:15], v38, s[56:59], s76 offen offset:128 nt
    v_pk_add_f32 v[16:17], v[16:17], v[52:53]
    v_pk_add_f32 v[18:19], v[18:19], v[54:55]
    buffer_store_dwordx4 v[16:19], v38, s[56:59], s76 offen offset:192 nt
    v_pk_add_f32 v[20:21], v[20:21], v[56:57]
    v_pk_add_f32 v[22:23], v[22:23], v[58:59]
    buffer_store_dwordx4 v[20:23], v38, s[56:59], s76 offen offset:256 nt
    s_endpgm
L_mlp:
    v_and_b32 v2, 15, v1
    v_lshrrev_b32 v3, 4, v1
    v_lshlrev_b32 v26, 4, v1
    s_xor_b32 s50, s4, s5
    s_xor_b32 s88, s8, 1
    s_mov_b32 s81, 0x40000
    s_and_b32 s14, s2, 127
    s_sub_u32 s78, 127, s14
    s_cmp_lt_u32 s78, 96
    s_cselect_b32 s78, s78, 0
    s_cselect_b32 s89, 0, 67108864
    s_lshl_b32 s14, s50, 2
    v_add_u32 v44, s14, v3
    v_lshrrev_b32 v45, 1, v2
    v_xor_b32 v45, v44, v45
    v_lshlrev_b32 v45, 4, v45
    v_lshl_add_u32 v45, v2, 7, v45
    s_lshl_b32 s13, s5, 13
    s_add_u32 s13, s13, 40960
    v_add_u32 v6, s13, v45
    v_xor_b32 v7, 64, v6
    v_lshrrev_b32 v40, 2, v2
    v_lshl_add_u32 v41, v3, 3, v40
    v_lshlrev_b32 v41, 7, v41
    v_and_b32 v42, 3, v2
    v_lshl_add_u32 v41, v42, 3, v41
    v_lshrrev_b32 v40, 1, v40
    v_and_b32 v42, 1, v3
    v_lshl_add_u32 v40, v42, 1, v40
    s_lshl_b32 s12, s50, 12
    s_add_u32 s12, s12, 90112
    v_add_u32 v41, s12, v41
    s_mul_i32 s14, s4, 6
    s_add_u32 s15, s14, 0
    s_lshr_b32 s12, s15, 2
    s_lshl_b32 s12, s12, 13
    s_and_b32 s15, s15, 3
    v_xor_b32 v42, s15, v40
    v_lshl_add_u32 v42, v42, 5, v41
    v_add_u32 v14, s12, v42
    v_xor_b32 v18, 4096, v14
    s_add_u32 s15, s14, 1
    s_lshr_b32 s12, s15, 2
    s_lshl_b32 s12, s12, 13
    s_and_b32 s15, s15, 3
    v_xor_b32 v42, s15, v40
    v_lshl_add_u32 v42, v42, 5, v41
    v_add_u32 v15, s12, v42
    v_xor_b32 v19, 4096, v15
    s_add_u32 s15, s14, 2
    s_lshr_b32 s12, s15, 2
    s_lshl_b32 s12, s12, 13
    s_and_b32 s15, s15, 3
    v_xor_b32 v42, s15, v40
    v_lshl_add_u32 v42, v42, 5, v41
    v_add_u32 v16, s12, v42
    v_xor_b32 v20, 4096, v16
    s_add_u32 s15, s14, 3
    s_lshr_b32 s12, s15, 2
    s_lshl_b32 s12, s12, 13
    s_and_b32 s15, s15, 3
    v_xor_b32 v42, s15, v40
    v_lshl_add_u32 v42, v42, 5, v41
    v_add_u32 v17, s12, v42
    v_xor_b32 v21, 4096, v17
    s_mov_b32 s82, 0xbdd2d3e8
    s_mov_b32 s83, 0xc0135761
    v_mov_b32 v46, 0x3f803f80
    v_cmp_eq_u32 vcc, 0, v2
    s_nop 1
    v_cndmask_b32 v46, 0, v46, vcc
    v_accvgpr_write_b32 a80, v46
    v_accvgpr_write_b32 a81, v46
    v_accvgpr_write_b32 a82, v46
    v_accvgpr_write_b32 a83, v46
    s_lshl_b32 s12, s8, 3
    s_add_u32 s12, s12, s7
    s_lshl_b32 s12, s12, 2
    s_add_u32 s12, s12, s3
    s_lshl_b32 s12, s12, 1
    s_lshl_b32 s13, s6, 7
    s_add_u32 s87, s12, s13
    s_mul_i32 s86, s87, 1280
    v_lshrrev_b32 v134, 5, v1
    v_mul_u32_u24 v134, 1280, v134
    v_and_b32 v135, 31, v1
    v_lshl_add_u32 v135, v135, 3, v134
    v_lshlrev_b32 v137, 1, v135
    v_sub_u32 v134, v137, v134
    v_lshrrev_b32 v40, 3, v1
    v_and_b32 v41, 7, v1
    v_mul_u32_u24 v40, 1280, v40
    v_lshl_add_u32 v40, v41, 4, v40
    v_or_b32 v11, s89, v40
    v_or_b32 v27, s89, v26
    s_lshl_b32 s12, s4, 26
    v_or_b32 v121, s12, v27
    s_lshl_b32 s80, s3, 10
    s_and_b32 s12, s78, 1
    s_lshr_b32 s13, s78, 1
    s_mov_b32 s67, 0x20000
    s_mov_b32 s64, s40
    s_mov_b32 s65, s41
    s_mov_b32 s66, 1966080
    s_lshl_b32 s14, s13, 2
    s_add_u32 s14, s14, s3
    s_mul_i32 s79, s14, 10240
    s_mul_i32 s14, s13, 5462
    s_lshr_b32 s14, s14, 16
    s_mul_i32 s14, s14, 10
    s_add_u32 s13, s13, s14
    s_mul_i32 s13, s13, 5120
    s_add_u32 s13, s13, 12582912
    s_mul_i32 s14, s12, 20
    s_add_u32 s14, s14, s3
    s_add_u32 s14, s14, 0
    s_mul_i32 s15, s14, 13108
    s_lshr_b32 s15, s15, 16
    s_mul_i32 s15, s15, 435
    s_add_u32 s15, s15, s14
    s_lshl_b32 s15, s15, 10
    s_add_u32 s92, s15, s13
    s_add_u32 s14, s14, 4
    s_mul_i32 s15, s14, 13108
    s_lshr_b32 s15, s15, 16
    s_mul_i32 s15, s15, 435
    s_add_u32 s15, s15, s14
    s_lshl_b32 s15, s15, 10
    s_add_u32 s93, s15, s13
    s_add_u32 s14, s14, 4
    s_mul_i32 s15, s14, 13108
    s_lshr_b32 s15, s15, 16
    s_mul_i32 s15, s15, 435
    s_add_u32 s15, s15, s14
    s_lshl_b32 s15, s15, 10
    s_add_u32 s94, s15, s13
    s_add_u32 s14, s14, 4
    v_lshrrev_b32 v40, 2, v2
    v_lshl_add_u32 v40, v3, 2, v40
    v_lshlrev_b32 v40, 7, v40
    v_and_b32 v41, 3, v2
    v_lshl_add_u32 v40, v41, 3, v40
    s_lshl_b32 s14, s3, 5
    s_add_u32 s14, s14, 20480
    v_add_u32 v120, s14, v40
    s_mul_i32 s12, s12, 640
    s_add_u32 s79, s79, s12
    s_add_u32 s79, s79, 0
    s_lshl_b32 s78, s78, 1
    s_add_u32 s78, s78, 0
    s_mul_i32 s12, s7, 160
    s_mov_b32 s68, s32
    s_mov_b32 s69, s33
    s_mov_b32 s70, 1280
    s_mov_b32 s71, 0x20000
    s_mov_b32 m0, 20160
    s_mov_b32 exec_lo, 1023
    s_mov_b32 exec_hi, 0
    buffer_load_dwordx4 v26, s[68:71], s12 offen lds
    s_mov_b64 exec, -1
    s_mov_b32 s68, s42
    s_mov_b32 s69, s43
    s_mov_b32 s70, 1280
    s_mov_b32 s71, 0x20000
    s_mov_b32 m0, 20320
    s_mov_b32 exec_lo, 1023
    s_mov_b32 exec_hi, 0
    buffer_load_dwordx4 v26, s[68:71], s12 offen lds
    s_mov_b64 exec, -1
    s_mul_i32 s12, s7, 384
    s_mov_b32 s68, s38
    s_mov_b32 s69, s39
    s_mov_b32 s70, 3072
    s_mov_b32 s71, 0x20000
    s_mov_b32 m0, 2048
    s_mov_b32 exec_lo, 16777215
    s_mov_b32 exec_hi, 0
    buffer_load_dwordx4 v26, s[68:71], s12 offen lds
    s_mov_b64 exec, -1
    s_mov_b32 s68, s26
    s_mov_b32 s69, s27
    s_mov_b32 s70, 819200
    s_mov_b32 s71, 0x20000
    s_mov_b64 s[84:85], s[28:29]
    s_and_b32 s12, s2, 31
    s_lshl_b32 s12, s12, 2
    s_add_u32 s12, s12, s3
    s_mul_i32 s12, s12, 6400
    s_xor_b32 s13, s89, 67108864
    s_or_b32 s12, s12, s13
    v_min_u32 v98, 49, v1
    v_lshlrev_b32 v98, 7, v98
    v_add_u32 v98, s12, v98
    v_min_u32 v42, 47, v1
    s_mul_i32 s12, s3, 48
    s_lshr_b32 s13, s7, 1
    s_add_u32 s12, s12, s13
    s_lshl_b32 s12, s12, 7
    s_add_u32 s12, s12, 17842176
    v_lshrrev_b32 v40, 2, v42
    v_and_b32 v41, 3, v42
    v_lshlrev_b32 v40, 9, v40
    v_lshl_add_u32 v40, v41, 4, v40
    v_add_u32 v24, s12, v40
    s_and_b32 s14, s7, 3
    s_add_u32 s14, s14, s9
    s_and_b32 s14, s14, 3
    s_mul_i32 s14, s14, 12
    s_lshr_b32 s14, s14, 2
    s_sub_u32 s26, 12, s14
    s_mul_i32 s12, s3, 22
    s_add_u32 s12, s12, s14
    s_add_u32 s12, s12, 0
    s_mul_i32 s13, s7, 88
    s_add_u32 s13, s13, s12
    s_mul_i32 s13, s13, 5120
    s_add_u32 s18, s13, 12582912
    s_sub_u32 s19, s18, 61440
    s_lshl_b32 s13, s6, 1
    s_add_u32 s13, s13, s88
    s_mul_i32 s14, s13, 88
    s_add_u32 s14, s14, s12
    s_lshl_b32 s14, s14, 12
    s_add_u32 s24, s14, 4096
    s_sub_u32 s25, s24, 49152
    s_add_u32 s22, s24, 360448
    s_sub_u32 s23, s22, 49152
    s_mul_i32 s34, s3, 20480
    s_add_u32 s34, s34, 20480
    s_mul_i32 s12, s3, 384
    s_add_u32 s12, s12, 2560
    v_lshlrev_b32 v77, 4, v3
    v_add_u32 v76, s12, v77
    v_min_u32 v78, 1, v2
    v_mul_u32_u24 v78, 0x30000, v78
    v_add_u32 v76, v76, v78
    s_mul_i32 s12, s4, 768
    s_add_u32 s12, s12, 2560
    v_add_u32 v77, s12, v77
    s_lshl_b32 s12, s5, 10
    v_lshlrev_b32 v78, 6, v2
    v_add_u32 v78, s12, v78
    v_lshlrev_b32 v79, 3, v0
    s_mul_i32 s12, s4, 192
    v_lshlrev_b32 v43, 3, v3
    v_add_u32 v43, s12, v43
    s_lshl_b32 s12, s6, 4
    s_lshl_b32 s13, s8, 3
    s_add_u32 s12, s12, s13
    s_lshl_b32 s13, s3, 1
    s_add_u32 s13, s12, s13
    s_lshl_b32 s13, s13, 7
    s_lshl_b32 s15, s8, 5
    s_add_u32 s15, s15, 17891328
    s_add_u32 s32, s13, s15
    s_xor_b32 s33, s32, 32
    s_add_u32 s12, s12, s7
    s_lshl_b32 s12, s12, 7
    s_lshl_b32 s13, s3, 3
    s_add_u32 s12, s12, s13
    s_add_u32 s31, s12, s15
    s_xor_b32 s12, s3, 0
    s_lshl_b32 s12, s12, 10
    v_add_u32 v32, s12, v26
    s_xor_b32 s12, s3, 1
    s_lshl_b32 s12, s12, 10
    v_add_u32 v33, s12, v26
    s_xor_b32 s12, s3, 2
    s_lshl_b32 s12, s12, 10
    v_add_u32 v34, s12, v26
    s_xor_b32 s12, s3, 3
    s_lshl_b32 s12, s12, 10
    v_add_u32 v35, s12, v26
    s_lshl_b32 s12, s4, 6
    s_add_u32 s12, s12, s5
    s_lshl_b32 s13, s88, 1
    s_add_u32 s12, s12, s13
    s_lshl_b32 s13, s6, 7
    s_add_u32 s13, s13, s12
    s_mul_i32 s30, s13, 1280
    s_mul_i32 s13, s7, 160
    s_add_u32 s30, s30, s13
    s_lshl_b32 s12, s12, 4
    v_lshrrev_b32 v96, 2, v1
    v_and_b32 v39, 3, v1
    v_lshlrev_b32 v97, 3, v39
    v_mul_u32_u24 v38, 5120, v96
    v_add_u32 v38, v38, v97
    v_bfe_u32 v30, v96, 1, 2
    v_xor_b32 v39, v39, v30
    v_lshlrev_b32 v39, 4, v39
    s_movk_i32 s13, 320
    v_mad_u32_u24 v39, v96, s13, v39
    v_lshlrev_b32 v96, 6, v96
    v_add_u32 v96, s12, v96
    s_add_u32 s72, s72, 128
    s_add_u32 s75, s75, 196608
    s_add_u32 s76, s76, 196608
    s_add_u32 m0, s74, 114688
    s_nop 0
    buffer_load_dwordx4 v8, s[56:59], s75 offen offset:0  lds
    s_add_u32 m0, s73, 57344
    s_nop 0
    buffer_load_dwordx4 v4, s[52:55], s72 offen offset:0  lds
    s_add_u32 m0, s74, 122752
    s_nop 0
    buffer_load_dwordx4 v8, s[56:59], s75 offen offset:128  lds
    s_add_u32 m0, s73, 58368
    s_nop 0
    buffer_load_dwordx4 v5, s[52:55], s72 offen offset:0  lds
    s_add_u32 m0, s74, 130816
    s_nop 0
    buffer_load_dwordx4 v8, s[56:59], s75 offen offset:256  lds
    s_add_u32 m0, s74, 115712
    s_nop 0
    buffer_load_dwordx4 v9, s[56:59], s76 offen offset:0  lds
    s_add_u32 m0, s73, 58112
    s_nop 0
    buffer_load_dwordx4 v4, s[52:55], s72 offen offset:1280  lds
    s_add_u32 m0, s74, 123776
    s_nop 0
    buffer_load_dwordx4 v9, s[56:59], s76 offen offset:128  lds
    s_add_u32 m0, s73, 59136
    s_nop 0
    buffer_load_dwordx4 v5, s[52:55], s72 offen offset:1280  lds
    s_add_u32 m0, s74, 131840
    s_nop 0
    buffer_load_dwordx4 v9, s[56:59], s76 offen offset:256  lds
    s_waitcnt vmcnt(14)
    s_barrier
    ds_read_b64_tr_b16 a[0:1], v14 offset:0
    ds_read_b128 a[24:27], v6 offset:0
    ds_read_b64_tr_b16 a[2:3], v14 offset:512
    ds_read_b64_tr_b16 a[4:5], v15 offset:0
    ds_read_b64_tr_b16 a[6:7], v15 offset:512
    ds_read_b128 a[28:31], v6 offset:2048
    ds_read_b64_tr_b16 a[8:9], v16 offset:0
    ds_read_b64_tr_b16 a[10:11], v16 offset:512
    ds_read_b64_tr_b16 a[12:13], v17 offset:0
    ds_read_b128 a[32:35], v6 offset:4096
    ds_read_b64_tr_b16 a[14:15], v17 offset:512
    ds_read_b64_tr_b16 a[16:17], v14 offset:8192
    ds_read_b64_tr_b16 a[18:19], v14 offset:8704
    ds_read_b128 a[36:39], v6 offset:6144
    ds_read_b64_tr_b16 a[20:21], v15 offset:8192
    ds_read_b64_tr_b16 a[22:23], v15 offset:8704
    s_waitcnt lgkmcnt(0)
    v_mfma_f32_16x16x32_bf16 v[160:163], a[0:3], a[24:27], 0
    s_add_u32 s72, s72, 128
    ds_read_b64_tr_b16 a[40:41], v18 offset:0
    v_mfma_f32_16x16x32_bf16 v[164:167], a[0:3], a[28:31], 0
    v_mov_b32 v13, 0
    v_mfma_f32_16x16x32_bf16 v[168:171], a[0:3], a[32:35], 0
    s_add_u32 s75, s75, 196608
    ds_read_b128 a[64:67], v7 offset:0
    v_mfma_f32_16x16x32_bf16 v[172:175], a[0:3], a[36:39], 0
    s_add_u32 s76, s76, 196608
    ds_read_b64_tr_b16 a[42:43], v18 offset:512
    v_mfma_f32_16x16x32_bf16 v[176:179], a[4:7], a[24:27], 0
    s_add_u32 m0, s74, 139264
    ds_read_b64_tr_b16 a[44:45], v19 offset:0
    v_mfma_f32_16x16x32_bf16 v[180:183], a[4:7], a[28:31], 0
    buffer_load_dwordx4 v8, s[56:59], s75 offen offset:0  lds
    v_mfma_f32_16x16x32_bf16 v[184:187], a[4:7], a[32:35], 0
    ds_read_b64_tr_b16 a[46:47], v19 offset:512
    global_load_dword v13, v13, s[46:47] sc1
    v_mfma_f32_16x16x32_bf16 v[188:191], a[4:7], a[36:39], 0
    s_add_u32 m0, s73, 73728
    ds_read_b128 a[68:71], v7 offset:2048
    v_mfma_f32_16x16x32_bf16 v[192:195], a[8:11], a[24:27], 0
    buffer_load_dwordx4 v4, s[52:55], s72 offen offset:0  lds
    v_mfma_f32_16x16x32_bf16 v[196:199], a[8:11], a[28:31], 0
    ds_read_b64_tr_b16 a[48:49], v20 offset:0
    v_mfma_f32_16x16x32_bf16 v[200:203], a[8:11], a[32:35], 0
    s_add_u32 m0, s74, 147328
    ds_read_b64_tr_b16 a[50:51], v20 offset:512
    v_mfma_f32_16x16x32_bf16 v[204:207], a[8:11], a[36:39], 0
    buffer_load_dwordx4 v8, s[56:59], s75 offen offset:128  lds
    v_mfma_f32_16x16x32_bf16 v[208:211], a[12:15], a[24:27], 0
    ds_read_b64_tr_b16 a[52:53], v21 offset:0
    v_mfma_f32_16x16x32_bf16 v[212:215], a[12:15], a[28:31], 0
    ds_read_b128 a[72:75], v7 offset:4096
    v_mfma_f32_16x16x32_bf16 v[216:219], a[12:15], a[32:35], 0
    s_add_u32 m0, s73, 74752
    ds_read_b64_tr_b16 a[54:55], v21 offset:512
    v_mfma_f32_16x16x32_bf16 v[220:223], a[12:15], a[36:39], 0
    buffer_load_dwordx4 v5, s[52:55], s72 offen offset:0  lds
    v_mfma_f32_16x16x32_bf16 v[224:227], a[16:19], a[24:27], 0
    ds_read_b64_tr_b16 a[56:57], v18 offset:8192
    v_mfma_f32_16x16x32_bf16 v[228:231], a[16:19], a[28:31], 0
    s_add_u32 m0, s74, 155392
    ds_read_b64_tr_b16 a[58:59], v18 offset:8704
    v_mfma_f32_16x16x32_bf16 v[232:235], a[16:19], a[32:35], 0
    buffer_load_dwordx4 v8, s[56:59], s75 offen offset:256  lds
    v_mfma_f32_16x16x32_bf16 v[236:239], a[16:19], a[36:39], 0
    ds_read_b128 a[76:79], v7 offset:6144
    v_mfma_f32_16x16x32_bf16 v[240:243], a[20:23], a[24:27], 0
    s_add_u32 m0, s74, 140288
    ds_read_b64_tr_b16 a[60:61], v19 offset:8192
    v_mfma_f32_16x16x32_bf16 v[244:247], a[20:23], a[28:31], 0
    buffer_load_dwordx4 v9, s[56:59], s76 offen offset:0  lds
    v_mfma_f32_16x16x32_bf16 v[248:251], a[20:23], a[32:35], 0
    ds_read_b64_tr_b16 a[62:63], v19 offset:8704
    v_mfma_f32_16x16x32_bf16 v[252:255], a[20:23], a[36:39], 0
    s_waitcnt lgkmcnt(0)
    v_mfma_f32_16x16x32_bf16 v[160:163], a[40:43], a[64:67], v[160:163]
    v_mfma_f32_16x16x32_bf16 v[164:167], a[40:43], a[68:71], v[164:167]
    s_waitcnt vmcnt(7)
    s_barrier
    v_mfma_f32_16x16x32_bf16 v[168:171], a[40:43], a[72:75], v[168:171]
    s_add_u32 m0, s73, 74496
    ds_read_b64_tr_b16 a[0:1], v14 offset:24576
    v_mfma_f32_16x16x32_bf16 v[172:175], a[40:43], a[76:79], v[172:175]
    v_mfma_f32_16x16x32_bf16 v[176:179], a[44:47], a[64:67], v[176:179]
    buffer_load_dwordx4 v4, s[52:55], s72 offen offset:1280  lds
    v_mfma_f32_16x16x32_bf16 v[180:183], a[44:47], a[68:71], v[180:183]
    ds_read_b128 a[24:27], v6 offset:16384
    v_mfma_f32_16x16x32_bf16 v[184:187], a[44:47], a[72:75], v[184:187]
    ds_read_b64_tr_b16 a[2:3], v14 offset:25088
    v_mfma_f32_16x16x32_bf16 v[188:191], a[44:47], a[76:79], v[188:191]
    s_add_u32 m0, s74, 148352
    ds_read_b64_tr_b16 a[4:5], v15 offset:24576
    v_mfma_f32_16x16x32_bf16 v[192:195], a[48:51], a[64:67], v[192:195]
    buffer_load_dwordx4 v9, s[56:59], s76 offen offset:128  lds
    v_mfma_f32_16x16x32_bf16 v[196:199], a[48:51], a[68:71], v[196:199]
    ds_read_b64_tr_b16 a[6:7], v15 offset:25088
    v_mfma_f32_16x16x32_bf16 v[200:203], a[48:51], a[72:75], v[200:203]
    ds_read_b128 a[28:31], v6 offset:18432
    v_mfma_f32_16x16x32_bf16 v[204:207], a[48:51], a[76:79], v[204:207]
    s_add_u32 m0, s73, 75520
    ds_read_b64_tr_b16 a[8:9], v16 offset:24576
    v_mfma_f32_16x16x32_bf16 v[208:211], a[52:55], a[64:67], v[208:211]
    ds_read_b64_tr_b16 a[10:11], v16 offset:25088
    v_mfma_f32_16x16x32_bf16 v[212:215], a[52:55], a[68:71], v[212:215]
    buffer_load_dwordx4 v5, s[52:55], s72 offen offset:1280  lds
    v_mfma_f32_16x16x32_bf16 v[216:219], a[52:55], a[72:75], v[216:219]
    ds_read_b64_tr_b16 a[12:13], v17 offset:24576
    v_mfma_f32_16x16x32_bf16 v[220:223], a[52:55], a[76:79], v[220:223]
    ds_read_b128 a[32:35], v6 offset:20480
    v_mfma_f32_16x16x32_bf16 v[224:227], a[56:59], a[64:67], v[224:227]
    s_add_u32 m0, s74, 156416
    ds_read_b64_tr_b16 a[14:15], v17 offset:25088
    v_mfma_f32_16x16x32_bf16 v[228:231], a[56:59], a[68:71], v[228:231]
    buffer_load_dwordx4 v9, s[56:59], s76 offen offset:256  lds
    v_mfma_f32_16x16x32_bf16 v[232:235], a[56:59], a[72:75], v[232:235]
    ds_read_b64_tr_b16 a[16:17], v14 offset:32768
    v_mfma_f32_16x16x32_bf16 v[236:239], a[56:59], a[76:79], v[236:239]
    ds_read_b64_tr_b16 a[18:19], v14 offset:33280
    v_mfma_f32_16x16x32_bf16 v[240:243], a[60:63], a[64:67], v[240:243]
    s_add_u32 m0, s80, 20480
    ds_read_b128 a[36:39], v6 offset:22528
    v_mfma_f32_16x16x32_bf16 v[244:247], a[60:63], a[68:71], v[244:247]
    v_mfma_f32_16x16x32_bf16 v[248:251], a[60:63], a[72:75], v[248:251]
    buffer_load_dwordx4 v11, s[64:67], s79 offen offset:0  lds
    v_mfma_f32_16x16x32_bf16 v[252:255], a[60:63], a[76:79], v[252:255]
    ds_read_b64_tr_b16 a[20:21], v15 offset:32768
    v_mfma_f32_16x16x32_bf16 a[84:87], a[40:43], a[80:83], 0
    ds_read_b64_tr_b16 a[22:23], v15 offset:33280
    v_mfma_f32_16x16x32_bf16 a[88:91], a[44:47], a[80:83], 0
    s_add_u32 m0, s80, 24448
    v_mfma_f32_16x16x32_bf16 a[92:95], a[48:51], a[80:83], 0
    buffer_load_dwordx4 v11, s[64:67], s79 offen offset:128  lds
    v_mfma_f32_16x16x32_bf16 a[96:99], a[52:55], a[80:83], 0
    v_mfma_f32_16x16x32_bf16 a[100:103], a[56:59], a[80:83], 0
    v_mfma_f32_16x16x32_bf16 a[104:107], a[60:63], a[80:83], 0
    s_waitcnt lgkmcnt(0)
    v_mfma_f32_16x16x32_bf16 v[160:163], a[0:3], a[24:27], v[160:163]
    s_add_u32 m0, s80, 28416
    ds_read_b64_tr_b16 a[40:41], v18 offset:24576
    v_mfma_f32_16x16x32_bf16 v[164:167], a[0:3], a[28:31], v[164:167]
    v_mfma_f32_16x16x32_bf16 v[168:171], a[0:3], a[32:35], v[168:171]
    buffer_load_dwordx4 v11, s[64:67], s79 offen offset:256  lds
    v_mfma_f32_16x16x32_bf16 v[172:175], a[0:3], a[36:39], v[172:175]
    ds_read_b128 a[64:67], v7 offset:16384
    v_mfma_f32_16x16x32_bf16 v[176:179], a[4:7], a[24:27], v[176:179]
    s_add_u32 s72, s72, 128
    ds_read_b64_tr_b16 a[42:43], v18 offset:25088
    v_mfma_f32_16x16x32_bf16 v[180:183], a[4:7], a[28:31], v[180:183]
    s_add_u32 s75, s75, 196608
    ds_read_b64_tr_b16 a[44:45], v19 offset:24576
    v_mfma_f32_16x16x32_bf16 v[184:187], a[4:7], a[32:35], v[184:187]
    s_add_u32 s76, s76, 196608
    ds_read_b64_tr_b16 a[46:47], v19 offset:25088
    v_mfma_f32_16x16x32_bf16 v[188:191], a[4:7], a[36:39], v[188:191]
    s_add_u32 m0, s74, 90112
    ds_read_b128 a[68:71], v7 offset:18432
    v_mfma_f32_16x16x32_bf16 v[192:195], a[8:11], a[24:27], v[192:195]
    buffer_load_dwordx4 v8, s[56:59], s75 offen offset:0  lds
    v_mfma_f32_16x16x32_bf16 v[196:199], a[8:11], a[28:31], v[196:199]
    ds_read_b64_tr_b16 a[48:49], v20 offset:24576
    v_mfma_f32_16x16x32_bf16 v[200:203], a[8:11], a[32:35], v[200:203]
    s_add_u32 m0, s73, 40960
    ds_read_b64_tr_b16 a[50:51], v20 offset:25088
    v_mfma_f32_16x16x32_bf16 v[204:207], a[8:11], a[36:39], v[204:207]
    buffer_load_dwordx4 v4, s[52:55], s72 offen offset:0  lds
    v_mfma_f32_16x16x32_bf16 v[208:211], a[12:15], a[24:27], v[208:211]
    ds_read_b64_tr_b16 a[52:53], v21 offset:24576
    v_mfma_f32_16x16x32_bf16 v[212:215], a[12:15], a[28:31], v[212:215]
    ds_read_b128 a[72:75], v7 offset:20480
    v_mfma_f32_16x16x32_bf16 v[216:219], a[12:15], a[32:35], v[216:219]
    s_add_u32 m0, s74, 98176
    ds_read_b64_tr_b16 a[54:55], v21 offset:25088
    v_mfma_f32_16x16x32_bf16 v[220:223], a[12:15], a[36:39], v[220:223]
    buffer_load_dwordx4 v8, s[56:59], s75 offen offset:128  lds
    v_mfma_f32_16x16x32_bf16 v[224:227], a[16:19], a[24:27], v[224:227]
    ds_read_b64_tr_b16 a[56:57], v18 offset:32768
    v_mfma_f32_16x16x32_bf16 v[228:231], a[16:19], a[28:31], v[228:231]
    s_add_u32 m0, s73, 41984
    ds_read_b64_tr_b16 a[58:59], v18 offset:33280
    v_mfma_f32_16x16x32_bf16 v[232:235], a[16:19], a[32:35], v[232:235]
    buffer_load_dwordx4 v5, s[52:55], s72 offen offset:0  lds
    v_mfma_f32_16x16x32_bf16 v[236:239], a[16:19], a[36:39], v[236:239]
    ds_read_b128 a[76:79], v7 offset:22528
    v_mfma_f32_16x16x32_bf16 v[240:243], a[20:23], a[24:27], v[240:243]
    s_add_u32 m0, s74, 106240
    ds_read_b64_tr_b16 a[60:61], v19 offset:32768
    v_mfma_f32_16x16x32_bf16 v[244:247], a[20:23], a[28:31], v[244:247]
    buffer_load_dwordx4 v8, s[56:59], s75 offen offset:256  lds
    v_mfma_f32_16x16x32_bf16 v[248:251], a[20:23], a[32:35], v[248:251]
    ds_read_b64_tr_b16 a[62:63], v19 offset:33280
    v_mfma_f32_16x16x32_bf16 v[252:255], a[20:23], a[36:39], v[252:255]
    s_waitcnt lgkmcnt(0)
    v_mfma_f32_16x16x32_bf16 v[160:163], a[40:43], a[64:67], v[160:163]
    v_mfma_f32_16x16x32_bf16 v[164:167], a[40:43], a[68:71], v[164:167]
    s_waitcnt vmcnt(5)
    s_barrier
    v_readfirstlane_b32 s11, v13
    s_cmp_lg_u32 s11, 0
    s_cbranch_scc1 L_ncok_mlp
L_ncl_mlp:
    s_sleep 1
    global_load_dword v13, v13, s[46:47] sc1
    s_sub_u32 s81, s81, 1
    s_cbranch_scc1 L_end
    s_waitcnt vmcnt(0)
    v_readfirstlane_b32 s11, v13
    s_cmp_eq_u32 s11, 0
    s_cbranch_scc1 L_ncl_mlp
L_ncok_mlp:
    s_nop 0
    ds_read_b64_tr_b16 v[136:137], v120 offset:0
    ds_read_b64_tr_b16 v[138:139], v120 offset:2048
    ds_read_b64_tr_b16 v[140:141], v120 offset:4096
    ds_read_b64_tr_b16 v[142:143], v120 offset:6144
    ds_read_b64_tr_b16 v[144:145], v120 offset:8192
    ds_read_b64_tr_b16 v[146:147], v120 offset:10240
    v_mfma_f32_16x16x32_bf16 v[168:171], a[40:43], a[72:75], v[168:171]
    buffer_load_dwordx4 v[124:127], v134, s[52:55], s86 offen offset:0
    v_mfma_f32_16x16x32_bf16 v[172:175], a[40:43], a[76:79], v[172:175]
    ds_read_b64_tr_b16 a[0:1], v14 offset:49152
    v_mfma_f32_16x16x32_bf16 v[176:179], a[44:47], a[64:67], v[176:179]
    ds_read_b128 a[24:27], v6 offset:32768
    v_mfma_f32_16x16x32_bf16 v[180:183], a[44:47], a[68:71], v[180:183]
    buffer_load_dwordx4 v[128:131], v134, s[52:55], s86 offen offset:512
    v_mfma_f32_16x16x32_bf16 v[184:187], a[44:47], a[72:75], v[184:187]
    ds_read_b64_tr_b16 a[2:3], v14 offset:49664
    v_mfma_f32_16x16x32_bf16 v[188:191], a[44:47], a[76:79], v[188:191]
    ds_read_b64_tr_b16 a[4:5], v15 offset:49152
    v_mfma_f32_16x16x32_bf16 v[192:195], a[48:51], a[64:67], v[192:195]
    buffer_load_dwordx2 v[132:133], v135, s[52:55], s86 offen offset:1024
    v_mfma_f32_16x16x32_bf16 v[196:199], a[48:51], a[68:71], v[196:199]
    ds_read_b64_tr_b16 a[6:7], v15 offset:49664
    v_mfma_f32_16x16x32_bf16 v[200:203], a[48:51], a[72:75], v[200:203]
    s_add_u32 m0, s74, 91136
    ds_read_b128 a[28:31], v6 offset:34816
    v_mfma_f32_16x16x32_bf16 v[204:207], a[48:51], a[76:79], v[204:207]
    buffer_load_dwordx4 v9, s[56:59], s76 offen offset:0  lds
    v_mfma_f32_16x16x32_bf16 v[208:211], a[52:55], a[64:67], v[208:211]
    ds_read_b64_tr_b16 a[8:9], v16 offset:49152
    v_mfma_f32_16x16x32_bf16 v[212:215], a[52:55], a[68:71], v[212:215]
    ds_read_b64_tr_b16 a[10:11], v16 offset:49664
    v_mfma_f32_16x16x32_bf16 v[216:219], a[52:55], a[72:75], v[216:219]
    s_add_u32 m0, s73, 41728
    ds_read_b64_tr_b16 a[12:13], v17 offset:49152
    v_mfma_f32_16x16x32_bf16 v[220:223], a[52:55], a[76:79], v[220:223]
    buffer_load_dwordx4 v4, s[52:55], s72 offen offset:1280  lds
    v_mfma_f32_16x16x32_bf16 v[224:227], a[56:59], a[64:67], v[224:227]
    ds_read_b128 a[32:35], v6 offset:36864
    v_mfma_f32_16x16x32_bf16 v[228:231], a[56:59], a[68:71], v[228:231]
    ds_read_b64_tr_b16 a[14:15], v17 offset:49664
    v_mfma_f32_16x16x32_bf16 v[232:235], a[56:59], a[72:75], v[232:235]
    s_add_u32 m0, s74, 99200
    ds_read_b64_tr_b16 a[16:17], v14 offset:57344
    v_mfma_f32_16x16x32_bf16 v[236:239], a[56:59], a[76:79], v[236:239]
    buffer_load_dwordx4 v9, s[56:59], s76 offen offset:128  lds
    v_mfma_f32_16x16x32_bf16 v[240:243], a[60:63], a[64:67], v[240:243]
    ds_read_b64_tr_b16 a[18:19], v14 offset:57856
    v_mfma_f32_16x16x32_bf16 v[244:247], a[60:63], a[68:71], v[244:247]
    ds_read_b128 a[36:39], v6 offset:38912
    v_mfma_f32_16x16x32_bf16 v[248:251], a[60:63], a[72:75], v[248:251]
    s_add_u32 m0, s73, 42752
    ds_read_b64_tr_b16 a[20:21], v15 offset:57344
    v_mfma_f32_16x16x32_bf16 v[252:255], a[60:63], a[76:79], v[252:255]
    buffer_load_dwordx4 v5, s[52:55], s72 offen offset:1280  lds
    v_mfma_f32_16x16x32_bf16 a[84:87], a[40:43], a[80:83], a[84:87]
    ds_read_b64_tr_b16 a[22:23], v15 offset:57856
    v_mfma_f32_16x16x32_bf16 a[88:91], a[44:47], a[80:83], a[88:91]
    v_mfma_f32_16x16x32_bf16 a[92:95], a[48:51], a[80:83], a[92:95]
    s_add_u32 m0, s74, 107264
    v_mfma_f32_16x16x32_bf16 a[96:99], a[52:55], a[80:83], a[96:99]
    buffer_load_dwordx4 v9, s[56:59], s76 offen offset:256  lds
    v_mfma_f32_16x16x32_bf16 a[100:103], a[56:59], a[80:83], a[100:103]
    v_mfma_f32_16x16x32_bf16 a[104:107], a[60:63], a[80:83], a[104:107]
    s_waitcnt lgkmcnt(0)
    buffer_store_dwordx4 v[136:139], v27, s[60:63], s92 offen sc1
    v_mfma_f32_16x16x32_bf16 v[160:163], a[0:3], a[24:27], v[160:163]
    s_add_u32 s72, s72, 128
    ds_read_b64_tr_b16 a[40:41], v18 offset:49152
    v_mfma_f32_16x16x32_bf16 v[164:167], a[0:3], a[28:31], v[164:167]
    s_waitcnt vmcnt(6)
    v_lshlrev_b32 v65, 16, v124
    v_mfma_f32_16x16x32_bf16 v[168:171], a[0:3], a[32:35], v[168:171]
    s_add_u32 s75, s75, 196608
    ds_read_b128 a[64:67], v7 offset:32768
    v_mfma_f32_16x16x32_bf16 v[172:175], a[0:3], a[36:39], v[172:175]
    s_add_u32 s76, s76, 196608
    ds_read_b64_tr_b16 a[42:43], v18 offset:49664
    v_mfma_f32_16x16x32_bf16 v[176:179], a[4:7], a[24:27], v[176:179]
    s_add_u32 m0, s74, 114688
    ds_read_b64_tr_b16 a[44:45], v19 offset:49152
    v_mfma_f32_16x16x32_bf16 v[180:183], a[4:7], a[28:31], v[180:183]
    ds_read_b64_tr_b16 a[46:47], v19 offset:49664
    v_and_b32 v66, 0xffff0000, v124
    v_mfma_f32_16x16x32_bf16 v[184:187], a[4:7], a[32:35], v[184:187]
    buffer_load_dwordx4 v8, s[56:59], s75 offen offset:0  lds
    v_mfma_f32_16x16x32_bf16 v[188:191], a[4:7], a[36:39], v[188:191]
    ds_read_b128 a[68:71], v7 offset:34816
    v_mov_b32 v60, v65
    v_mfma_f32_16x16x32_bf16 v[192:195], a[8:11], a[24:27], v[192:195]
    s_add_u32 m0, s73, 57344
    ds_read_b64_tr_b16 a[48:49], v20 offset:49152
    v_mfma_f32_16x16x32_bf16 v[196:199], a[8:11], a[28:31], v[196:199]
    buffer_load_dwordx4 v4, s[52:55], s72 offen offset:0  lds
    v_mfma_f32_16x16x32_bf16 v[200:203], a[8:11], a[32:35], v[200:203]
    ds_read_b64_tr_b16 a[50:51], v20 offset:49664
    v_mov_b32 v62, v66
    v_mfma_f32_16x16x32_bf16 v[204:207], a[8:11], a[36:39], v[204:207]
    ds_read_b64_tr_b16 a[52:53], v21 offset:49152
    v_mul_f32 v61, v65, v65
    v_mfma_f32_16x16x32_bf16 v[208:211], a[12:15], a[24:27], v[208:211]
    s_add_u32 m0, s74, 122752
    ds_read_b128 a[72:75], v7 offset:36864
    v_mfma_f32_16x16x32_bf16 v[212:215], a[12:15], a[28:31], v[212:215]
    buffer_load_dwordx4 v8, s[56:59], s75 offen offset:128  lds
    v_mfma_f32_16x16x32_bf16 v[216:219], a[12:15], a[32:35], v[216:219]
    ds_read_b64_tr_b16 a[54:55], v21 offset:49664
    v_mul_f32 v63, v66, v66
    v_mfma_f32_16x16x32_bf16 v[220:223], a[12:15], a[36:39], v[220:223]
    ds_read_b64_tr_b16 a[56:57], v18 offset:57344
    v_lshlrev_b32 v65, 16, v125
    v_mfma_f32_16x16x32_bf16 v[224:227], a[16:19], a[24:27], v[224:227]
    s_add_u32 m0, s73, 58368
    ds_read_b64_tr_b16 a[58:59], v18 offset:57856
    v_mfma_f32_16x16x32_bf16 v[228:231], a[16:19], a[28:31], v[228:231]
    buffer_load_dwordx4 v5, s[52:55], s72 offen offset:0  lds
    v_mfma_f32_16x16x32_bf16 v[232:235], a[16:19], a[32:35], v[232:235]
    ds_read_b128 a[76:79], v7 offset:38912
    v_and_b32 v66, 0xffff0000, v125
    v_mfma_f32_16x16x32_bf16 v[236:239], a[16:19], a[36:39], v[236:239]
    ds_read_b64_tr_b16 a[60:61], v19 offset:57344
    v_add_f32 v60, v60, v65
    v_mfma_f32_16x16x32_bf16 v[240:243], a[20:23], a[24:27], v[240:243]
    s_add_u32 m0, s74, 130816
    ds_read_b64_tr_b16 a[62:63], v19 offset:57856
    v_mfma_f32_16x16x32_bf16 v[244:247], a[20:23], a[28:31], v[244:247]
    buffer_load_dwordx4 v8, s[56:59], s75 offen offset:256  lds
    v_mfma_f32_16x16x32_bf16 v[248:251], a[20:23], a[32:35], v[248:251]
    v_add_f32 v62, v62, v66
    v_fmac_f32 v61, v65, v65
    v_mfma_f32_16x16x32_bf16 v[252:255], a[20:23], a[36:39], v[252:255]
    v_fmac_f32 v63, v66, v66
    v_lshlrev_b32 v65, 16, v126
    s_waitcnt lgkmcnt(0)
    v_mfma_f32_16x16x32_bf16 v[160:163], a[40:43], a[64:67], v[160:163]
    v_mfma_f32_16x16x32_bf16 v[164:167], a[40:43], a[68:71], v[164:167]
    s_waitcnt vmcnt(6)
    s_barrier
    v_mfma_f32_16x16x32_bf16 v[168:171], a[40:43], a[72:75], v[168:171]
    s_add_u32 m0, s74, 115712
    ds_read_b64_tr_b16 a[0:1], v14 offset:0
    v_mfma_f32_16x16x32_bf16 v[172:175], a[40:43], a[76:79], v[172:175]
    v_and_b32 v66, 0xffff0000, v126
    v_add_f32 v60, v60, v65
    v_mfma_f32_16x16x32_bf16 v[176:179], a[44:47], a[64:67], v[176:179]
    buffer_load_dwordx4 v9, s[56:59], s76 offen offset:0  lds
    v_mfma_f32_16x16x32_bf16 v[180:183], a[44:47], a[68:71], v[180:183]
    ds_read_b128 a[24:27], v6 offset:0
    v_add_f32 v62, v62, v66
    v_mfma_f32_16x16x32_bf16 v[184:187], a[44:47], a[72:75], v[184:187]
    s_add_u32 m0, s73, 58112
    ds_read_b64_tr_b16 a[2:3], v14 offset:512
    v_mfma_f32_16x16x32_bf16 v[188:191], a[44:47], a[76:79], v[188:191]
    ds_read_b64_tr_b16 a[4:5], v15 offset:0
    v_fmac_f32 v61, v65, v65
    v_mfma_f32_16x16x32_bf16 v[192:195], a[48:51], a[64:67], v[192:195]
    buffer_load_dwordx4 v4, s[52:55], s72 offen offset:1280  lds
    v_mfma_f32_16x16x32_bf16 v[196:199], a[48:51], a[68:71], v[196:199]
    ds_read_b64_tr_b16 a[6:7], v15 offset:512
    v_fmac_f32 v63, v66, v66
    v_mfma_f32_16x16x32_bf16 v[200:203], a[48:51], a[72:75], v[200:203]
    s_add_u32 m0, s74, 123776
    ds_read_b128 a[28:31], v6 offset:2048
    v_mfma_f32_16x16x32_bf16 v[204:207], a[48:51], a[76:79], v[204:207]
    buffer_load_dwordx4 v9, s[56:59], s76 offen offset:128  lds
    v_mfma_f32_16x16x32_bf16 v[208:211], a[52:55], a[64:67], v[208:211]
    ds_read_b64_tr_b16 a[8:9], v16 offset:0
    v_lshlrev_b32 v65, 16, v127
    v_mfma_f32_16x16x32_bf16 v[212:215], a[52:55], a[68:71], v[212:215]
    ds_read_b64_tr_b16 a[10:11], v16 offset:512
    v_and_b32 v66, 0xffff0000, v127
    v_mfma_f32_16x16x32_bf16 v[216:219], a[52:55], a[72:75], v[216:219]
    s_add_u32 m0, s73, 59136
    ds_read_b64_tr_b16 a[12:13], v17 offset:0
    v_mfma_f32_16x16x32_bf16 v[220:223], a[52:55], a[76:79], v[220:223]
    buffer_load_dwordx4 v5, s[52:55], s72 offen offset:1280  lds
    v_mfma_f32_16x16x32_bf16 v[224:227], a[56:59], a[64:67], v[224:227]
    ds_read_b128 a[32:35], v6 offset:4096
    v_add_f32 v60, v60, v65
    v_mfma_f32_16x16x32_bf16 v[228:231], a[56:59], a[68:71], v[228:231]
    ds_read_b64_tr_b16 a[14:15], v17 offset:512
    v_add_f32 v62, v62, v66
    v_mfma_f32_16x16x32_bf16 v[232:235], a[56:59], a[72:75], v[232:235]
    s_add_u32 m0, s74, 131840
    ds_read_b64_tr_b16 a[16:17], v14 offset:8192
    v_mfma_f32_16x16x32_bf16 v[236:239], a[56:59], a[76:79], v[236:239]
    buffer_load_dwordx4 v9, s[56:59], s76 offen offset:256  lds
    v_mfma_f32_16x16x32_bf16 v[240:243], a[60:63], a[64:67], v[240:243]
    ds_read_b64_tr_b16 a[18:19], v14 offset:8704
    v_fmac_f32 v61, v65, v65
    v_mfma_f32_16x16x32_bf16 v[244:247], a[60:63], a[68:71], v[244:247]
    ds_read_b128 a[36:39], v6 offset:6144
    v_fmac_f32 v63, v66, v66
    v_mfma_f32_16x16x32_bf16 v[248:251], a[60:63], a[72:75], v[248:251]
    s_add_u32 s72, s72, 128
    ds_read_b64_tr_b16 a[20:21], v15 offset:8192
    v_mfma_f32_16x16x32_bf16 v[252:255], a[60:63], a[76:79], v[252:255]
    s_add_u32 s75, s75, 196608
    ds_read_b64_tr_b16 a[22:23], v15 offset:8704
    v_mfma_f32_16x16x32_bf16 a[84:87], a[40:43], a[80:83], a[84:87]
    s_add_u32 s76, s76, 196608
    v_lshlrev_b32 v65, 16, v128
    v_mfma_f32_16x16x32_bf16 a[88:91], a[44:47], a[80:83], a[88:91]
    v_and_b32 v66, 0xffff0000, v128
    v_add_f32 v60, v60, v65
    v_mfma_f32_16x16x32_bf16 a[92:95], a[48:51], a[80:83], a[92:95]
    s_add_u32 m0, s74, 139264
    v_add_f32 v62, v62, v66
    v_mfma_f32_16x16x32_bf16 a[96:99], a[52:55], a[80:83], a[96:99]
    buffer_load_dwordx4 v8, s[56:59], s75 offen offset:0  lds
    v_mfma_f32_16x16x32_bf16 a[100:103], a[56:59], a[80:83], a[100:103]
    v_fmac_f32 v61, v65, v65
    v_fmac_f32 v63, v66, v66
    v_mfma_f32_16x16x32_bf16 a[104:107], a[60:63], a[80:83], a[104:107]
    v_lshlrev_b32 v65, 16, v129
    v_and_b32 v66, 0xffff0000, v129
    s_waitcnt lgkmcnt(0)
    buffer_store_dwordx4 v[140:143], v27, s[60:63], s93 offen sc1
    v_mfma_f32_16x16x32_bf16 v[160:163], a[0:3], a[24:27], v[160:163]
    s_add_u32 m0, s73, 73728
    ds_read_b64_tr_b16 a[40:41], v18 offset:0
    v_mfma_f32_16x16x32_bf16 v[164:167], a[0:3], a[28:31], v[164:167]
    v_add_f32 v60, v60, v65
    v_add_f32 v62, v62, v66
    v_mfma_f32_16x16x32_bf16 v[168:171], a[0:3], a[32:35], v[168:171]
    buffer_load_dwordx4 v4, s[52:55], s72 offen offset:0  lds
    v_mfma_f32_16x16x32_bf16 v[172:175], a[0:3], a[36:39], v[172:175]
    ds_read_b128 a[64:67], v7 offset:0
    v_fmac_f32 v61, v65, v65
    v_mfma_f32_16x16x32_bf16 v[176:179], a[4:7], a[24:27], v[176:179]
    ds_read_b64_tr_b16 a[42:43], v18 offset:512
    v_fmac_f32 v63, v66, v66
    v_mfma_f32_16x16x32_bf16 v[180:183], a[4:7], a[28:31], v[180:183]
    ds_read_b64_tr_b16 a[44:45], v19 offset:0
    v_lshlrev_b32 v65, 16, v130
    v_mfma_f32_16x16x32_bf16 v[184:187], a[4:7], a[32:35], v[184:187]
    s_add_u32 m0, s74, 147328
    ds_read_b64_tr_b16 a[46:47], v19 offset:512
    v_mfma_f32_16x16x32_bf16 v[188:191], a[4:7], a[36:39], v[188:191]
    ds_read_b128 a[68:71], v7 offset:2048
    v_and_b32 v66, 0xffff0000, v130
    v_mfma_f32_16x16x32_bf16 v[192:195], a[8:11], a[24:27], v[192:195]
    buffer_load_dwordx4 v8, s[56:59], s75 offen offset:128  lds
    v_mfma_f32_16x16x32_bf16 v[196:199], a[8:11], a[28:31], v[196:199]
    ds_read_b64_tr_b16 a[48:49], v20 offset:0
    v_add_f32 v60, v60, v65
    v_mfma_f32_16x16x32_bf16 v[200:203], a[8:11], a[32:35], v[200:203]
    ds_read_b64_tr_b16 a[50:51], v20 offset:512
    v_add_f32 v62, v62, v66
    v_mfma_f32_16x16x32_bf16 v[204:207], a[8:11], a[36:39], v[204:207]
    ds_read_b64_tr_b16 a[52:53], v21 offset:0
    v_fmac_f32 v61, v65, v65
    v_mfma_f32_16x16x32_bf16 v[208:211], a[12:15], a[24:27], v[208:211]
    s_add_u32 m0, s73, 74752
    ds_read_b128 a[72:75], v7 offset:4096
    v_mfma_f32_16x16x32_bf16 v[212:215], a[12:15], a[28:31], v[212:215]
    ds_read_b64_tr_b16 a[54:55], v21 offset:512
    v_fmac_f32 v63, v66, v66
    v_mfma_f32_16x16x32_bf16 v[216:219], a[12:15], a[32:35], v[216:219]
    buffer_load_dwordx4 v5, s[52:55], s72 offen offset:0  lds
    v_mfma_f32_16x16x32_bf16 v[220:223], a[12:15], a[36:39], v[220:223]
    ds_read_b64_tr_b16 a[56:57], v18 offset:8192
    v_lshlrev_b32 v65, 16, v131
    v_mfma_f32_16x16x32_bf16 v[224:227], a[16:19], a[24:27], v[224:227]
    ds_read_b64_tr_b16 a[58:59], v18 offset:8704
    v_and_b32 v66, 0xffff0000, v131
    v_mfma_f32_16x16x32_bf16 v[228:231], a[16:19], a[28:31], v[228:231]
    ds_read_b128 a[76:79], v7 offset:6144
    v_add_f32 v60, v60, v65
    v_mfma_f32_16x16x32_bf16 v[232:235], a[16:19], a[32:35], v[232:235]
    s_add_u32 m0, s74, 155392
    ds_read_b64_tr_b16 a[60:61], v19 offset:8192
    v_mfma_f32_16x16x32_bf16 v[236:239], a[16:19], a[36:39], v[236:239]
    ds_read_b64_tr_b16 a[62:63], v19 offset:8704
    v_add_f32 v62, v62, v66
    v_mfma_f32_16x16x32_bf16 v[240:243], a[20:23], a[24:27], v[240:243]
    buffer_load_dwordx4 v8, s[56:59], s75 offen offset:256  lds
    v_mfma_f32_16x16x32_bf16 v[244:247], a[20:23], a[28:31], v[244:247]
    v_fmac_f32 v61, v65, v65
    v_fmac_f32 v63, v66, v66
    v_mfma_f32_16x16x32_bf16 v[248:251], a[20:23], a[32:35], v[248:251]
    v_lshlrev_b32 v65, 16, v132
    v_and_b32 v66, 0xffff0000, v132
    v_mfma_f32_16x16x32_bf16 v[252:255], a[20:23], a[36:39], v[252:255]
    v_add_f32 v60, v60, v65
    v_add_f32 v62, v62, v66
    s_waitcnt lgkmcnt(0)
    v_mfma_f32_16x16x32_bf16 v[160:163], a[40:43], a[64:67], v[160:163]
    v_mfma_f32_16x16x32_bf16 v[164:167], a[40:43], a[68:71], v[164:167]
    s_waitcnt vmcnt(6)
    s_barrier
    v_mfma_f32_16x16x32_bf16 v[168:171], a[40:43], a[72:75], v[168:171]
    s_add_u32 m0, s74, 140288
    ds_read_b64_tr_b16 a[0:1], v14 offset:24576
    v_mfma_f32_16x16x32_bf16 v[172:175], a[40:43], a[76:79], v[172:175]
    v_fmac_f32 v61, v65, v65
    v_fmac_f32 v63, v66, v66
    v_mfma_f32_16x16x32_bf16 v[176:179], a[44:47], a[64:67], v[176:179]
    buffer_load_dwordx4 v9, s[56:59], s76 offen offset:0  lds
    v_mfma_f32_16x16x32_bf16 v[180:183], a[44:47], a[68:71], v[180:183]
    ds_read_b128 a[24:27], v6 offset:16384
    v_lshlrev_b32 v65, 16, v133
    v_mfma_f32_16x16x32_bf16 v[184:187], a[44:47], a[72:75], v[184:187]
    s_add_u32 m0, s73, 74496
    ds_read_b64_tr_b16 a[2:3], v14 offset:25088
    v_mfma_f32_16x16x32_bf16 v[188:191], a[44:47], a[76:79], v[188:191]
    ds_read_b64_tr_b16 a[4:5], v15 offset:24576
    v_and_b32 v66, 0xffff0000, v133
    v_mfma_f32_16x16x32_bf16 v[192:195], a[48:51], a[64:67], v[192:195]
    buffer_load_dwordx4 v4, s[52:55], s72 offen offset:1280  lds
    v_mfma_f32_16x16x32_bf16 v[196:199], a[48:51], a[68:71], v[196:199]
    ds_read_b64_tr_b16 a[6:7], v15 offset:25088
    v_add_f32 v60, v60, v65
    v_mfma_f32_16x16x32_bf16 v[200:203], a[48:51], a[72:75], v[200:203]
    s_add_u32 m0, s74, 148352
    ds_read_b128 a[28:31], v6 offset:18432
    v_mfma_f32_16x16x32_bf16 v[204:207], a[48:51], a[76:79], v[204:207]
    buffer_load_dwordx4 v9, s[56:59], s76 offen offset:128  lds
    v_mfma_f32_16x16x32_bf16 v[208:211], a[52:55], a[64:67], v[208:211]
    ds_read_b64_tr_b16 a[8:9], v16 offset:24576
    v_add_f32 v62, v62, v66
    v_mfma_f32_16x16x32_bf16 v[212:215], a[52:55], a[68:71], v[212:215]
    ds_read_b64_tr_b16 a[10:11], v16 offset:25088
    v_fmac_f32 v61, v65, v65
    v_mfma_f32_16x16x32_bf16 v[216:219], a[52:55], a[72:75], v[216:219]
    s_add_u32 m0, s73, 75520
    ds_read_b64_tr_b16 a[12:13], v17 offset:24576
    v_mfma_f32_16x16x32_bf16 v[220:223], a[52:55], a[76:79], v[220:223]
    buffer_load_dwordx4 v5, s[52:55], s72 offen offset:1280  lds
    v_mfma_f32_16x16x32_bf16 v[224:227], a[56:59], a[64:67], v[224:227]
    ds_read_b128 a[32:35], v6 offset:20480
    v_fmac_f32 v63, v66, v66
    v_mfma_f32_16x16x32_bf16 v[228:231], a[56:59], a[68:71], v[228:231]
    ds_read_b64_tr_b16 a[14:15], v17 offset:25088
    v_add_f32 v60, v60, v62
    v_mfma_f32_16x16x32_bf16 v[232:235], a[56:59], a[72:75], v[232:235]
    s_add_u32 m0, s74, 156416
    ds_read_b64_tr_b16 a[16:17], v14 offset:32768
    v_mfma_f32_16x16x32_bf16 v[236:239], a[56:59], a[76:79], v[236:239]
    buffer_load_dwordx4 v9, s[56:59], s76 offen offset:256  lds
    v_mfma_f32_16x16x32_bf16 v[240:243], a[60:63], a[64:67], v[240:243]
    ds_read_b64_tr_b16 a[18:19], v14 offset:33280
    v_add_f32 v61, v61, v63
    v_mfma_f32_16x16x32_bf16 v[244:247], a[60:63], a[68:71], v[244:247]
    ds_read_b128 a[36:39], v6 offset:22528
    v_mov_b32 v65, 0
    v_mfma_f32_16x16x32_bf16 v[248:251], a[60:63], a[72:75], v[248:251]
    s_add_u32 s72, s72, 128
    ds_read_b64_tr_b16 a[20:21], v15 offset:32768
    v_mfma_f32_16x16x32_bf16 v[252:255], a[60:63], a[76:79], v[252:255]
    s_add_u32 s75, s75, 196608
    ds_read_b64_tr_b16 a[22:23], v15 offset:33280
    v_mfma_f32_16x16x32_bf16 a[84:87], a[40:43], a[80:83], a[84:87]
    s_add_u32 s76, s76, 196608
    v_add_f32_dpp v60, v60, v60 row_shr:1 row_mask:0xf bank_mask:0xf bound_ctrl:0
    v_mfma_f32_16x16x32_bf16 a[88:91], a[44:47], a[80:83], a[88:91]
    v_add_f32_dpp v61, v61, v61 row_shr:1 row_mask:0xf bank_mask:0xf bound_ctrl:0
    v_mfma_f32_16x16x32_bf16 a[92:95], a[48:51], a[80:83], a[92:95]
    s_add_u32 m0, s74, 90112
    v_add_f32_dpp v60, v60, v60 row_shr:2 row_mask:0xf bank_mask:0xf bound_ctrl:0
    v_mfma_f32_16x16x32_bf16 a[96:99], a[52:55], a[80:83], a[96:99]
    buffer_load_dwordx4 v8, s[56:59], s75 offen offset:0  lds
    v_mfma_f32_16x16x32_bf16 a[100:103], a[56:59], a[80:83], a[100:103]
    v_add_f32_dpp v61, v61, v61 row_shr:2 row_mask:0xf bank_mask:0xf bound_ctrl:0
    v_mfma_f32_16x16x32_bf16 a[104:107], a[60:63], a[80:83], a[104:107]
    v_add_f32_dpp v60, v60, v60 row_shr:4 row_mask:0xf bank_mask:0xf bound_ctrl:0
    v_add_f32_dpp v61, v61, v61 row_shr:4 row_mask:0xf bank_mask:0xf bound_ctrl:0
    s_waitcnt lgkmcnt(0)
    buffer_store_dwordx4 v[144:147], v121, s[60:63], s94 offen sc1
    v_mfma_f32_16x16x32_bf16 v[160:163], a[0:3], a[24:27], v[160:163]
    s_add_u32 m0, s73, 40960
    ds_read_b64_tr_b16 a[40:41], v18 offset:24576
    v_mfma_f32_16x16x32_bf16 v[164:167], a[0:3], a[28:31], v[164:167]
    v_mov_b32 v40, s11
    v_mov_b32 v41, s11
    v_mfma_f32_16x16x32_bf16 v[168:171], a[0:3], a[32:35], v[168:171]
    buffer_load_dwordx4 v4, s[52:55], s72 offen offset:0  lds
    v_mfma_f32_16x16x32_bf16 v[172:175], a[0:3], a[36:39], v[172:175]
    ds_read_b128 a[64:67], v7 offset:16384
    s_lshl_b32 s79, s78, 7
    v_mfma_f32_16x16x32_bf16 v[176:179], a[4:7], a[24:27], v[176:179]
    ds_read_b64_tr_b16 a[42:43], v18 offset:25088
    s_lshl_b32 s13, s3, 4
    v_mfma_f32_16x16x32_bf16 v[180:183], a[4:7], a[28:31], v[180:183]
    ds_read_b64_tr_b16 a[44:45], v19 offset:24576
    s_add_u32 s79, s79, s13
    v_mfma_f32_16x16x32_bf16 v[184:187], a[4:7], a[32:35], v[184:187]
    s_add_u32 m0, s74, 98176
    ds_read_b64_tr_b16 a[46:47], v19 offset:25088
    v_mfma_f32_16x16x32_bf16 v[188:191], a[4:7], a[36:39], v[188:191]
    ds_read_b128 a[68:71], v7 offset:18432
    s_add_u32 s79, s79, 17825792
    v_mfma_f32_16x16x32_bf16 v[192:195], a[8:11], a[24:27], v[192:195]
    buffer_load_dwordx4 v8, s[56:59], s75 offen offset:128  lds
    v_mfma_f32_16x16x32_bf16 v[196:199], a[8:11], a[28:31], v[196:199]
    ds_read_b64_tr_b16 a[48:49], v20 offset:24576
    s_add_u32 s79, s79, 16384
    v_mfma_f32_16x16x32_bf16 v[200:203], a[8:11], a[32:35], v[200:203]
    ds_read_b64_tr_b16 a[50:51], v20 offset:25088
    v_lshlrev_b32 v42, 26, v1
    v_mfma_f32_16x16x32_bf16 v[204:207], a[8:11], a[36:39], v[204:207]
    ds_read_b64_tr_b16 a[52:53], v21 offset:24576
    v_or_b32 v42, s89, v42
    v_mfma_f32_16x16x32_bf16 v[208:211], a[12:15], a[24:27], v[208:211]
    s_add_u32 m0, s73, 41984
    ds_read_b128 a[72:75], v7 offset:20480
    v_mfma_f32_16x16x32_bf16 v[212:215], a[12:15], a[28:31], v[212:215]
    ds_read_b64_tr_b16 a[54:55], v21 offset:25088
    v_mfma_f32_16x16x32_bf16 v[216:219], a[12:15], a[32:35], v[216:219]
    buffer_load_dwordx4 v5, s[52:55], s72 offen offset:0  lds
    v_mfma_f32_16x16x32_bf16 v[220:223], a[12:15], a[36:39], v[220:223]
    ds_read_b64_tr_b16 a[56:57], v18 offset:32768
    v_add_f32_dpp v60, v60, v60 row_shr:8 row_mask:0xf bank_mask:0xf bound_ctrl:0
    v_mfma_f32_16x16x32_bf16 v[224:227], a[16:19], a[24:27], v[224:227]
    ds_read_b64_tr_b16 a[58:59], v18 offset:33280
    v_add_f32_dpp v61, v61, v61 row_shr:8 row_mask:0xf bank_mask:0xf bound_ctrl:0
    v_mfma_f32_16x16x32_bf16 v[228:231], a[16:19], a[28:31], v[228:231]
    ds_read_b128 a[76:79], v7 offset:22528
    v_add_f32_dpp v60, v60, v60 row_bcast:15 row_mask:0xa bank_mask:0xf bound_ctrl:0
    v_mfma_f32_16x16x32_bf16 v[232:235], a[16:19], a[32:35], v[232:235]
    s_add_u32 m0, s74, 106240
    ds_read_b64_tr_b16 a[60:61], v19 offset:32768
    v_mfma_f32_16x16x32_bf16 v[236:239], a[16:19], a[36:39], v[236:239]
    ds_read_b64_tr_b16 a[62:63], v19 offset:33280
    v_add_f32_dpp v61, v61, v61 row_bcast:15 row_mask:0xa bank_mask:0xf bound_ctrl:0
    v_mfma_f32_16x16x32_bf16 v[240:243], a[20:23], a[24:27], v[240:243]
    buffer_load_dwordx4 v8, s[56:59], s75 offen offset:256  lds
    v_mfma_f32_16x16x32_bf16 v[244:247], a[20:23], a[28:31], v[244:247]
    v_mul_f32 v62, 0x3acccccd, v60
    v_mul_f32 v63, 0x3acccccd, v61
    v_mfma_f32_16x16x32_bf16 v[248:251], a[20:23], a[32:35], v[248:251]
    v_fma_f32 v63, -v62, v62, v63
    v_mfma_f32_16x16x32_bf16 v[252:255], a[20:23], a[36:39], v[252:255]
    v_max_f32 v63, 0, v63
    v_cvt_pk_bf16_f32 v68, v62, v62
    s_waitcnt lgkmcnt(0)
    v_mfma_f32_16x16x32_bf16 v[160:163], a[40:43], a[64:67], v[160:163]
    v_mfma_f32_16x16x32_bf16 v[164:167], a[40:43], a[68:71], v[164:167]
    s_waitcnt vmcnt(6)
    s_barrier
    v_mfma_f32_16x16x32_bf16 v[168:171], a[40:43], a[72:75], v[168:171]
    s_add_u32 m0, s74, 91136
    ds_read_b64_tr_b16 a[0:1], v14 offset:49152
    v_mfma_f32_16x16x32_bf16 v[172:175], a[40:43], a[76:79], v[172:175]
    v_and_b32 v68, 0xffff0000, v68
    v_cvt_pk_bf16_f32 v65, v63, v63
    v_mfma_f32_16x16x32_bf16 v[176:179], a[44:47], a[64:67], v[176:179]
    buffer_load_dwordx4 v9, s[56:59], s76 offen offset:0  lds
    v_mfma_f32_16x16x32_bf16 v[180:183], a[44:47], a[68:71], v[180:183]
    ds_read_b128 a[24:27], v6 offset:32768
    v_and_b32 v65, 0xffff0000, v65
    v_mfma_f32_16x16x32_bf16 v[184:187], a[44:47], a[72:75], v[184:187]
    s_add_u32 m0, s73, 41728
    ds_read_b64_tr_b16 a[2:3], v14 offset:49664
    v_mfma_f32_16x16x32_bf16 v[188:191], a[44:47], a[76:79], v[188:191]
    ds_read_b64_tr_b16 a[4:5], v15 offset:49152
    v_add_f32 v65, 0x3727c5ac, v65
    v_mfma_f32_16x16x32_bf16 v[192:195], a[48:51], a[64:67], v[192:195]
    buffer_load_dwordx4 v4, s[52:55], s72 offen offset:1280  lds
    v_mfma_f32_16x16x32_bf16 v[196:199], a[48:51], a[68:71], v[196:199]
    ds_read_b64_tr_b16 a[6:7], v15 offset:49664
    v_cvt_pk_bf16_f32 v65, v65, v65
    v_mfma_f32_16x16x32_bf16 v[200:203], a[48:51], a[72:75], v[200:203]
    s_add_u32 m0, s74, 99200
    ds_read_b128 a[28:31], v6 offset:34816
    v_mfma_f32_16x16x32_bf16 v[204:207], a[48:51], a[76:79], v[204:207]
    buffer_load_dwordx4 v9, s[56:59], s76 offen offset:128  lds
    v_mfma_f32_16x16x32_bf16 v[208:211], a[52:55], a[64:67], v[208:211]
    ds_read_b64_tr_b16 a[8:9], v16 offset:49152
    v_and_b32 v65, 0xffff0000, v65
    v_mfma_f32_16x16x32_bf16 v[212:215], a[52:55], a[68:71], v[212:215]
    ds_read_b64_tr_b16 a[10:11], v16 offset:49664
    v_mfma_f32_16x16x32_bf16 v[216:219], a[52:55], a[72:75], v[216:219]
    s_add_u32 m0, s73, 42752
    ds_read_b64_tr_b16 a[12:13], v17 offset:49152
    v_mfma_f32_16x16x32_bf16 v[220:223], a[52:55], a[76:79], v[220:223]
    buffer_load_dwordx4 v5, s[52:55], s72 offen offset:1280  lds
    v_mfma_f32_16x16x32_bf16 v[224:227], a[56:59], a[64:67], v[224:227]
    ds_read_b128 a[32:35], v6 offset:36864
    v_sqrt_f32 v65, v65
    v_mfma_f32_16x16x32_bf16 v[228:231], a[56:59], a[68:71], v[228:231]
    ds_read_b64_tr_b16 a[14:15], v17 offset:49664
    v_sub_f32 v66, v62, v68
    v_mfma_f32_16x16x32_bf16 v[232:235], a[56:59], a[72:75], v[232:235]
    s_add_u32 m0, s74, 107264
    ds_read_b64_tr_b16 a[16:17], v14 offset:57344
    v_mfma_f32_16x16x32_bf16 v[236:239], a[56:59], a[76:79], v[236:239]
    buffer_load_dwordx4 v9, s[56:59], s76 offen offset:256  lds
    v_mfma_f32_16x16x32_bf16 v[240:243], a[60:63], a[64:67], v[240:243]
    ds_read_b64_tr_b16 a[18:19], v14 offset:57856
    v_cvt_pk_bf16_f32 v64, v65, v65
    v_mfma_f32_16x16x32_bf16 v[244:247], a[60:63], a[68:71], v[244:247]
    ds_read_b128 a[36:39], v6 offset:38912
    v_and_b32 v64, 0xffff0000, v64
    v_mfma_f32_16x16x32_bf16 v[248:251], a[60:63], a[72:75], v[248:251]
    s_add_u32 s72, s72, 128
    ds_read_b64_tr_b16 a[20:21], v15 offset:57344
    v_mfma_f32_16x16x32_bf16 v[252:255], a[60:63], a[76:79], v[252:255]
    s_add_u32 s75, s75, 196608
    ds_read_b64_tr_b16 a[22:23], v15 offset:57856
    v_mfma_f32_16x16x32_bf16 a[84:87], a[40:43], a[80:83], a[84:87]
    s_add_u32 s76, s76, 196608
    v_rcp_f32 v70, v64
    v_mfma_f32_16x16x32_bf16 a[88:91], a[44:47], a[80:83], a[88:91]
    v_mul_f32 v66, v66, v70
    v_mul_f32 v65, v63, v70
    v_mfma_f32_16x16x32_bf16 a[92:95], a[48:51], a[80:83], a[92:95]
    s_add_u32 m0, s74, 114688
    v_cvt_pk_bf16_f32 v66, v66, v66
    v_mfma_f32_16x16x32_bf16 a[96:99], a[52:55], a[80:83], a[96:99]
    buffer_load_dwordx4 v8, s[56:59], s75 offen offset:0  lds
    v_mfma_f32_16x16x32_bf16 a[100:103], a[56:59], a[80:83], a[100:103]
    v_and_b32 v66, 0xffff0000, v66
    v_mul_f32 v65, v65, v70
    v_mfma_f32_16x16x32_bf16 a[104:107], a[60:63], a[80:83], a[104:107]
    v_cvt_pk_bf16_f32 v65, v65, v65
    s_waitcnt lgkmcnt(0)
    s_waitcnt vmcnt(10)
    buffer_store_dwordx2 v[40:41], v42, s[60:63], s79 offen sc1
    v_mfma_f32_16x16x32_bf16 v[160:163], a[0:3], a[24:27], v[160:163]
    s_add_u32 m0, s73, 57344
    ds_read_b64_tr_b16 a[40:41], v18 offset:49152
    v_mfma_f32_16x16x32_bf16 v[164:167], a[0:3], a[28:31], v[164:167]
    v_and_b32 v65, 0xffff0000, v65
    v_mfma_f32_16x16x32_bf16 v[168:171], a[0:3], a[32:35], v[168:171]
    buffer_load_dwordx4 v4, s[52:55], s72 offen offset:0  lds
    v_mfma_f32_16x16x32_bf16 v[172:175], a[0:3], a[36:39], v[172:175]
    ds_read_b128 a[64:67], v7 offset:32768
    v_add_f32 v65, 0x3727c5ac, v65
    v_mfma_f32_16x16x32_bf16 v[176:179], a[4:7], a[24:27], v[176:179]
    s_add_u32 m0, s74, 122752
    ds_read_b64_tr_b16 a[42:43], v18 offset:49664
    v_mfma_f32_16x16x32_bf16 v[180:183], a[4:7], a[28:31], v[180:183]
    ds_read_b64_tr_b16 a[44:45], v19 offset:49152
    v_cvt_pk_bf16_f32 v65, v65, v65
    v_mfma_f32_16x16x32_bf16 v[184:187], a[4:7], a[32:35], v[184:187]
    buffer_load_dwordx4 v8, s[56:59], s75 offen offset:128  lds
    v_mfma_f32_16x16x32_bf16 v[188:191], a[4:7], a[36:39], v[188:191]
    ds_read_b64_tr_b16 a[46:47], v19 offset:49664
    v_and_b32 v65, 0xffff0000, v65
    v_mfma_f32_16x16x32_bf16 v[192:195], a[8:11], a[24:27], v[192:195]
    s_add_u32 m0, s73, 58368
    ds_read_b128 a[68:71], v7 offset:34816
    v_mfma_f32_16x16x32_bf16 v[196:199], a[8:11], a[28:31], v[196:199]
    buffer_load_dwordx4 v5, s[52:55], s72 offen offset:0  lds
    v_mfma_f32_16x16x32_bf16 v[200:203], a[8:11], a[32:35], v[200:203]
    ds_read_b64_tr_b16 a[48:49], v20 offset:49152
    v_sqrt_f32 v65, v65
    v_mfma_f32_16x16x32_bf16 v[204:207], a[8:11], a[36:39], v[204:207]
    ds_read_b64_tr_b16 a[50:51], v20 offset:49664
    v_fma_f32 v66, v66, v64, v68
    v_mfma_f32_16x16x32_bf16 v[208:211], a[12:15], a[24:27], v[208:211]
    s_add_u32 m0, s74, 130816
    ds_read_b64_tr_b16 a[52:53], v21 offset:49152
    v_mfma_f32_16x16x32_bf16 v[212:215], a[12:15], a[28:31], v[212:215]
    buffer_load_dwordx4 v8, s[56:59], s75 offen offset:256  lds
    v_mfma_f32_16x16x32_bf16 v[216:219], a[12:15], a[32:35], v[216:219]
    ds_read_b128 a[72:75], v7 offset:36864
    v_cvt_pk_bf16_f32 v65, v65, v65
    v_mfma_f32_16x16x32_bf16 v[220:223], a[12:15], a[36:39], v[220:223]
    ds_read_b64_tr_b16 a[54:55], v21 offset:49664
    v_and_b32 v65, 0xffff0000, v65
    v_mfma_f32_16x16x32_bf16 v[224:227], a[16:19], a[24:27], v[224:227]
    s_add_u32 m0, s74, 115712
    ds_read_b64_tr_b16 a[56:57], v18 offset:57344
    v_mfma_f32_16x16x32_bf16 v[228:231], a[16:19], a[28:31], v[228:231]
    buffer_load_dwordx4 v9, s[56:59], s76 offen offset:0  lds
    v_mfma_f32_16x16x32_bf16 v[232:235], a[16:19], a[32:35], v[232:235]
    ds_read_b64_tr_b16 a[58:59], v18 offset:57856
    v_mul_f32 v65, v65, v64
    v_mfma_f32_16x16x32_bf16 v[236:239], a[16:19], a[36:39], v[236:239]
    ds_read_b128 a[76:79], v7 offset:38912
    v_mfma_f32_16x16x32_bf16 v[240:243], a[20:23], a[24:27], v[240:243]
    s_add_u32 m0, s73, 58112
    ds_read_b64_tr_b16 a[60:61], v19 offset:57344
    v_mfma_f32_16x16x32_bf16 v[244:247], a[20:23], a[28:31], v[244:247]
    buffer_load_dwordx4 v4, s[52:55], s72 offen offset:1280  lds
    v_mfma_f32_16x16x32_bf16 v[248:251], a[20:23], a[32:35], v[248:251]
    ds_read_b64_tr_b16 a[62:63], v19 offset:57856
    v_rcp_f32 v72, v65
    v_mfma_f32_16x16x32_bf16 v[252:255], a[20:23], a[36:39], v[252:255]
    v_and_b32 v65, 31, v1
    v_mul_f32 v74, v72, v66
    s_waitcnt lgkmcnt(0)
    v_mfma_f32_16x16x32_bf16 v[160:163], a[40:43], a[64:67], v[160:163]
    v_mfma_f32_16x16x32_bf16 v[164:167], a[40:43], a[68:71], v[164:167]
    s_waitcnt vmcnt(8)
    s_barrier
    v_mfma_f32_16x16x32_bf16 v[168:171], a[40:43], a[72:75], v[168:171]
    s_add_u32 m0, s74, 123776
    ds_read_b64_tr_b16 a[0:1], v14 offset:0
    v_mfma_f32_16x16x32_bf16 v[172:175], a[40:43], a[76:79], v[172:175]
    v_sub_u32 v65, 31, v65
    v_and_b32 v66, 32, v1
    v_mfma_f32_16x16x32_bf16 v[176:179], a[44:47], a[64:67], v[176:179]
    buffer_load_dwordx4 v9, s[56:59], s76 offen offset:128  lds
    v_mfma_f32_16x16x32_bf16 v[180:183], a[44:47], a[68:71], v[180:183]
    ds_read_b128 a[24:27], v6 offset:0
    v_lshl_add_u32 v65, v65, 26, v66
    v_mfma_f32_16x16x32_bf16 v[184:187], a[44:47], a[72:75], v[184:187]
    s_add_u32 m0, s73, 59136
    ds_read_b64_tr_b16 a[2:3], v14 offset:512
    v_mfma_f32_16x16x32_bf16 v[188:191], a[44:47], a[76:79], v[188:191]
    ds_read_b64_tr_b16 a[4:5], v15 offset:0
    s_lshl_b32 s12, s87, 5
    v_mfma_f32_16x16x32_bf16 v[192:195], a[48:51], a[64:67], v[192:195]
    buffer_load_dwordx4 v5, s[52:55], s72 offen offset:1280  lds
    v_mfma_f32_16x16x32_bf16 v[196:199], a[48:51], a[68:71], v[196:199]
    ds_read_b64_tr_b16 a[6:7], v15 offset:512
    s_add_u32 s12, s12, 18874368
    v_mfma_f32_16x16x32_bf16 v[200:203], a[48:51], a[72:75], v[200:203]
    s_add_u32 m0, s74, 131840
    ds_read_b128 a[28:31], v6 offset:2048
    v_mfma_f32_16x16x32_bf16 v[204:207], a[48:51], a[76:79], v[204:207]
    buffer_load_dwordx4 v9, s[56:59], s76 offen offset:256  lds
    v_mfma_f32_16x16x32_bf16 v[208:211], a[52:55], a[64:67], v[208:211]
    ds_read_b64_tr_b16 a[8:9], v16 offset:0
    v_mov_b32 v69, s11
    v_mfma_f32_16x16x32_bf16 v[212:215], a[52:55], a[68:71], v[212:215]
    ds_read_b64_tr_b16 a[10:11], v16 offset:512
    v_mov_b32 v71, s11
    v_mfma_f32_16x16x32_bf16 v[216:219], a[52:55], a[72:75], v[216:219]
    s_add_u32 s72, s72, 128
    ds_read_b64_tr_b16 a[12:13], v17 offset:0
    v_mfma_f32_16x16x32_bf16 v[220:223], a[52:55], a[76:79], v[220:223]
    s_add_u32 s75, s75, 196608
    ds_read_b128 a[32:35], v6 offset:4096
    v_mfma_f32_16x16x32_bf16 v[224:227], a[56:59], a[64:67], v[224:227]
    ds_read_b64_tr_b16 a[14:15], v17 offset:512
    v_mov_b32 v73, s11
    v_mfma_f32_16x16x32_bf16 v[228:231], a[56:59], a[68:71], v[228:231]
    s_add_u32 s76, s76, 196608
    v_mov_b32 v75, s11
    v_mfma_f32_16x16x32_bf16 v[232:235], a[56:59], a[72:75], v[232:235]
    s_add_u32 m0, s74, 139264
    ds_read_b64_tr_b16 a[16:17], v14 offset:8192
    v_mfma_f32_16x16x32_bf16 v[236:239], a[56:59], a[76:79], v[236:239]
    buffer_load_dwordx4 v8, s[56:59], s75 offen offset:0  lds
    v_mfma_f32_16x16x32_bf16 v[240:243], a[60:63], a[64:67], v[240:243]
    ds_read_b64_tr_b16 a[18:19], v14 offset:8704
    buffer_store_dwordx4 v[68:71], v65, s[60:63], s12 offen sc1
    v_mfma_f32_16x16x32_bf16 v[244:247], a[60:63], a[68:71], v[244:247]
    ds_read_b128 a[36:39], v6 offset:6144
    v_mfma_f32_16x16x32_bf16 v[248:251], a[60:63], a[72:75], v[248:251]
    s_add_u32 m0, s73, 73728
    ds_read_b64_tr_b16 a[20:21], v15 offset:8192
    v_mfma_f32_16x16x32_bf16 v[252:255], a[60:63], a[76:79], v[252:255]
    buffer_load_dwordx4 v4, s[52:55], s72 offen offset:0  lds
    v_mfma_f32_16x16x32_bf16 a[84:87], a[40:43], a[80:83], a[84:87]
    ds_read_b64_tr_b16 a[22:23], v15 offset:8704
    buffer_store_dwordx4 v[72:75], v65, s[60:63], s12 offen offset:16 sc1
    v_mfma_f32_16x16x32_bf16 a[88:91], a[44:47], a[80:83], a[88:91]
    buffer_load_dword v12, v98, s[68:71], 0 offen
    v_mfma_f32_16x16x32_bf16 a[92:95], a[48:51], a[80:83], a[92:95]
    s_add_u32 m0, s74, 147328
    s_mov_b32 s68, s84
    v_mfma_f32_16x16x32_bf16 a[96:99], a[52:55], a[80:83], a[96:99]
    buffer_load_dwordx4 v8, s[56:59], s75 offen offset:128  lds
    v_mfma_f32_16x16x32_bf16 a[100:103], a[56:59], a[80:83], a[100:103]
    s_mov_b32 s69, s85
    v_mfma_f32_16x16x32_bf16 a[104:107], a[60:63], a[80:83], a[104:107]
    buffer_load_dword v12, v98, s[68:71], 0 offen
    s_waitcnt lgkmcnt(0)
    v_mfma_f32_16x16x32_bf16 v[160:163], a[0:3], a[24:27], v[160:163]
    s_add_u32 m0, s73, 74752
    ds_read_b64_tr_b16 a[40:41], v18 offset:0
    v_mfma_f32_16x16x32_bf16 v[164:167], a[0:3], a[28:31], v[164:167]
    v_mfma_f32_16x16x32_bf16 v[168:171], a[0:3], a[32:35], v[168:171]
    buffer_load_dwordx4 v5, s[52:55], s72 offen offset:0  lds
    v_mfma_f32_16x16x32_bf16 v[172:175], a[0:3], a[36:39], v[172:175]
    ds_read_b128 a[64:67], v7 offset:0
    v_mfma_f32_16x16x32_bf16 v[176:179], a[4:7], a[24:27], v[176:179]
    s_add_u32 m0, s74, 155392
    ds_read_b64_tr_b16 a[42:43], v18 offset:512
    v_mfma_f32_16x16x32_bf16 v[180:183], a[4:7], a[28:31], v[180:183]
    ds_read_b64_tr_b16 a[44:45], v19 offset:0
    v_mfma_f32_16x16x32_bf16 v[184:187], a[4:7], a[32:35], v[184:187]
    buffer_load_dwordx4 v8, s[56:59], s75 offen offset:256  lds
    v_mfma_f32_16x16x32_bf16 v[188:191], a[4:7], a[36:39], v[188:191]
    ds_read_b64_tr_b16 a[46:47], v19 offset:512
    v_mfma_f32_16x16x32_bf16 v[192:195], a[8:11], a[24:27], v[192:195]
    s_add_u32 m0, s74, 140288
    ds_read_b128 a[68:71], v7 offset:2048
    v_mfma_f32_16x16x32_bf16 v[196:199], a[8:11], a[28:31], v[196:199]
    buffer_load_dwordx4 v9, s[56:59], s76 offen offset:0  lds
    v_mfma_f32_16x16x32_bf16 v[200:203], a[8:11], a[32:35], v[200:203]
    ds_read_b64_tr_b16 a[48:49], v20 offset:0
    v_mfma_f32_16x16x32_bf16 v[204:207], a[8:11], a[36:39], v[204:207]
    ds_read_b64_tr_b16 a[50:51], v20 offset:512
    v_mfma_f32_16x16x32_bf16 v[208:211], a[12:15], a[24:27], v[208:211]
    s_add_u32 m0, s73, 74496
    ds_read_b64_tr_b16 a[52:53], v21 offset:0
    v_mfma_f32_16x16x32_bf16 v[212:215], a[12:15], a[28:31], v[212:215]
    buffer_load_dwordx4 v4, s[52:55], s72 offen offset:1280  lds
    v_mfma_f32_16x16x32_bf16 v[216:219], a[12:15], a[32:35], v[216:219]
    ds_read_b128 a[72:75], v7 offset:4096
    v_mfma_f32_16x16x32_bf16 v[220:223], a[12:15], a[36:39], v[220:223]
    ds_read_b64_tr_b16 a[54:55], v21 offset:512
    v_mfma_f32_16x16x32_bf16 v[224:227], a[16:19], a[24:27], v[224:227]
    s_add_u32 m0, s74, 148352
    ds_read_b64_tr_b16 a[56:57], v18 offset:8192
    v_mfma_f32_16x16x32_bf16 v[228:231], a[16:19], a[28:31], v[228:231]
    buffer_load_dwordx4 v9, s[56:59], s76 offen offset:128  lds
    v_mfma_f32_16x16x32_bf16 v[232:235], a[16:19], a[32:35], v[232:235]
    ds_read_b64_tr_b16 a[58:59], v18 offset:8704
    v_mfma_f32_16x16x32_bf16 v[236:239], a[16:19], a[36:39], v[236:239]
    ds_read_b128 a[76:79], v7 offset:6144
    v_mfma_f32_16x16x32_bf16 v[240:243], a[20:23], a[24:27], v[240:243]
    s_add_u32 m0, s73, 75520
    ds_read_b64_tr_b16 a[60:61], v19 offset:8192
    v_mfma_f32_16x16x32_bf16 v[244:247], a[20:23], a[28:31], v[244:247]
    buffer_load_dwordx4 v5, s[52:55], s72 offen offset:1280  lds
    v_mfma_f32_16x16x32_bf16 v[248:251], a[20:23], a[32:35], v[248:251]
    ds_read_b64_tr_b16 a[62:63], v19 offset:8704
    v_mfma_f32_16x16x32_bf16 v[252:255], a[20:23], a[36:39], v[252:255]
    s_waitcnt lgkmcnt(0)
    v_mfma_f32_16x16x32_bf16 v[160:163], a[40:43], a[64:67], v[160:163]
    v_mfma_f32_16x16x32_bf16 v[164:167], a[40:43], a[68:71], v[164:167]
    s_waitcnt vmcnt(13)
    s_barrier
    buffer_load_dwordx2 v[44:45], v24, s[60:63], 0 offen sc1
    v_mfma_f32_16x16x32_bf16 v[168:171], a[40:43], a[72:75], v[168:171]
    s_add_u32 m0, s74, 156416
    ds_read_b64_tr_b16 a[0:1], v14 offset:24576
    v_mfma_f32_16x16x32_bf16 v[172:175], a[40:43], a[76:79], v[172:175]
    v_mfma_f32_16x16x32_bf16 v[176:179], a[44:47], a[64:67], v[176:179]
    buffer_load_dwordx4 v9, s[56:59], s76 offen offset:256  lds
    v_mfma_f32_16x16x32_bf16 v[180:183], a[44:47], a[68:71], v[180:183]
    ds_read_b128 a[24:27], v6 offset:16384
    v_mfma_f32_16x16x32_bf16 v[184:187], a[44:47], a[72:75], v[184:187]
    s_add_u32 s72, s72, 128
    ds_read_b64_tr_b16 a[2:3], v14 offset:25088
    v_mfma_f32_16x16x32_bf16 v[188:191], a[44:47], a[76:79], v[188:191]
    ds_read_b64_tr_b16 a[4:5], v15 offset:24576
    v_mfma_f32_16x16x32_bf16 v[192:195], a[48:51], a[64:67], v[192:195]
    s_add_u32 s75, s75, 196608
    ds_read_b64_tr_b16 a[6:7], v15 offset:25088
    v_mfma_f32_16x16x32_bf16 v[196:199], a[48:51], a[68:71], v[196:199]
    s_add_u32 s76, s76, 196608
    ds_read_b128 a[28:31], v6 offset:18432
    v_mfma_f32_16x16x32_bf16 v[200:203], a[48:51], a[72:75], v[200:203]
    s_add_u32 m0, s74, 90112
    v_mfma_f32_16x16x32_bf16 v[204:207], a[48:51], a[76:79], v[204:207]
    buffer_load_dwordx4 v8, s[56:59], s75 offen offset:0  lds
    v_mfma_f32_16x16x32_bf16 v[208:211], a[52:55], a[64:67], v[208:211]
    ds_read_b64_tr_b16 a[8:9], v16 offset:24576
    v_mfma_f32_16x16x32_bf16 v[212:215], a[52:55], a[68:71], v[212:215]
    ds_read_b64_tr_b16 a[10:11], v16 offset:25088
    v_mfma_f32_16x16x32_bf16 v[216:219], a[52:55], a[72:75], v[216:219]
    s_add_u32 m0, s73, 40960
    ds_read_b64_tr_b16 a[12:13], v17 offset:24576
    v_mfma_f32_16x16x32_bf16 v[220:223], a[52:55], a[76:79], v[220:223]
    buffer_load_dwordx4 v4, s[52:55], s72 offen offset:0  lds
    v_mfma_f32_16x16x32_bf16 v[224:227], a[56:59], a[64:67], v[224:227]
    ds_read_b128 a[32:35], v6 offset:20480
    v_mfma_f32_16x16x32_bf16 v[228:231], a[56:59], a[68:71], v[228:231]
    ds_read_b64_tr_b16 a[14:15], v17 offset:25088
    v_mfma_f32_16x16x32_bf16 v[232:235], a[56:59], a[72:75], v[232:235]
    s_add_u32 m0, s74, 98176
    ds_read_b64_tr_b16 a[16:17], v14 offset:32768
    v_mfma_f32_16x16x32_bf16 v[236:239], a[56:59], a[76:79], v[236:239]
    buffer_load_dwordx4 v8, s[56:59], s75 offen offset:128  lds
    v_mfma_f32_16x16x32_bf16 v[240:243], a[60:63], a[64:67], v[240:243]
    ds_read_b64_tr_b16 a[18:19], v14 offset:33280
    v_mfma_f32_16x16x32_bf16 v[244:247], a[60:63], a[68:71], v[244:247]
    ds_read_b128 a[36:39], v6 offset:22528
    v_mfma_f32_16x16x32_bf16 v[248:251], a[60:63], a[72:75], v[248:251]
    s_add_u32 m0, s73, 41984
    ds_read_b64_tr_b16 a[20:21], v15 offset:32768
    v_mfma_f32_16x16x32_bf16 v[252:255], a[60:63], a[76:79], v[252:255]
    buffer_load_dwordx4 v5, s[52:55], s72 offen offset:0  lds
    v_mfma_f32_16x16x32_bf16 a[84:87], a[40:43], a[80:83], a[84:87]
    ds_read_b64_tr_b16 a[22:23], v15 offset:33280
    v_mfma_f32_16x16x32_bf16 a[88:91], a[44:47], a[80:83], a[88:91]
    v_mfma_f32_16x16x32_bf16 a[92:95], a[48:51], a[80:83], a[92:95]
    s_add_u32 m0, s74, 106240
    v_mfma_f32_16x16x32_bf16 a[96:99], a[52:55], a[80:83], a[96:99]
    buffer_load_dwordx4 v8, s[56:59], s75 offen offset:256  lds
    v_mfma_f32_16x16x32_bf16 a[100:103], a[56:59], a[80:83], a[100:103]
    v_mfma_f32_16x16x32_bf16 a[104:107], a[60:63], a[80:83], a[104:107]
    s_waitcnt lgkmcnt(0)
    s_waitcnt vmcnt(6)
L_chk_rf_mlp:
    v_cmp_ne_u32 vcc, s11, v44
    v_cmp_ne_u32 s[12:13], s11, v45
    s_or_b64 vcc, vcc, s[12:13]
    s_cmp_eq_u64 vcc, 0
    s_cbranch_scc1 L_chkok_rf_mlp
    s_sub_u32 s81, s81, 1
    s_cbranch_scc1 L_end
    buffer_load_dwordx2 v[44:45], v24, s[60:63], 0 offen sc1
    s_waitcnt vmcnt(0)
    s_branch L_chk_rf_mlp
L_chkok_rf_mlp:
    v_mfma_f32_16x16x32_bf16 v[160:163], a[0:3], a[24:27], v[160:163]
    s_add_u32 m0, s74, 91136
    ds_read_b64_tr_b16 a[40:41], v18 offset:24576
    v_mfma_f32_16x16x32_bf16 v[164:167], a[0:3], a[28:31], v[164:167]
    v_mfma_f32_16x16x32_bf16 v[168:171], a[0:3], a[32:35], v[168:171]
    buffer_load_dwordx4 v9, s[56:59], s76 offen offset:0  lds
    v_mfma_f32_16x16x32_bf16 v[172:175], a[0:3], a[36:39], v[172:175]
    ds_read_b128 a[64:67], v7 offset:16384
    v_mfma_f32_16x16x32_bf16 v[176:179], a[4:7], a[24:27], v[176:179]
    s_add_u32 m0, s73, 41728
    ds_read_b64_tr_b16 a[42:43], v18 offset:25088
    v_mfma_f32_16x16x32_bf16 v[180:183], a[4:7], a[28:31], v[180:183]
    buffer_load_dwordx4 v4, s[52:55], s72 offen offset:1280  lds
    v_mfma_f32_16x16x32_bf16 v[184:187], a[4:7], a[32:35], v[184:187]
    ds_read_b64_tr_b16 a[44:45], v19 offset:24576
    v_mfma_f32_16x16x32_bf16 v[188:191], a[4:7], a[36:39], v[188:191]
    s_add_u32 m0, s74, 99200
    ds_read_b64_tr_b16 a[46:47], v19 offset:25088
    v_mfma_f32_16x16x32_bf16 v[192:195], a[8:11], a[24:27], v[192:195]
    ds_read_b128 a[68:71], v7 offset:18432
    v_mfma_f32_16x16x32_bf16 v[196:199], a[8:11], a[28:31], v[196:199]
    buffer_load_dwordx4 v9, s[56:59], s76 offen offset:128  lds
    v_mfma_f32_16x16x32_bf16 v[200:203], a[8:11], a[32:35], v[200:203]
    ds_read_b64_tr_b16 a[48:49], v20 offset:24576
    v_mfma_f32_16x16x32_bf16 v[204:207], a[8:11], a[36:39], v[204:207]
    s_add_u32 m0, s73, 42752
    ds_read_b64_tr_b16 a[50:51], v20 offset:25088
    v_mfma_f32_16x16x32_bf16 v[208:211], a[12:15], a[24:27], v[208:211]
    buffer_load_dwordx4 v5, s[52:55], s72 offen offset:1280  lds
    v_mfma_f32_16x16x32_bf16 v[212:215], a[12:15], a[28:31], v[212:215]
    ds_read_b64_tr_b16 a[52:53], v21 offset:24576
    v_mfma_f32_16x16x32_bf16 v[216:219], a[12:15], a[32:35], v[216:219]
    s_add_u32 m0, s74, 107264
    ds_read_b128 a[72:75], v7 offset:20480
    v_mfma_f32_16x16x32_bf16 v[220:223], a[12:15], a[36:39], v[220:223]
    buffer_load_dwordx4 v9, s[56:59], s76 offen offset:256  lds
    v_mfma_f32_16x16x32_bf16 v[224:227], a[16:19], a[24:27], v[224:227]
    ds_read_b64_tr_b16 a[54:55], v21 offset:25088
    v_mfma_f32_16x16x32_bf16 v[228:231], a[16:19], a[28:31], v[228:231]
    ds_read_b64_tr_b16 a[56:57], v18 offset:32768
    v_mfma_f32_16x16x32_bf16 v[232:235], a[16:19], a[32:35], v[232:235]
    s_cmp_gt_u32 s26, 0
    s_cselect_b32 s14, s18, s19
    v_mfma_f32_16x16x32_bf16 v[236:239], a[16:19], a[36:39], v[236:239]
    ds_read_b64_tr_b16 a[58:59], v18 offset:33280
    v_mfma_f32_16x16x32_bf16 v[240:243], a[20:23], a[24:27], v[240:243]
    s_add_u32 s14, s14, 0
    ds_read_b128 a[76:79], v7 offset:22528
    v_mfma_f32_16x16x32_bf16 v[244:247], a[20:23], a[28:31], v[244:247]
    buffer_load_dwordx4 a[108:111], v26, s[60:63], s14 offen offset:0 sc1
    v_mfma_f32_16x16x32_bf16 v[248:251], a[20:23], a[32:35], v[248:251]
    ds_read_b64_tr_b16 a[60:61], v19 offset:32768
    v_mfma_f32_16x16x32_bf16 v[252:255], a[20:23], a[36:39], v[252:255]
    ds_read_b64_tr_b16 a[62:63], v19 offset:33280
    s_waitcnt lgkmcnt(0)
    v_mfma_f32_16x16x32_bf16 v[160:163], a[40:43], a[64:67], v[160:163]
    v_mfma_f32_16x16x32_bf16 v[164:167], a[40:43], a[68:71], v[164:167]
    s_waitcnt vmcnt(11)
    s_barrier
    v_mfma_f32_16x16x32_bf16 v[168:171], a[40:43], a[72:75], v[168:171]
    buffer_load_dwordx4 a[112:115], v26, s[60:63], s14 offen offset:1024 sc1
    v_mfma_f32_16x16x32_bf16 v[172:175], a[40:43], a[76:79], v[172:175]
    ds_read_b64_tr_b16 a[0:1], v14 offset:49152
    v_mfma_f32_16x16x32_bf16 v[176:179], a[44:47], a[64:67], v[176:179]
    ds_read_b128 a[24:27], v6 offset:32768
    v_mfma_f32_16x16x32_bf16 v[180:183], a[44:47], a[68:71], v[180:183]
    ds_read_b64_tr_b16 a[2:3], v14 offset:49664
    v_mfma_f32_16x16x32_bf16 v[184:187], a[44:47], a[72:75], v[184:187]
    buffer_load_dwordx4 a[116:119], v26, s[60:63], s14 offen offset:2048 sc1
    v_mfma_f32_16x16x32_bf16 v[188:191], a[44:47], a[76:79], v[188:191]
    ds_read_b64_tr_b16 a[4:5], v15 offset:49152
    v_mfma_f32_16x16x32_bf16 v[192:195], a[48:51], a[64:67], v[192:195]
    ds_read_b64_tr_b16 a[6:7], v15 offset:49664
    v_mfma_f32_16x16x32_bf16 v[196:199], a[48:51], a[68:71], v[196:199]
    buffer_load_dwordx4 a[120:123], v26, s[60:63], s14 offen offset:3072 sc1
    v_mfma_f32_16x16x32_bf16 v[200:203], a[48:51], a[72:75], v[200:203]
    ds_read_b128 a[28:31], v6 offset:34816
    v_mfma_f32_16x16x32_bf16 v[204:207], a[48:51], a[76:79], v[204:207]
    ds_read_b64_tr_b16 a[8:9], v16 offset:49152
    v_mfma_f32_16x16x32_bf16 v[208:211], a[52:55], a[64:67], v[208:211]
    ds_read_b64_tr_b16 a[10:11], v16 offset:49664
    v_mfma_f32_16x16x32_bf16 v[212:215], a[52:55], a[68:71], v[212:215]
    s_add_u32 s14, s14, 4096
    ds_read_b64_tr_b16 a[12:13], v17 offset:49152
    v_mfma_f32_16x16x32_bf16 v[216:219], a[52:55], a[72:75], v[216:219]
    buffer_load_dwordx4 a[124:127], v26, s[60:63], s14 offen offset:0 sc1
    v_mfma_f32_16x16x32_bf16 v[220:223], a[52:55], a[76:79], v[220:223]
    ds_read_b128 a[32:35], v6 offset:36864
    v_mfma_f32_16x16x32_bf16 v[224:227], a[56:59], a[64:67], v[224:227]
    ds_read_b64_tr_b16 a[14:15], v17 offset:49664
    v_mfma_f32_16x16x32_bf16 v[228:231], a[56:59], a[68:71], v[228:231]
    v_mfma_f32_16x16x32_bf16 v[232:235], a[56:59], a[72:75], v[232:235]
    s_cmp_gt_u32 s26, 1
    s_cselect_b32 s14, s18, s19
    v_mfma_f32_16x16x32_bf16 v[236:239], a[56:59], a[76:79], v[236:239]
    ds_read_b64_tr_b16 a[16:17], v14 offset:57344
    v_mfma_f32_16x16x32_bf16 v[240:243], a[60:63], a[64:67], v[240:243]
    ds_read_b64_tr_b16 a[18:19], v14 offset:57856
    v_mfma_f32_16x16x32_bf16 v[244:247], a[60:63], a[68:71], v[244:247]
    s_add_u32 s14, s14, 5120
    ds_read_b128 a[36:39], v6 offset:38912
    v_mfma_f32_16x16x32_bf16 v[248:251], a[60:63], a[72:75], v[248:251]
    ds_read_b64_tr_b16 a[20:21], v15 offset:57344
    v_mfma_f32_16x16x32_bf16 v[252:255], a[60:63], a[76:79], v[252:255]
    buffer_load_dwordx4 a[128:131], v26, s[60:63], s14 offen offset:0 sc1
    v_mfma_f32_16x16x32_bf16 a[84:87], a[40:43], a[80:83], a[84:87]
    ds_read_b64_tr_b16 a[22:23], v15 offset:57856
    v_mfma_f32_16x16x32_bf16 a[88:91], a[44:47], a[80:83], a[88:91]
    v_mfma_f32_16x16x32_bf16 a[92:95], a[48:51], a[80:83], a[92:95]
    buffer_load_dwordx4 a[132:135], v26, s[60:63], s14 offen offset:1024 sc1
    v_mfma_f32_16x16x32_bf16 a[96:99], a[52:55], a[80:83], a[96:99]
    v_mfma_f32_16x16x32_bf16 a[100:103], a[56:59], a[80:83], a[100:103]
    v_mfma_f32_16x16x32_bf16 a[104:107], a[60:63], a[80:83], a[104:107]
    s_waitcnt lgkmcnt(0)
    v_mfma_f32_16x16x32_bf16 v[160:163], a[0:3], a[24:27], v[160:163]
    buffer_load_dwordx4 a[136:139], v26, s[60:63], s14 offen offset:2048 sc1
    v_mfma_f32_16x16x32_bf16 v[164:167], a[0:3], a[28:31], v[164:167]
    ds_read_b64_tr_b16 a[40:41], v18 offset:49152
    s_lshl_b32 s12, s6, 12
    v_mfma_f32_16x16x32_bf16 v[168:171], a[0:3], a[32:35], v[168:171]
    ds_read_b128 a[64:67], v7 offset:32768
    s_add_u32 s12, s12, 18874368
    v_mfma_f32_16x16x32_bf16 v[172:175], a[0:3], a[36:39], v[172:175]
    buffer_load_dwordx4 a[140:143], v26, s[60:63], s14 offen offset:3072 sc1
    v_mfma_f32_16x16x32_bf16 v[176:179], a[4:7], a[24:27], v[176:179]
    ds_read_b64_tr_b16 a[42:43], v18 offset:49664
    v_lshlrev_b32 v128, 4, v0
    v_mfma_f32_16x16x32_bf16 v[180:183], a[4:7], a[28:31], v[180:183]
    ds_read_b64_tr_b16 a[44:45], v19 offset:49152
    v_add_u32 v128, s12, v128
    v_mfma_f32_16x16x32_bf16 v[184:187], a[4:7], a[32:35], v[184:187]
    s_add_u32 s14, s14, 4096
    ds_read_b64_tr_b16 a[46:47], v19 offset:49664
    v_mfma_f32_16x16x32_bf16 v[188:191], a[4:7], a[36:39], v[188:191]
    ds_read_b128 a[68:71], v7 offset:34816
    v_mfma_f32_16x16x32_bf16 v[192:195], a[8:11], a[24:27], v[192:195]
    buffer_load_dwordx4 a[144:147], v26, s[60:63], s14 offen offset:0 sc1
    v_mfma_f32_16x16x32_bf16 v[196:199], a[8:11], a[28:31], v[196:199]
    ds_read_b64_tr_b16 a[48:49], v20 offset:49152
    buffer_load_dwordx4 v[124:127], v128, s[60:63], 0 offen sc1
    v_mfma_f32_16x16x32_bf16 v[200:203], a[8:11], a[32:35], v[200:203]
    ds_read_b64_tr_b16 a[50:51], v20 offset:49664
    v_mfma_f32_16x16x32_bf16 v[204:207], a[8:11], a[36:39], v[204:207]
    s_cmp_gt_u32 s26, 2
    s_cselect_b32 s14, s18, s19
    v_mfma_f32_16x16x32_bf16 v[208:211], a[12:15], a[24:27], v[208:211]
    ds_read_b64_tr_b16 a[52:53], v21 offset:49152
    v_mfma_f32_16x16x32_bf16 v[212:215], a[12:15], a[28:31], v[212:215]
    s_add_u32 s14, s14, 10240
    ds_read_b128 a[72:75], v7 offset:36864
    v_mfma_f32_16x16x32_bf16 v[216:219], a[12:15], a[32:35], v[216:219]
    ds_read_b64_tr_b16 a[54:55], v21 offset:49664
    v_mfma_f32_16x16x32_bf16 v[220:223], a[12:15], a[36:39], v[220:223]
    buffer_load_dwordx4 a[148:151], v26, s[60:63], s14 offen offset:0 sc1
    v_mfma_f32_16x16x32_bf16 v[224:227], a[16:19], a[24:27], v[224:227]
    ds_read_b64_tr_b16 a[56:57], v18 offset:57344
    v_mfma_f32_16x16x32_bf16 v[228:231], a[16:19], a[28:31], v[228:231]
    ds_read_b64_tr_b16 a[58:59], v18 offset:57856
    v_mfma_f32_16x16x32_bf16 v[232:235], a[16:19], a[32:35], v[232:235]
    buffer_load_dwordx4 a[152:155], v26, s[60:63], s14 offen offset:1024 sc1
    v_mfma_f32_16x16x32_bf16 v[236:239], a[16:19], a[36:39], v[236:239]
    ds_read_b128 a[76:79], v7 offset:38912
    v_mfma_f32_16x16x32_bf16 v[240:243], a[20:23], a[24:27], v[240:243]
    ds_read_b64_tr_b16 a[60:61], v19 offset:57344
    v_mfma_f32_16x16x32_bf16 v[244:247], a[20:23], a[28:31], v[244:247]
    buffer_load_dwordx4 a[156:159], v26, s[60:63], s14 offen offset:2048 sc1
    v_mfma_f32_16x16x32_bf16 v[248:251], a[20:23], a[32:35], v[248:251]
    ds_read_b64_tr_b16 a[62:63], v19 offset:57856
    v_mfma_f32_16x16x32_bf16 v[252:255], a[20:23], a[36:39], v[252:255]
    s_waitcnt lgkmcnt(0)
    v_mfma_f32_16x16x32_bf16 v[160:163], a[40:43], a[64:67], v[160:163]
    v_mfma_f32_16x16x32_bf16 v[164:167], a[40:43], a[68:71], v[164:167]
    s_waitcnt vmcnt(14)
    s_barrier
    v_mfma_f32_16x16x32_bf16 v[168:171], a[40:43], a[72:75], v[168:171]
    buffer_load_dwordx4 a[160:163], v26, s[60:63], s14 offen offset:3072 sc1
    v_mfma_f32_16x16x32_bf16 v[172:175], a[40:43], a[76:79], v[172:175]
    ds_read_b64_tr_b16 a[0:1], v14 offset:0
    v_mfma_f32_16x16x32_bf16 v[176:179], a[44:47], a[64:67], v[176:179]
    ds_read_b128 a[24:27], v6 offset:0
    v_mfma_f32_16x16x32_bf16 v[180:183], a[44:47], a[68:71], v[180:183]
    ds_read_b64_tr_b16 a[2:3], v14 offset:512
    v_mfma_f32_16x16x32_bf16 v[184:187], a[44:47], a[72:75], v[184:187]
    s_add_u32 s14, s14, 4096
    v_mfma_f32_16x16x32_bf16 v[188:191], a[44:47], a[76:79], v[188:191]
    ds_read_b64_tr_b16 a[4:5], v15 offset:0
    v_mfma_f32_16x16x32_bf16 v[192:195], a[48:51], a[64:67], v[192:195]
    buffer_load_dwordx4 a[164:167], v26, s[60:63], s14 offen offset:0 sc1
    v_mfma_f32_16x16x32_bf16 v[196:199], a[48:51], a[68:71], v[196:199]
    ds_read_b64_tr_b16 a[6:7], v15 offset:512
    v_mfma_f32_16x16x32_bf16 v[200:203], a[48:51], a[72:75], v[200:203]
    ds_read_b128 a[28:31], v6 offset:2048
    v_mfma_f32_16x16x32_bf16 v[204:207], a[48:51], a[76:79], v[204:207]
    s_cmp_gt_u32 s26, 3
    s_cselect_b32 s14, s18, s19
    v_mfma_f32_16x16x32_bf16 v[208:211], a[52:55], a[64:67], v[208:211]
    ds_read_b64_tr_b16 a[8:9], v16 offset:0
    v_mfma_f32_16x16x32_bf16 v[212:215], a[52:55], a[68:71], v[212:215]
    ds_read_b64_tr_b16 a[10:11], v16 offset:512
    v_mfma_f32_16x16x32_bf16 v[216:219], a[52:55], a[72:75], v[216:219]
    s_add_u32 s14, s14, 15360
    ds_read_b64_tr_b16 a[12:13], v17 offset:0
    v_mfma_f32_16x16x32_bf16 v[220:223], a[52:55], a[76:79], v[220:223]
    ds_read_b128 a[32:35], v6 offset:4096
    v_mfma_f32_16x16x32_bf16 v[224:227], a[56:59], a[64:67], v[224:227]
    buffer_load_dwordx4 a[168:171], v26, s[60:63], s14 offen offset:0 sc1
    v_mfma_f32_16x16x32_bf16 v[228:231], a[56:59], a[68:71], v[228:231]
    ds_read_b64_tr_b16 a[14:15], v17 offset:512
    v_mfma_f32_16x16x32_bf16 v[232:235], a[56:59], a[72:75], v[232:235]
    ds_read_b64_tr_b16 a[16:17], v14 offset:8192
    v_mfma_f32_16x16x32_bf16 v[236:239], a[56:59], a[76:79], v[236:239]
    buffer_load_dwordx4 a[172:175], v26, s[60:63], s14 offen offset:1024 sc1
    v_mfma_f32_16x16x32_bf16 v[240:243], a[60:63], a[64:67], v[240:243]
    ds_read_b64_tr_b16 a[18:19], v14 offset:8704
    v_mfma_f32_16x16x32_bf16 v[244:247], a[60:63], a[68:71], v[244:247]
    ds_read_b128 a[36:39], v6 offset:6144
    v_mfma_f32_16x16x32_bf16 v[248:251], a[60:63], a[72:75], v[248:251]
    ds_read_b64_tr_b16 a[20:21], v15 offset:8192
    v_mfma_f32_16x16x32_bf16 v[252:255], a[60:63], a[76:79], v[252:255]
    buffer_load_dwordx4 a[176:179], v26, s[60:63], s14 offen offset:2048 sc1
    v_mfma_f32_16x16x32_bf16 a[84:87], a[40:43], a[80:83], a[84:87]
    ds_read_b64_tr_b16 a[22:23], v15 offset:8704
    v_mfma_f32_16x16x32_bf16 a[88:91], a[44:47], a[80:83], a[88:91]
    v_mfma_f32_16x16x32_bf16 a[92:95], a[48:51], a[80:83], a[92:95]
    buffer_load_dwordx4 a[180:183], v26, s[60:63], s14 offen offset:3072 sc1
    v_mfma_f32_16x16x32_bf16 a[96:99], a[52:55], a[80:83], a[96:99]
    v_mfma_f32_16x16x32_bf16 a[100:103], a[56:59], a[80:83], a[100:103]
    v_mfma_f32_16x16x32_bf16 a[104:107], a[60:63], a[80:83], a[104:107]
    s_waitcnt lgkmcnt(0)
    v_mfma_f32_16x16x32_bf16 v[160:163], a[0:3], a[24:27], v[160:163]
    s_add_u32 s14, s14, 4096
    ds_read_b64_tr_b16 a[40:41], v18 offset:0
    v_mfma_f32_16x16x32_bf16 v[164:167], a[0:3], a[28:31], v[164:167]
    v_mfma_f32_16x16x32_bf16 v[168:171], a[0:3], a[32:35], v[168:171]
    buffer_load_dwordx4 a[184:187], v26, s[60:63], s14 offen offset:0 sc1
    v_mfma_f32_16x16x32_bf16 v[172:175], a[0:3], a[36:39], v[172:175]
    ds_read_b128 a[64:67], v7 offset:0
    v_mfma_f32_16x16x32_bf16 v[176:179], a[4:7], a[24:27], v[176:179]
    ds_read_b64_tr_b16 a[42:43], v18 offset:512
    v_mfma_f32_16x16x32_bf16 v[180:183], a[4:7], a[28:31], v[180:183]
    s_cmp_gt_u32 s26, 4
    s_cselect_b32 s14, s18, s19
    v_mfma_f32_16x16x32_bf16 v[184:187], a[4:7], a[32:35], v[184:187]
    ds_read_b64_tr_b16 a[44:45], v19 offset:0
    v_mfma_f32_16x16x32_bf16 v[188:191], a[4:7], a[36:39], v[188:191]
    s_add_u32 s14, s14, 20480
    ds_read_b64_tr_b16 a[46:47], v19 offset:512
    v_mfma_f32_16x16x32_bf16 v[192:195], a[8:11], a[24:27], v[192:195]
    ds_read_b128 a[68:71], v7 offset:2048
    v_mfma_f32_16x16x32_bf16 v[196:199], a[8:11], a[28:31], v[196:199]
    buffer_load_dwordx4 a[188:191], v26, s[60:63], s14 offen offset:0 sc1
    v_mfma_f32_16x16x32_bf16 v[200:203], a[8:11], a[32:35], v[200:203]
    ds_read_b64_tr_b16 a[48:49], v20 offset:0
    v_mfma_f32_16x16x32_bf16 v[204:207], a[8:11], a[36:39], v[204:207]
    buffer_load_dwordx4 a[192:195], v26, s[60:63], s14 offen offset:1024 sc1
    v_mfma_f32_16x16x32_bf16 v[208:211], a[12:15], a[24:27], v[208:211]
    ds_read_b64_tr_b16 a[50:51], v20 offset:512
    v_mfma_f32_16x16x32_bf16 v[212:215], a[12:15], a[28:31], v[212:215]
    ds_read_b64_tr_b16 a[52:53], v21 offset:0
    v_mfma_f32_16x16x32_bf16 v[216:219], a[12:15], a[32:35], v[216:219]
    buffer_load_dwordx4 a[196:199], v26, s[60:63], s14 offen offset:2048 sc1
    v_mfma_f32_16x16x32_bf16 v[220:223], a[12:15], a[36:39], v[220:223]
    ds_read_b128 a[72:75], v7 offset:4096
    v_mfma_f32_16x16x32_bf16 v[224:227], a[16:19], a[24:27], v[224:227]
    ds_read_b64_tr_b16 a[54:55], v21 offset:512
    v_mfma_f32_16x16x32_bf16 v[228:231], a[16:19], a[28:31], v[228:231]
    buffer_load_dwordx4 a[200:203], v26, s[60:63], s14 offen offset:3072 sc1
    v_mfma_f32_16x16x32_bf16 v[232:235], a[16:19], a[32:35], v[232:235]
    ds_read_b64_tr_b16 a[56:57], v18 offset:8192
    v_mfma_f32_16x16x32_bf16 v[236:239], a[16:19], a[36:39], v[236:239]
    s_add_u32 s14, s14, 4096
    ds_read_b64_tr_b16 a[58:59], v18 offset:8704
    v_mfma_f32_16x16x32_bf16 v[240:243], a[20:23], a[24:27], v[240:243]
    ds_read_b128 a[76:79], v7 offset:6144
    v_mfma_f32_16x16x32_bf16 v[244:247], a[20:23], a[28:31], v[244:247]
    buffer_load_dwordx4 a[204:207], v26, s[60:63], s14 offen offset:0 sc1
    v_mfma_f32_16x16x32_bf16 v[248:251], a[20:23], a[32:35], v[248:251]
    ds_read_b64_tr_b16 a[60:61], v19 offset:8192
    v_mfma_f32_16x16x32_bf16 v[252:255], a[20:23], a[36:39], v[252:255]
    ds_read_b64_tr_b16 a[62:63], v19 offset:8704
    s_waitcnt lgkmcnt(0)
    v_mfma_f32_16x16x32_bf16 a[84:87], a[40:43], a[80:83], a[84:87]
    v_mfma_f32_16x16x32_bf16 a[88:91], a[44:47], a[80:83], a[88:91]
    s_waitcnt vmcnt(15)
L_chk_rs_mlp:
    v_cmp_ne_u32 vcc, s11, v125
    v_cmp_ne_u32 s[12:13], s11, v127
    s_or_b64 vcc, vcc, s[12:13]
    s_cmp_eq_u64 vcc, 0
    s_cbranch_scc1 L_chkok_rs_mlp
    s_sub_u32 s81, s81, 1
    s_cbranch_scc1 L_end
    buffer_load_dwordx4 v[124:127], v128, s[60:63], 0 offen sc1
    s_waitcnt vmcnt(0)
    s_branch L_chk_rs_mlp
L_chkok_rs_mlp:
    ds_write2_b32 v79, v124, v126 offset0:0 offset1:1
    v_mfma_f32_16x16x32_bf16 a[92:95], a[48:51], a[80:83], a[92:95]
    s_cmp_gt_u32 s26, 5
    s_cselect_b32 s14, s18, s19
    v_mfma_f32_16x16x32_bf16 a[96:99], a[52:55], a[80:83], a[96:99]
    ds_read_b64 v[140:141], v43 offset:2048
    v_mfma_f32_16x16x32_bf16 a[100:103], a[56:59], a[80:83], a[100:103]
    ds_read_b64 v[142:143], v43 offset:2080
    buffer_load_dwordx2 v[14:15], v38, s[52:55], s30 offen offset:0
    v_mfma_f32_16x16x32_bf16 a[104:107], a[60:63], a[80:83], a[104:107]
    s_add_u32 s14, s14, 25600
    ds_read_b64 v[144:145], v43 offset:2112
    v_mfma_f32_16x16x32_bf16 v[160:163], a[40:43], a[64:67], v[160:163]
    buffer_load_dwordx2 v[16:17], v38, s[52:55], s30 offen offset:32
    v_mfma_f32_16x16x32_bf16 v[164:167], a[40:43], a[68:71], v[164:167]
    buffer_load_dwordx4 a[208:211], v26, s[60:63], s14 offen offset:0 sc1
    v_mfma_f32_16x16x32_bf16 v[168:171], a[40:43], a[72:75], v[168:171]
    ds_read_b64 v[146:147], v43 offset:2144
    v_mfma_f32_16x16x32_bf16 v[172:175], a[40:43], a[76:79], v[172:175]
    ds_read_b64 v[148:149], v43 offset:2176
    buffer_load_dwordx2 v[18:19], v38, s[52:55], s30 offen offset:64
    v_mfma_f32_16x16x32_bf16 v[176:179], a[44:47], a[64:67], v[176:179]
    buffer_load_dwordx4 a[212:215], v26, s[60:63], s14 offen offset:1024 sc1
    v_mfma_f32_16x16x32_bf16 v[180:183], a[44:47], a[68:71], v[180:183]
    ds_write_b128 v76, a[84:87] offset:0
    v_mfma_f32_16x16x32_bf16 v[184:187], a[44:47], a[72:75], v[184:187]
    buffer_load_dwordx4 a[216:219], v26, s[60:63], s14 offen offset:2048 sc1
    v_mfma_f32_16x16x32_bf16 v[188:191], a[44:47], a[76:79], v[188:191]
    ds_read_b64 v[150:151], v43 offset:2208
    buffer_load_dwordx2 v[20:21], v38, s[52:55], s30 offen offset:96
    v_mfma_f32_16x16x32_bf16 v[192:195], a[48:51], a[64:67], v[192:195]
    ds_write_b128 v76, a[88:91] offset:64
    v_mfma_f32_16x16x32_bf16 v[196:199], a[48:51], a[68:71], v[196:199]
    buffer_load_dwordx4 a[220:223], v26, s[60:63], s14 offen offset:3072 sc1
    v_mfma_f32_16x16x32_bf16 v[200:203], a[48:51], a[72:75], v[200:203]
    ds_write_b128 v76, a[92:95] offset:128
    buffer_load_dwordx2 v[22:23], v38, s[52:55], s30 offen offset:128
    v_mfma_f32_16x16x32_bf16 v[204:207], a[48:51], a[76:79], v[204:207]
    v_mfma_f32_16x16x32_bf16 v[208:211], a[52:55], a[64:67], v[208:211]
    s_add_u32 s14, s14, 4096
    ds_write_b128 v76, a[96:99] offset:192
    v_mfma_f32_16x16x32_bf16 v[212:215], a[52:55], a[68:71], v[212:215]
    v_mfma_f32_16x16x32_bf16 v[216:219], a[52:55], a[72:75], v[216:219]
    buffer_load_dwordx4 a[224:227], v26, s[60:63], s14 offen offset:0 sc1
    v_mfma_f32_16x16x32_bf16 v[220:223], a[52:55], a[76:79], v[220:223]
    ds_write_b128 v76, a[100:103] offset:256
    v_mfma_f32_16x16x32_bf16 v[224:227], a[56:59], a[64:67], v[224:227]
    s_cmp_gt_u32 s26, 6
    s_cselect_b32 s14, s18, s19
    v_mfma_f32_16x16x32_bf16 v[228:231], a[56:59], a[68:71], v[228:231]
    ds_write_b128 v76, a[104:107] offset:320
    v_mfma_f32_16x16x32_bf16 v[232:235], a[56:59], a[72:75], v[232:235]
    v_mfma_f32_16x16x32_bf16 v[236:239], a[56:59], a[76:79], v[236:239]
    s_add_u32 s14, s14, 30720
    v_mfma_f32_16x16x32_bf16 v[240:243], a[60:63], a[64:67], v[240:243]
    v_mfma_f32_16x16x32_bf16 v[244:247], a[60:63], a[68:71], v[244:247]
    buffer_load_dwordx4 a[228:231], v26, s[60:63], s14 offen offset:0 sc1
    v_mfma_f32_16x16x32_bf16 v[248:251], a[60:63], a[72:75], v[248:251]
    v_mfma_f32_16x16x32_bf16 v[252:255], a[60:63], a[76:79], v[252:255]
    s_waitcnt lgkmcnt(0)
    s_barrier
    ds_read_b128 v[48:51], v78 offset:0
    ds_read_b128 v[52:55], v78 offset:16
    ds_read_b128 v[56:59], v78 offset:32
    ds_read_b128 v[60:63], v78 offset:48
    ds_read_b128 v[100:103], v77 offset:384
    ds_read_b128 v[104:107], v77 offset:448
    ds_read_b128 v[108:111], v77 offset:512
    ds_read_b128 v[112:115], v77 offset:576
    ds_read_b128 v[116:119], v77 offset:640
    ds_read_b128 v[120:123], v77 offset:704
    ds_read_b128 v[64:67], v77 offset:0
    ds_read_b128 v[68:71], v77 offset:64
    ds_read_b128 v[72:75], v77 offset:128
    ds_read_b128 v[80:83], v77 offset:256
    ds_read_b128 v[84:87], v77 offset:320
    ds_read_b128 v[76:79], v77 offset:192
    s_mul_i32 s86, s6, 720896
    s_lshl_b32 s12, s5, 11
    s_add_u32 s86, s86, s12
    s_add_u32 s86, s86, 4096
    s_lshr_b32 s12, s7, 1
    s_mul_i32 s12, s12, 22
    s_and_b32 s13, s7, 1
    s_mul_i32 s13, s13, 6
    s_add_u32 s12, s12, s13
    s_mul_i32 s13, s4, 3
    s_add_u32 s12, s12, s13
    s_lshl_b32 s12, s12, 12
    s_add_u32 s86, s86, s12
    s_waitcnt lgkmcnt(0)
    v_pk_add_f32 v[64:65], v[64:65], v[100:101]
    v_pk_add_f32 v[66:67], v[66:67], v[102:103]
    v_pk_add_f32 v[68:69], v[68:69], v[104:105]
    v_pk_add_f32 v[70:71], v[70:71], v[106:107]
    v_pk_add_f32 v[72:73], v[72:73], v[108:109]
    v_pk_add_f32 v[74:75], v[74:75], v[110:111]
    v_pk_add_f32 v[76:77], v[76:77], v[112:113]
    v_pk_add_f32 v[78:79], v[78:79], v[114:115]
    v_pk_add_f32 v[80:81], v[80:81], v[116:117]
    v_pk_add_f32 v[82:83], v[82:83], v[118:119]
    v_pk_add_f32 v[84:85], v[84:85], v[120:121]
    v_pk_add_f32 v[86:87], v[86:87], v[122:123]
    v_lshlrev_b32 v100, 16, v140
    v_and_b32 v101, 0xffff0000, v140
    v_lshlrev_b32 v102, 16, v141
    v_and_b32 v103, 0xffff0000, v141
    v_lshlrev_b32 v104, 16, v142
    v_and_b32 v105, 0xffff0000, v142
    v_lshlrev_b32 v106, 16, v143
    v_and_b32 v107, 0xffff0000, v143
    v_lshlrev_b32 v108, 16, v144
    v_and_b32 v109, 0xffff0000, v144
    v_lshlrev_b32 v110, 16, v145
    v_and_b32 v111, 0xffff0000, v145
    v_lshlrev_b32 v112, 16, v146
    v_and_b32 v113, 0xffff0000, v146
    v_lshlrev_b32 v114, 16, v147
    v_and_b32 v115, 0xffff0000, v147
    v_lshlrev_b32 v116, 16, v148
    v_and_b32 v117, 0xffff0000, v148
    v_lshlrev_b32 v118, 16, v149
    v_and_b32 v119, 0xffff0000, v149
    v_lshlrev_b32 v120, 16, v150
    v_and_b32 v121, 0xffff0000, v150
    v_lshlrev_b32 v122, 16, v151
    v_and_b32 v123, 0xffff0000, v151
    s_mov_b32 s74, s31
    s_xor_b32 s73, s31, 32
    s_mov_b32 s84, s11
    s_mov_b32 s85, s11
    v_mov_b32 v36, s11
    v_mov_b32 v37, s11
    v_lshlrev_b32 v24, 26, v1
    s_mov_b32 s72, s30
    s_add_u32 s75, s86, 360448
.p2align 3
    v_pk_fma_f32 v[124:125], v[64:65], v[58:59], v[100:101] op_sel:[0,1,0] op_sel_hi:[1,1,1] neg_lo:[0,1,0] neg_hi:[0,1,0]
    v_pk_fma_f32 v[126:127], v[66:67], v[58:59], v[102:103] op_sel:[0,1,0] op_sel_hi:[1,1,1] neg_lo:[0,1,0] neg_hi:[0,1,0]
    v_pk_fma_f32 v[128:129], v[68:69], v[58:59], v[104:105] op_sel:[0,1,0] op_sel_hi:[1,1,1] neg_lo:[0,1,0] neg_hi:[0,1,0]
    v_pk_fma_f32 v[130:131], v[70:71], v[58:59], v[106:107] op_sel:[0,1,0] op_sel_hi:[1,1,1] neg_lo:[0,1,0] neg_hi:[0,1,0]
    v_pk_fma_f32 v[168:169], v[168:169], v[58:59], v[124:125] op_sel:[0,0,0] op_sel_hi:[1,0,1]
    v_pk_fma_f32 v[170:171], v[170:171], v[58:59], v[126:127] op_sel:[0,0,0] op_sel_hi:[1,0,1]
    v_pk_fma_f32 v[184:185], v[184:185], v[58:59], v[128:129] op_sel:[0,0,0] op_sel_hi:[1,0,1]
    v_pk_fma_f32 v[186:187], v[186:187], v[58:59], v[130:131] op_sel:[0,0,0] op_sel_hi:[1,0,1]
    v_pk_mul_f32 v[124:125], v[168:169], v[168:169]
    v_pk_mul_f32 v[126:127], v[170:171], v[170:171]
    v_pk_mul_f32 v[128:129], v[184:185], v[184:185]
    v_pk_mul_f32 v[130:131], v[186:187], v[186:187]
    v_pk_fma_f32 v[124:125], v[124:125], s[82:83], s[82:83] op_sel:[0,0,1] op_sel_hi:[1,0,1]
    v_pk_fma_f32 v[126:127], v[126:127], s[82:83], s[82:83] op_sel:[0,0,1] op_sel_hi:[1,0,1]
    v_pk_fma_f32 v[128:129], v[128:129], s[82:83], s[82:83] op_sel:[0,0,1] op_sel_hi:[1,0,1]
    v_pk_fma_f32 v[130:131], v[130:131], s[82:83], s[82:83] op_sel:[0,0,1] op_sel_hi:[1,0,1]
    v_pk_mul_f32 v[124:125], v[124:125], v[168:169]
    v_pk_mul_f32 v[126:127], v[126:127], v[170:171]
    v_pk_mul_f32 v[128:129], v[128:129], v[184:185]
    v_pk_mul_f32 v[130:131], v[130:131], v[186:187]
    v_exp_f32 v132, v124
    v_exp_f32 v133, v125
    v_exp_f32 v134, v126
    v_exp_f32 v135, v127
    v_exp_f32 v136, v128
    v_exp_f32 v137, v129
    v_exp_f32 v138, v130
    v_exp_f32 v139, v131
    v_pk_add_f32 v[132:133], v[132:133], 1.0 op_sel_hi:[1,0]
    v_pk_add_f32 v[134:135], v[134:135], 1.0 op_sel_hi:[1,0]
    v_pk_add_f32 v[136:137], v[136:137], 1.0 op_sel_hi:[1,0]
    v_pk_add_f32 v[138:139], v[138:139], 1.0 op_sel_hi:[1,0]
    v_rcp_f32 v132, v132
    v_rcp_f32 v133, v133
    v_rcp_f32 v134, v134
    v_rcp_f32 v135, v135
    v_rcp_f32 v136, v136
    v_rcp_f32 v137, v137
    v_rcp_f32 v138, v138
    v_rcp_f32 v139, v139
    v_pk_mul_f32 v[168:169], v[168:169], v[132:133]
    v_pk_mul_f32 v[170:171], v[170:171], v[134:135]
    v_pk_mul_f32 v[184:185], v[184:185], v[136:137]
    v_pk_mul_f32 v[186:187], v[186:187], v[138:139]
    v_cvt_pk_bf16_f32 v88, v168, v169
    v_cvt_pk_bf16_f32 v89, v170, v171
    v_cvt_pk_bf16_f32 v90, v184, v185
    v_cvt_pk_bf16_f32 v91, v186, v187
    buffer_store_dwordx4 v[88:91], v26, s[60:63], s75 offen offset:0 sc1
.p2align 3
    v_pk_fma_f32 v[124:125], v[64:65], v[62:63], v[100:101] op_sel:[0,1,0] op_sel_hi:[1,1,1] neg_lo:[0,1,0] neg_hi:[0,1,0]
    v_pk_fma_f32 v[126:127], v[66:67], v[62:63], v[102:103] op_sel:[0,1,0] op_sel_hi:[1,1,1] neg_lo:[0,1,0] neg_hi:[0,1,0]
    v_pk_fma_f32 v[128:129], v[68:69], v[62:63], v[104:105] op_sel:[0,1,0] op_sel_hi:[1,1,1] neg_lo:[0,1,0] neg_hi:[0,1,0]
    v_pk_fma_f32 v[130:131], v[70:71], v[62:63], v[106:107] op_sel:[0,1,0] op_sel_hi:[1,1,1] neg_lo:[0,1,0] neg_hi:[0,1,0]
    v_pk_fma_f32 v[172:173], v[172:173], v[62:63], v[124:125] op_sel:[0,0,0] op_sel_hi:[1,0,1]
    v_pk_fma_f32 v[174:175], v[174:175], v[62:63], v[126:127] op_sel:[0,0,0] op_sel_hi:[1,0,1]
    v_pk_fma_f32 v[188:189], v[188:189], v[62:63], v[128:129] op_sel:[0,0,0] op_sel_hi:[1,0,1]
    v_pk_fma_f32 v[190:191], v[190:191], v[62:63], v[130:131] op_sel:[0,0,0] op_sel_hi:[1,0,1]
    v_pk_mul_f32 v[124:125], v[172:173], v[172:173]
    v_pk_mul_f32 v[126:127], v[174:175], v[174:175]
    v_pk_mul_f32 v[128:129], v[188:189], v[188:189]
    v_pk_mul_f32 v[130:131], v[190:191], v[190:191]
    v_pk_fma_f32 v[124:125], v[124:125], s[82:83], s[82:83] op_sel:[0,0,1] op_sel_hi:[1,0,1]
    v_pk_fma_f32 v[126:127], v[126:127], s[82:83], s[82:83] op_sel:[0,0,1] op_sel_hi:[1,0,1]
    v_pk_fma_f32 v[128:129], v[128:129], s[82:83], s[82:83] op_sel:[0,0,1] op_sel_hi:[1,0,1]
    v_pk_fma_f32 v[130:131], v[130:131], s[82:83], s[82:83] op_sel:[0,0,1] op_sel_hi:[1,0,1]
    v_pk_mul_f32 v[124:125], v[124:125], v[172:173]
    v_pk_mul_f32 v[126:127], v[126:127], v[174:175]
    v_pk_mul_f32 v[128:129], v[128:129], v[188:189]
    v_pk_mul_f32 v[130:131], v[130:131], v[190:191]
    v_exp_f32 v132, v124
    v_exp_f32 v133, v125
    v_exp_f32 v134, v126
    v_exp_f32 v135, v127
    v_exp_f32 v136, v128
    v_exp_f32 v137, v129
    v_exp_f32 v138, v130
    v_exp_f32 v139, v131
    v_pk_add_f32 v[132:133], v[132:133], 1.0 op_sel_hi:[1,0]
    v_pk_add_f32 v[134:135], v[134:135], 1.0 op_sel_hi:[1,0]
    v_pk_add_f32 v[136:137], v[136:137], 1.0 op_sel_hi:[1,0]
    v_pk_add_f32 v[138:139], v[138:139], 1.0 op_sel_hi:[1,0]
    v_rcp_f32 v132, v132
    v_rcp_f32 v133, v133
    v_rcp_f32 v134, v134
    v_rcp_f32 v135, v135
    v_rcp_f32 v136, v136
    v_rcp_f32 v137, v137
    v_rcp_f32 v138, v138
    v_rcp_f32 v139, v139
    v_pk_mul_f32 v[172:173], v[172:173], v[132:133]
    v_pk_mul_f32 v[174:175], v[174:175], v[134:135]
    v_pk_mul_f32 v[188:189], v[188:189], v[136:137]
    v_pk_mul_f32 v[190:191], v[190:191], v[138:139]
    v_cvt_pk_bf16_f32 v92, v172, v173
    v_cvt_pk_bf16_f32 v93, v174, v175
    v_cvt_pk_bf16_f32 v94, v188, v189
    v_cvt_pk_bf16_f32 v95, v190, v191
    buffer_store_dwordx4 v[92:95], v26, s[60:63], s75 offen offset:1024 sc1
    s_add_u32 s75, s75, 4096
.p2align 3
    v_pk_fma_f32 v[124:125], v[72:73], v[58:59], v[108:109] op_sel:[0,1,0] op_sel_hi:[1,1,1] neg_lo:[0,1,0] neg_hi:[0,1,0]
    v_pk_fma_f32 v[126:127], v[74:75], v[58:59], v[110:111] op_sel:[0,1,0] op_sel_hi:[1,1,1] neg_lo:[0,1,0] neg_hi:[0,1,0]
    v_pk_fma_f32 v[128:129], v[76:77], v[58:59], v[112:113] op_sel:[0,1,0] op_sel_hi:[1,1,1] neg_lo:[0,1,0] neg_hi:[0,1,0]
    v_pk_fma_f32 v[130:131], v[78:79], v[58:59], v[114:115] op_sel:[0,1,0] op_sel_hi:[1,1,1] neg_lo:[0,1,0] neg_hi:[0,1,0]
    v_pk_fma_f32 v[200:201], v[200:201], v[58:59], v[124:125] op_sel:[0,0,0] op_sel_hi:[1,0,1]
    v_pk_fma_f32 v[202:203], v[202:203], v[58:59], v[126:127] op_sel:[0,0,0] op_sel_hi:[1,0,1]
    v_pk_fma_f32 v[216:217], v[216:217], v[58:59], v[128:129] op_sel:[0,0,0] op_sel_hi:[1,0,1]
    v_pk_fma_f32 v[218:219], v[218:219], v[58:59], v[130:131] op_sel:[0,0,0] op_sel_hi:[1,0,1]
    v_pk_mul_f32 v[124:125], v[200:201], v[200:201]
    v_pk_mul_f32 v[126:127], v[202:203], v[202:203]
    v_pk_mul_f32 v[128:129], v[216:217], v[216:217]
    v_pk_mul_f32 v[130:131], v[218:219], v[218:219]
    v_pk_fma_f32 v[124:125], v[124:125], s[82:83], s[82:83] op_sel:[0,0,1] op_sel_hi:[1,0,1]
    v_pk_fma_f32 v[126:127], v[126:127], s[82:83], s[82:83] op_sel:[0,0,1] op_sel_hi:[1,0,1]
    v_pk_fma_f32 v[128:129], v[128:129], s[82:83], s[82:83] op_sel:[0,0,1] op_sel_hi:[1,0,1]
    v_pk_fma_f32 v[130:131], v[130:131], s[82:83], s[82:83] op_sel:[0,0,1] op_sel_hi:[1,0,1]
    v_pk_mul_f32 v[124:125], v[124:125], v[200:201]
    v_pk_mul_f32 v[126:127], v[126:127], v[202:203]
    v_pk_mul_f32 v[128:129], v[128:129], v[216:217]
    v_pk_mul_f32 v[130:131], v[130:131], v[218:219]
    v_exp_f32 v132, v124
    v_exp_f32 v133, v125
    v_exp_f32 v134, v126
    v_exp_f32 v135, v127
    v_exp_f32 v136, v128
    v_exp_f32 v137, v129
    v_exp_f32 v138, v130
    v_exp_f32 v139, v131
    v_pk_add_f32 v[132:133], v[132:133], 1.0 op_sel_hi:[1,0]
    v_pk_add_f32 v[134:135], v[134:135], 1.0 op_sel_hi:[1,0]
    v_pk_add_f32 v[136:137], v[136:137], 1.0 op_sel_hi:[1,0]
    v_pk_add_f32 v[138:139], v[138:139], 1.0 op_sel_hi:[1,0]
    v_rcp_f32 v132, v132
    v_rcp_f32 v133, v133
    v_rcp_f32 v134, v134
    v_rcp_f32 v135, v135
    v_rcp_f32 v136, v136
    v_rcp_f32 v137, v137
    v_rcp_f32 v138, v138
    v_rcp_f32 v139, v139
    v_pk_mul_f32 v[200:201], v[200:201], v[132:133]
    v_pk_mul_f32 v[202:203], v[202:203], v[134:135]
    v_pk_mul_f32 v[216:217], v[216:217], v[136:137]
    v_pk_mul_f32 v[218:219], v[218:219], v[138:139]
    v_cvt_pk_bf16_f32 v88, v200, v201
    v_cvt_pk_bf16_f32 v89, v202, v203
    v_cvt_pk_bf16_f32 v90, v216, v217
    v_cvt_pk_bf16_f32 v91, v218, v219
    buffer_store_dwordx4 v[88:91], v26, s[60:63], s75 offen offset:0 sc1
.p2align 3
    v_pk_fma_f32 v[124:125], v[72:73], v[62:63], v[108:109] op_sel:[0,1,0] op_sel_hi:[1,1,1] neg_lo:[0,1,0] neg_hi:[0,1,0]
    v_pk_fma_f32 v[126:127], v[74:75], v[62:63], v[110:111] op_sel:[0,1,0] op_sel_hi:[1,1,1] neg_lo:[0,1,0] neg_hi:[0,1,0]
    v_pk_fma_f32 v[128:129], v[76:77], v[62:63], v[112:113] op_sel:[0,1,0] op_sel_hi:[1,1,1] neg_lo:[0,1,0] neg_hi:[0,1,0]
    v_pk_fma_f32 v[130:131], v[78:79], v[62:63], v[114:115] op_sel:[0,1,0] op_sel_hi:[1,1,1] neg_lo:[0,1,0] neg_hi:[0,1,0]
    v_pk_fma_f32 v[204:205], v[204:205], v[62:63], v[124:125] op_sel:[0,0,0] op_sel_hi:[1,0,1]
    v_pk_fma_f32 v[206:207], v[206:207], v[62:63], v[126:127] op_sel:[0,0,0] op_sel_hi:[1,0,1]
    v_pk_fma_f32 v[220:221], v[220:221], v[62:63], v[128:129] op_sel:[0,0,0] op_sel_hi:[1,0,1]
    v_pk_fma_f32 v[222:223], v[222:223], v[62:63], v[130:131] op_sel:[0,0,0] op_sel_hi:[1,0,1]
    v_pk_mul_f32 v[124:125], v[204:205], v[204:205]
    v_pk_mul_f32 v[126:127], v[206:207], v[206:207]
    v_pk_mul_f32 v[128:129], v[220:221], v[220:221]
    v_pk_mul_f32 v[130:131], v[222:223], v[222:223]
    v_pk_fma_f32 v[124:125], v[124:125], s[82:83], s[82:83] op_sel:[0,0,1] op_sel_hi:[1,0,1]
    v_pk_fma_f32 v[126:127], v[126:127], s[82:83], s[82:83] op_sel:[0,0,1] op_sel_hi:[1,0,1]
    v_pk_fma_f32 v[128:129], v[128:129], s[82:83], s[82:83] op_sel:[0,0,1] op_sel_hi:[1,0,1]
    v_pk_fma_f32 v[130:131], v[130:131], s[82:83], s[82:83] op_sel:[0,0,1] op_sel_hi:[1,0,1]
    v_pk_mul_f32 v[124:125], v[124:125], v[204:205]
    v_pk_mul_f32 v[126:127], v[126:127], v[206:207]
    v_pk_mul_f32 v[128:129], v[128:129], v[220:221]
    v_pk_mul_f32 v[130:131], v[130:131], v[222:223]
    v_exp_f32 v132, v124
    v_exp_f32 v133, v125
    v_exp_f32 v134, v126
    v_exp_f32 v135, v127
    v_exp_f32 v136, v128
    v_exp_f32 v137, v129
    v_exp_f32 v138, v130
    v_exp_f32 v139, v131
    v_pk_add_f32 v[132:133], v[132:133], 1.0 op_sel_hi:[1,0]
    v_pk_add_f32 v[134:135], v[134:135], 1.0 op_sel_hi:[1,0]
    v_pk_add_f32 v[136:137], v[136:137], 1.0 op_sel_hi:[1,0]
    v_pk_add_f32 v[138:139], v[138:139], 1.0 op_sel_hi:[1,0]
    v_rcp_f32 v132, v132
    v_rcp_f32 v133, v133
    v_rcp_f32 v134, v134
    v_rcp_f32 v135, v135
    v_rcp_f32 v136, v136
    v_rcp_f32 v137, v137
    v_rcp_f32 v138, v138
    v_rcp_f32 v139, v139
    v_pk_mul_f32 v[204:205], v[204:205], v[132:133]
    v_pk_mul_f32 v[206:207], v[206:207], v[134:135]
    v_pk_mul_f32 v[220:221], v[220:221], v[136:137]
    v_pk_mul_f32 v[222:223], v[222:223], v[138:139]
    v_cvt_pk_bf16_f32 v92, v204, v205
    v_cvt_pk_bf16_f32 v93, v206, v207
    v_cvt_pk_bf16_f32 v94, v220, v221
    v_cvt_pk_bf16_f32 v95, v222, v223
    buffer_store_dwordx4 v[92:95], v26, s[60:63], s75 offen offset:1024 sc1
    s_add_u32 s75, s75, 4096
.p2align 3
    v_pk_fma_f32 v[124:125], v[80:81], v[58:59], v[116:117] op_sel:[0,1,0] op_sel_hi:[1,1,1] neg_lo:[0,1,0] neg_hi:[0,1,0]
    v_pk_fma_f32 v[126:127], v[82:83], v[58:59], v[118:119] op_sel:[0,1,0] op_sel_hi:[1,1,1] neg_lo:[0,1,0] neg_hi:[0,1,0]
    v_pk_fma_f32 v[128:129], v[84:85], v[58:59], v[120:121] op_sel:[0,1,0] op_sel_hi:[1,1,1] neg_lo:[0,1,0] neg_hi:[0,1,0]
    v_pk_fma_f32 v[130:131], v[86:87], v[58:59], v[122:123] op_sel:[0,1,0] op_sel_hi:[1,1,1] neg_lo:[0,1,0] neg_hi:[0,1,0]
    v_pk_fma_f32 v[232:233], v[232:233], v[58:59], v[124:125] op_sel:[0,0,0] op_sel_hi:[1,0,1]
    v_pk_fma_f32 v[234:235], v[234:235], v[58:59], v[126:127] op_sel:[0,0,0] op_sel_hi:[1,0,1]
    v_pk_fma_f32 v[248:249], v[248:249], v[58:59], v[128:129] op_sel:[0,0,0] op_sel_hi:[1,0,1]
    v_pk_fma_f32 v[250:251], v[250:251], v[58:59], v[130:131] op_sel:[0,0,0] op_sel_hi:[1,0,1]
    v_pk_mul_f32 v[124:125], v[232:233], v[232:233]
    v_pk_mul_f32 v[126:127], v[234:235], v[234:235]
    v_pk_mul_f32 v[128:129], v[248:249], v[248:249]
    v_pk_mul_f32 v[130:131], v[250:251], v[250:251]
    v_pk_fma_f32 v[124:125], v[124:125], s[82:83], s[82:83] op_sel:[0,0,1] op_sel_hi:[1,0,1]
    v_pk_fma_f32 v[126:127], v[126:127], s[82:83], s[82:83] op_sel:[0,0,1] op_sel_hi:[1,0,1]
    v_pk_fma_f32 v[128:129], v[128:129], s[82:83], s[82:83] op_sel:[0,0,1] op_sel_hi:[1,0,1]
    v_pk_fma_f32 v[130:131], v[130:131], s[82:83], s[82:83] op_sel:[0,0,1] op_sel_hi:[1,0,1]
    v_pk_mul_f32 v[124:125], v[124:125], v[232:233]
    v_pk_mul_f32 v[126:127], v[126:127], v[234:235]
    v_pk_mul_f32 v[128:129], v[128:129], v[248:249]
    v_pk_mul_f32 v[130:131], v[130:131], v[250:251]
    v_exp_f32 v132, v124
    v_exp_f32 v133, v125
    v_exp_f32 v134, v126
    v_exp_f32 v135, v127
    v_exp_f32 v136, v128
    v_exp_f32 v137, v129
    v_exp_f32 v138, v130
    v_exp_f32 v139, v131
    v_pk_add_f32 v[132:133], v[132:133], 1.0 op_sel_hi:[1,0]
    v_pk_add_f32 v[134:135], v[134:135], 1.0 op_sel_hi:[1,0]
    v_pk_add_f32 v[136:137], v[136:137], 1.0 op_sel_hi:[1,0]
    v_pk_add_f32 v[138:139], v[138:139], 1.0 op_sel_hi:[1,0]
    v_rcp_f32 v132, v132
    v_rcp_f32 v133, v133
    v_rcp_f32 v134, v134
    v_rcp_f32 v135, v135
    v_rcp_f32 v136, v136
    v_rcp_f32 v137, v137
    v_rcp_f32 v138, v138
    v_rcp_f32 v139, v139
    v_pk_mul_f32 v[232:233], v[232:233], v[132:133]
    v_pk_mul_f32 v[234:235], v[234:235], v[134:135]
    v_pk_mul_f32 v[248:249], v[248:249], v[136:137]
    v_pk_mul_f32 v[250:251], v[250:251], v[138:139]
    v_cvt_pk_bf16_f32 v88, v232, v233
    v_cvt_pk_bf16_f32 v89, v234, v235
    v_cvt_pk_bf16_f32 v90, v248, v249
    v_cvt_pk_bf16_f32 v91, v250, v251
    buffer_store_dwordx4 v[88:91], v26, s[60:63], s75 offen offset:0 sc1
.p2align 3
    v_pk_fma_f32 v[124:125], v[80:81], v[62:63], v[116:117] op_sel:[0,1,0] op_sel_hi:[1,1,1] neg_lo:[0,1,0] neg_hi:[0,1,0]
    v_pk_fma_f32 v[126:127], v[82:83], v[62:63], v[118:119] op_sel:[0,1,0] op_sel_hi:[1,1,1] neg_lo:[0,1,0] neg_hi:[0,1,0]
    v_pk_fma_f32 v[128:129], v[84:85], v[62:63], v[120:121] op_sel:[0,1,0] op_sel_hi:[1,1,1] neg_lo:[0,1,0] neg_hi:[0,1,0]
    v_pk_fma_f32 v[130:131], v[86:87], v[62:63], v[122:123] op_sel:[0,1,0] op_sel_hi:[1,1,1] neg_lo:[0,1,0] neg_hi:[0,1,0]
    v_pk_fma_f32 v[236:237], v[236:237], v[62:63], v[124:125] op_sel:[0,0,0] op_sel_hi:[1,0,1]
    v_pk_fma_f32 v[238:239], v[238:239], v[62:63], v[126:127] op_sel:[0,0,0] op_sel_hi:[1,0,1]
    v_pk_fma_f32 v[252:253], v[252:253], v[62:63], v[128:129] op_sel:[0,0,0] op_sel_hi:[1,0,1]
    v_pk_fma_f32 v[254:255], v[254:255], v[62:63], v[130:131] op_sel:[0,0,0] op_sel_hi:[1,0,1]
    v_pk_mul_f32 v[124:125], v[236:237], v[236:237]
    v_pk_mul_f32 v[126:127], v[238:239], v[238:239]
    v_pk_mul_f32 v[128:129], v[252:253], v[252:253]
    v_pk_mul_f32 v[130:131], v[254:255], v[254:255]
    v_pk_fma_f32 v[124:125], v[124:125], s[82:83], s[82:83] op_sel:[0,0,1] op_sel_hi:[1,0,1]
    v_pk_fma_f32 v[126:127], v[126:127], s[82:83], s[82:83] op_sel:[0,0,1] op_sel_hi:[1,0,1]
    v_pk_fma_f32 v[128:129], v[128:129], s[82:83], s[82:83] op_sel:[0,0,1] op_sel_hi:[1,0,1]
    v_pk_fma_f32 v[130:131], v[130:131], s[82:83], s[82:83] op_sel:[0,0,1] op_sel_hi:[1,0,1]
    v_pk_mul_f32 v[124:125], v[124:125], v[236:237]
    v_pk_mul_f32 v[126:127], v[126:127], v[238:239]
    v_pk_mul_f32 v[128:129], v[128:129], v[252:253]
    v_pk_mul_f32 v[130:131], v[130:131], v[254:255]
    v_exp_f32 v132, v124
    v_exp_f32 v133, v125
    v_exp_f32 v134, v126
    v_exp_f32 v135, v127
    v_exp_f32 v136, v128
    v_exp_f32 v137, v129
    v_exp_f32 v138, v130
    v_exp_f32 v139, v131
    v_pk_add_f32 v[132:133], v[132:133], 1.0 op_sel_hi:[1,0]
    v_pk_add_f32 v[134:135], v[134:135], 1.0 op_sel_hi:[1,0]
    v_pk_add_f32 v[136:137], v[136:137], 1.0 op_sel_hi:[1,0]
    v_pk_add_f32 v[138:139], v[138:139], 1.0 op_sel_hi:[1,0]
    v_rcp_f32 v132, v132
    v_rcp_f32 v133, v133
    v_rcp_f32 v134, v134
    v_rcp_f32 v135, v135
    v_rcp_f32 v136, v136
    v_rcp_f32 v137, v137
    v_rcp_f32 v138, v138
    v_rcp_f32 v139, v139
    v_pk_mul_f32 v[236:237], v[236:237], v[132:133]
    v_pk_mul_f32 v[238:239], v[238:239], v[134:135]
    v_pk_mul_f32 v[252:253], v[252:253], v[136:137]
    v_pk_mul_f32 v[254:255], v[254:255], v[138:139]
    v_cvt_pk_bf16_f32 v92, v236, v237
    v_cvt_pk_bf16_f32 v93, v238, v239
    v_cvt_pk_bf16_f32 v94, v252, v253
    v_cvt_pk_bf16_f32 v95, v254, v255
    buffer_store_dwordx4 v[92:95], v26, s[60:63], s75 offen offset:1024 sc1
.p2align 3
    v_pk_fma_f32 v[124:125], v[64:65], v[50:51], v[100:101] op_sel:[0,1,0] op_sel_hi:[1,1,1] neg_lo:[0,1,0] neg_hi:[0,1,0]
    v_pk_fma_f32 v[126:127], v[66:67], v[50:51], v[102:103] op_sel:[0,1,0] op_sel_hi:[1,1,1] neg_lo:[0,1,0] neg_hi:[0,1,0]
    v_pk_fma_f32 v[128:129], v[68:69], v[50:51], v[104:105] op_sel:[0,1,0] op_sel_hi:[1,1,1] neg_lo:[0,1,0] neg_hi:[0,1,0]
    v_pk_fma_f32 v[130:131], v[70:71], v[50:51], v[106:107] op_sel:[0,1,0] op_sel_hi:[1,1,1] neg_lo:[0,1,0] neg_hi:[0,1,0]
    v_pk_fma_f32 v[160:161], v[160:161], v[50:51], v[124:125] op_sel:[0,0,0] op_sel_hi:[1,0,1]
    v_pk_fma_f32 v[162:163], v[162:163], v[50:51], v[126:127] op_sel:[0,0,0] op_sel_hi:[1,0,1]
    v_pk_fma_f32 v[176:177], v[176:177], v[50:51], v[128:129] op_sel:[0,0,0] op_sel_hi:[1,0,1]
    v_pk_fma_f32 v[178:179], v[178:179], v[50:51], v[130:131] op_sel:[0,0,0] op_sel_hi:[1,0,1]
    v_pk_mul_f32 v[124:125], v[160:161], v[160:161]
    v_pk_mul_f32 v[126:127], v[162:163], v[162:163]
    v_pk_mul_f32 v[128:129], v[176:177], v[176:177]
    v_pk_mul_f32 v[130:131], v[178:179], v[178:179]
    v_pk_fma_f32 v[124:125], v[124:125], s[82:83], s[82:83] op_sel:[0,0,1] op_sel_hi:[1,0,1]
    v_pk_fma_f32 v[126:127], v[126:127], s[82:83], s[82:83] op_sel:[0,0,1] op_sel_hi:[1,0,1]
    v_pk_fma_f32 v[128:129], v[128:129], s[82:83], s[82:83] op_sel:[0,0,1] op_sel_hi:[1,0,1]
    v_pk_fma_f32 v[130:131], v[130:131], s[82:83], s[82:83] op_sel:[0,0,1] op_sel_hi:[1,0,1]
    v_pk_mul_f32 v[124:125], v[124:125], v[160:161]
    v_pk_mul_f32 v[126:127], v[126:127], v[162:163]
    v_pk_mul_f32 v[128:129], v[128:129], v[176:177]
    v_pk_mul_f32 v[130:131], v[130:131], v[178:179]
    v_exp_f32 v132, v124
    v_exp_f32 v133, v125
    v_exp_f32 v134, v126
    v_exp_f32 v135, v127
    v_exp_f32 v136, v128
    v_exp_f32 v137, v129
    v_exp_f32 v138, v130
    v_exp_f32 v139, v131
    v_pk_add_f32 v[132:133], v[132:133], 1.0 op_sel_hi:[1,0]
    v_pk_add_f32 v[134:135], v[134:135], 1.0 op_sel_hi:[1,0]
    v_pk_add_f32 v[136:137], v[136:137], 1.0 op_sel_hi:[1,0]
    v_pk_add_f32 v[138:139], v[138:139], 1.0 op_sel_hi:[1,0]
    v_rcp_f32 v132, v132
    v_rcp_f32 v133, v133
    v_rcp_f32 v134, v134
    v_rcp_f32 v135, v135
    v_rcp_f32 v136, v136
    v_rcp_f32 v137, v137
    v_rcp_f32 v138, v138
    v_rcp_f32 v139, v139
    v_pk_mul_f32 v[160:161], v[160:161], v[132:133]
    v_pk_mul_f32 v[162:163], v[162:163], v[134:135]
    v_pk_mul_f32 v[176:177], v[176:177], v[136:137]
    v_pk_mul_f32 v[178:179], v[178:179], v[138:139]
    v_cvt_pk_bf16_f32 v88, v160, v161
    v_cvt_pk_bf16_f32 v89, v162, v163
    v_cvt_pk_bf16_f32 v90, v176, v177
    v_cvt_pk_bf16_f32 v91, v178, v179
    buffer_store_dwordx4 v[88:91], v26, s[60:63], s86 offen offset:0 sc1
    s_waitcnt vmcnt(1)
    buffer_store_dwordx2 v[36:37], v24, s[60:63], s74 offen sc1
.p2align 3
    v_pk_fma_f32 v[124:125], v[64:65], v[54:55], v[100:101] op_sel:[0,1,0] op_sel_hi:[1,1,1] neg_lo:[0,1,0] neg_hi:[0,1,0]
    v_pk_fma_f32 v[126:127], v[66:67], v[54:55], v[102:103] op_sel:[0,1,0] op_sel_hi:[1,1,1] neg_lo:[0,1,0] neg_hi:[0,1,0]
    v_pk_fma_f32 v[128:129], v[68:69], v[54:55], v[104:105] op_sel:[0,1,0] op_sel_hi:[1,1,1] neg_lo:[0,1,0] neg_hi:[0,1,0]
    v_pk_fma_f32 v[130:131], v[70:71], v[54:55], v[106:107] op_sel:[0,1,0] op_sel_hi:[1,1,1] neg_lo:[0,1,0] neg_hi:[0,1,0]
    v_pk_fma_f32 v[164:165], v[164:165], v[54:55], v[124:125] op_sel:[0,0,0] op_sel_hi:[1,0,1]
    v_pk_fma_f32 v[166:167], v[166:167], v[54:55], v[126:127] op_sel:[0,0,0] op_sel_hi:[1,0,1]
    v_pk_fma_f32 v[180:181], v[180:181], v[54:55], v[128:129] op_sel:[0,0,0] op_sel_hi:[1,0,1]
    v_pk_fma_f32 v[182:183], v[182:183], v[54:55], v[130:131] op_sel:[0,0,0] op_sel_hi:[1,0,1]
    v_pk_mul_f32 v[124:125], v[164:165], v[164:165]
    v_pk_mul_f32 v[126:127], v[166:167], v[166:167]
    v_pk_mul_f32 v[128:129], v[180:181], v[180:181]
    v_pk_mul_f32 v[130:131], v[182:183], v[182:183]
    v_pk_fma_f32 v[124:125], v[124:125], s[82:83], s[82:83] op_sel:[0,0,1] op_sel_hi:[1,0,1]
    v_pk_fma_f32 v[126:127], v[126:127], s[82:83], s[82:83] op_sel:[0,0,1] op_sel_hi:[1,0,1]
    v_pk_fma_f32 v[128:129], v[128:129], s[82:83], s[82:83] op_sel:[0,0,1] op_sel_hi:[1,0,1]
    v_pk_fma_f32 v[130:131], v[130:131], s[82:83], s[82:83] op_sel:[0,0,1] op_sel_hi:[1,0,1]
    v_pk_mul_f32 v[124:125], v[124:125], v[164:165]
    v_pk_mul_f32 v[126:127], v[126:127], v[166:167]
    v_pk_mul_f32 v[128:129], v[128:129], v[180:181]
    v_pk_mul_f32 v[130:131], v[130:131], v[182:183]
    v_exp_f32 v132, v124
    v_exp_f32 v133, v125
    v_exp_f32 v134, v126
    v_exp_f32 v135, v127
    v_exp_f32 v136, v128
    v_exp_f32 v137, v129
    v_exp_f32 v138, v130
    v_exp_f32 v139, v131
    v_pk_add_f32 v[132:133], v[132:133], 1.0 op_sel_hi:[1,0]
    v_pk_add_f32 v[134:135], v[134:135], 1.0 op_sel_hi:[1,0]
    v_pk_add_f32 v[136:137], v[136:137], 1.0 op_sel_hi:[1,0]
    v_pk_add_f32 v[138:139], v[138:139], 1.0 op_sel_hi:[1,0]
    v_rcp_f32 v132, v132
    v_rcp_f32 v133, v133
    v_rcp_f32 v134, v134
    v_rcp_f32 v135, v135
    v_rcp_f32 v136, v136
    v_rcp_f32 v137, v137
    v_rcp_f32 v138, v138
    v_rcp_f32 v139, v139
    v_pk_mul_f32 v[164:165], v[164:165], v[132:133]
    v_pk_mul_f32 v[166:167], v[166:167], v[134:135]
    v_pk_mul_f32 v[180:181], v[180:181], v[136:137]
    v_pk_mul_f32 v[182:183], v[182:183], v[138:139]
    v_cvt_pk_bf16_f32 v92, v164, v165
    v_cvt_pk_bf16_f32 v93, v166, v167
    v_cvt_pk_bf16_f32 v94, v180, v181
    v_cvt_pk_bf16_f32 v95, v182, v183
    buffer_store_dwordx4 v[92:95], v26, s[60:63], s86 offen offset:1024 sc1
    s_add_u32 s86, s86, 4096
.p2align 3
    v_pk_fma_f32 v[124:125], v[72:73], v[50:51], v[108:109] op_sel:[0,1,0] op_sel_hi:[1,1,1] neg_lo:[0,1,0] neg_hi:[0,1,0]
    v_pk_fma_f32 v[126:127], v[74:75], v[50:51], v[110:111] op_sel:[0,1,0] op_sel_hi:[1,1,1] neg_lo:[0,1,0] neg_hi:[0,1,0]
    v_pk_fma_f32 v[128:129], v[76:77], v[50:51], v[112:113] op_sel:[0,1,0] op_sel_hi:[1,1,1] neg_lo:[0,1,0] neg_hi:[0,1,0]
    v_pk_fma_f32 v[130:131], v[78:79], v[50:51], v[114:115] op_sel:[0,1,0] op_sel_hi:[1,1,1] neg_lo:[0,1,0] neg_hi:[0,1,0]
    v_pk_fma_f32 v[192:193], v[192:193], v[50:51], v[124:125] op_sel:[0,0,0] op_sel_hi:[1,0,1]
    v_pk_fma_f32 v[194:195], v[194:195], v[50:51], v[126:127] op_sel:[0,0,0] op_sel_hi:[1,0,1]
    v_pk_fma_f32 v[208:209], v[208:209], v[50:51], v[128:129] op_sel:[0,0,0] op_sel_hi:[1,0,1]
    v_pk_fma_f32 v[210:211], v[210:211], v[50:51], v[130:131] op_sel:[0,0,0] op_sel_hi:[1,0,1]
    v_pk_mul_f32 v[124:125], v[192:193], v[192:193]
    v_pk_mul_f32 v[126:127], v[194:195], v[194:195]
    v_pk_mul_f32 v[128:129], v[208:209], v[208:209]
    v_pk_mul_f32 v[130:131], v[210:211], v[210:211]
    v_pk_fma_f32 v[124:125], v[124:125], s[82:83], s[82:83] op_sel:[0,0,1] op_sel_hi:[1,0,1]
    v_pk_fma_f32 v[126:127], v[126:127], s[82:83], s[82:83] op_sel:[0,0,1] op_sel_hi:[1,0,1]
    v_pk_fma_f32 v[128:129], v[128:129], s[82:83], s[82:83] op_sel:[0,0,1] op_sel_hi:[1,0,1]
    v_pk_fma_f32 v[130:131], v[130:131], s[82:83], s[82:83] op_sel:[0,0,1] op_sel_hi:[1,0,1]
    v_pk_mul_f32 v[124:125], v[124:125], v[192:193]
    v_pk_mul_f32 v[126:127], v[126:127], v[194:195]
    v_pk_mul_f32 v[128:129], v[128:129], v[208:209]
    v_pk_mul_f32 v[130:131], v[130:131], v[210:211]
    v_exp_f32 v132, v124
    v_exp_f32 v133, v125
    v_exp_f32 v134, v126
    v_exp_f32 v135, v127
    v_exp_f32 v136, v128
    v_exp_f32 v137, v129
    v_exp_f32 v138, v130
    v_exp_f32 v139, v131
    v_pk_add_f32 v[132:133], v[132:133], 1.0 op_sel_hi:[1,0]
    v_pk_add_f32 v[134:135], v[134:135], 1.0 op_sel_hi:[1,0]
    v_pk_add_f32 v[136:137], v[136:137], 1.0 op_sel_hi:[1,0]
    v_pk_add_f32 v[138:139], v[138:139], 1.0 op_sel_hi:[1,0]
    v_rcp_f32 v132, v132
    v_rcp_f32 v133, v133
    v_rcp_f32 v134, v134
    v_rcp_f32 v135, v135
    v_rcp_f32 v136, v136
    v_rcp_f32 v137, v137
    v_rcp_f32 v138, v138
    v_rcp_f32 v139, v139
    v_pk_mul_f32 v[192:193], v[192:193], v[132:133]
    v_pk_mul_f32 v[194:195], v[194:195], v[134:135]
    v_pk_mul_f32 v[208:209], v[208:209], v[136:137]
    v_pk_mul_f32 v[210:211], v[210:211], v[138:139]
    v_cvt_pk_bf16_f32 v88, v192, v193
    v_cvt_pk_bf16_f32 v89, v194, v195
    v_cvt_pk_bf16_f32 v90, v208, v209
    v_cvt_pk_bf16_f32 v91, v210, v211
    buffer_store_dwordx4 v[88:91], v26, s[60:63], s86 offen offset:0 sc1
    s_add_u32 s12, s32, 128
    s_load_dwordx8 s[36:43], s[48:49], s32 glc
    s_load_dwordx8 s[64:71], s[48:49], s12 glc
.p2align 3
    v_pk_fma_f32 v[124:125], v[72:73], v[54:55], v[108:109] op_sel:[0,1,0] op_sel_hi:[1,1,1] neg_lo:[0,1,0] neg_hi:[0,1,0]
    v_pk_fma_f32 v[126:127], v[74:75], v[54:55], v[110:111] op_sel:[0,1,0] op_sel_hi:[1,1,1] neg_lo:[0,1,0] neg_hi:[0,1,0]
    v_pk_fma_f32 v[128:129], v[76:77], v[54:55], v[112:113] op_sel:[0,1,0] op_sel_hi:[1,1,1] neg_lo:[0,1,0] neg_hi:[0,1,0]
    v_pk_fma_f32 v[130:131], v[78:79], v[54:55], v[114:115] op_sel:[0,1,0] op_sel_hi:[1,1,1] neg_lo:[0,1,0] neg_hi:[0,1,0]
    v_pk_fma_f32 v[196:197], v[196:197], v[54:55], v[124:125] op_sel:[0,0,0] op_sel_hi:[1,0,1]
    v_pk_fma_f32 v[198:199], v[198:199], v[54:55], v[126:127] op_sel:[0,0,0] op_sel_hi:[1,0,1]
    v_pk_fma_f32 v[212:213], v[212:213], v[54:55], v[128:129] op_sel:[0,0,0] op_sel_hi:[1,0,1]
    v_pk_fma_f32 v[214:215], v[214:215], v[54:55], v[130:131] op_sel:[0,0,0] op_sel_hi:[1,0,1]
    v_pk_mul_f32 v[124:125], v[196:197], v[196:197]
    v_pk_mul_f32 v[126:127], v[198:199], v[198:199]
    v_pk_mul_f32 v[128:129], v[212:213], v[212:213]
    v_pk_mul_f32 v[130:131], v[214:215], v[214:215]
    v_pk_fma_f32 v[124:125], v[124:125], s[82:83], s[82:83] op_sel:[0,0,1] op_sel_hi:[1,0,1]
    v_pk_fma_f32 v[126:127], v[126:127], s[82:83], s[82:83] op_sel:[0,0,1] op_sel_hi:[1,0,1]
    v_pk_fma_f32 v[128:129], v[128:129], s[82:83], s[82:83] op_sel:[0,0,1] op_sel_hi:[1,0,1]
    v_pk_fma_f32 v[130:131], v[130:131], s[82:83], s[82:83] op_sel:[0,0,1] op_sel_hi:[1,0,1]
    v_pk_mul_f32 v[124:125], v[124:125], v[196:197]
    v_pk_mul_f32 v[126:127], v[126:127], v[198:199]
    v_pk_mul_f32 v[128:129], v[128:129], v[212:213]
    v_pk_mul_f32 v[130:131], v[130:131], v[214:215]
    v_exp_f32 v132, v124
    v_exp_f32 v133, v125
    v_exp_f32 v134, v126
    v_exp_f32 v135, v127
    v_exp_f32 v136, v128
    v_exp_f32 v137, v129
    v_exp_f32 v138, v130
    v_exp_f32 v139, v131
    v_pk_add_f32 v[132:133], v[132:133], 1.0 op_sel_hi:[1,0]
    v_pk_add_f32 v[134:135], v[134:135], 1.0 op_sel_hi:[1,0]
    v_pk_add_f32 v[136:137], v[136:137], 1.0 op_sel_hi:[1,0]
    v_pk_add_f32 v[138:139], v[138:139], 1.0 op_sel_hi:[1,0]
    v_rcp_f32 v132, v132
    v_rcp_f32 v133, v133
    v_rcp_f32 v134, v134
    v_rcp_f32 v135, v135
    v_rcp_f32 v136, v136
    v_rcp_f32 v137, v137
    v_rcp_f32 v138, v138
    v_rcp_f32 v139, v139
    v_pk_mul_f32 v[196:197], v[196:197], v[132:133]
    v_pk_mul_f32 v[198:199], v[198:199], v[134:135]
    v_pk_mul_f32 v[212:213], v[212:213], v[136:137]
    v_pk_mul_f32 v[214:215], v[214:215], v[138:139]
    v_cvt_pk_bf16_f32 v92, v196, v197
    v_cvt_pk_bf16_f32 v93, v198, v199
    v_cvt_pk_bf16_f32 v94, v212, v213
    v_cvt_pk_bf16_f32 v95, v214, v215
    buffer_store_dwordx4 v[92:95], v26, s[60:63], s86 offen offset:1024 sc1
    s_add_u32 s86, s86, 4096
.p2align 3
    v_pk_fma_f32 v[124:125], v[80:81], v[50:51], v[116:117] op_sel:[0,1,0] op_sel_hi:[1,1,1] neg_lo:[0,1,0] neg_hi:[0,1,0]
    v_pk_fma_f32 v[126:127], v[82:83], v[50:51], v[118:119] op_sel:[0,1,0] op_sel_hi:[1,1,1] neg_lo:[0,1,0] neg_hi:[0,1,0]
    v_pk_fma_f32 v[128:129], v[84:85], v[50:51], v[120:121] op_sel:[0,1,0] op_sel_hi:[1,1,1] neg_lo:[0,1,0] neg_hi:[0,1,0]
    v_pk_fma_f32 v[130:131], v[86:87], v[50:51], v[122:123] op_sel:[0,1,0] op_sel_hi:[1,1,1] neg_lo:[0,1,0] neg_hi:[0,1,0]
    v_pk_fma_f32 v[224:225], v[224:225], v[50:51], v[124:125] op_sel:[0,0,0] op_sel_hi:[1,0,1]
    v_pk_fma_f32 v[226:227], v[226:227], v[50:51], v[126:127] op_sel:[0,0,0] op_sel_hi:[1,0,1]
    v_pk_fma_f32 v[240:241], v[240:241], v[50:51], v[128:129] op_sel:[0,0,0] op_sel_hi:[1,0,1]
    v_pk_fma_f32 v[242:243], v[242:243], v[50:51], v[130:131] op_sel:[0,0,0] op_sel_hi:[1,0,1]
    v_pk_mul_f32 v[124:125], v[224:225], v[224:225]
    v_pk_mul_f32 v[126:127], v[226:227], v[226:227]
    v_pk_mul_f32 v[128:129], v[240:241], v[240:241]
    v_pk_mul_f32 v[130:131], v[242:243], v[242:243]
    v_pk_fma_f32 v[124:125], v[124:125], s[82:83], s[82:83] op_sel:[0,0,1] op_sel_hi:[1,0,1]
    v_pk_fma_f32 v[126:127], v[126:127], s[82:83], s[82:83] op_sel:[0,0,1] op_sel_hi:[1,0,1]
    v_pk_fma_f32 v[128:129], v[128:129], s[82:83], s[82:83] op_sel:[0,0,1] op_sel_hi:[1,0,1]
    v_pk_fma_f32 v[130:131], v[130:131], s[82:83], s[82:83] op_sel:[0,0,1] op_sel_hi:[1,0,1]
    v_pk_mul_f32 v[124:125], v[124:125], v[224:225]
    v_pk_mul_f32 v[126:127], v[126:127], v[226:227]
    v_pk_mul_f32 v[128:129], v[128:129], v[240:241]
    v_pk_mul_f32 v[130:131], v[130:131], v[242:243]
    v_exp_f32 v132, v124
    v_exp_f32 v133, v125
    v_exp_f32 v134, v126
    v_exp_f32 v135, v127
    v_exp_f32 v136, v128
    v_exp_f32 v137, v129
    v_exp_f32 v138, v130
    v_exp_f32 v139, v131
    v_pk_add_f32 v[132:133], v[132:133], 1.0 op_sel_hi:[1,0]
    v_pk_add_f32 v[134:135], v[134:135], 1.0 op_sel_hi:[1,0]
    v_pk_add_f32 v[136:137], v[136:137], 1.0 op_sel_hi:[1,0]
    v_pk_add_f32 v[138:139], v[138:139], 1.0 op_sel_hi:[1,0]
    v_rcp_f32 v132, v132
    v_rcp_f32 v133, v133
    v_rcp_f32 v134, v134
    v_rcp_f32 v135, v135
    v_rcp_f32 v136, v136
    v_rcp_f32 v137, v137
    v_rcp_f32 v138, v138
    v_rcp_f32 v139, v139
    v_pk_mul_f32 v[224:225], v[224:225], v[132:133]
    v_pk_mul_f32 v[226:227], v[226:227], v[134:135]
    v_pk_mul_f32 v[240:241], v[240:241], v[136:137]
    v_pk_mul_f32 v[242:243], v[242:243], v[138:139]
    v_cvt_pk_bf16_f32 v88, v224, v225
    v_cvt_pk_bf16_f32 v89, v226, v227
    v_cvt_pk_bf16_f32 v90, v240, v241
    v_cvt_pk_bf16_f32 v91, v242, v243
    buffer_store_dwordx4 v[88:91], v26, s[60:63], s86 offen offset:0 sc1
.p2align 3
    v_pk_fma_f32 v[124:125], v[80:81], v[54:55], v[116:117] op_sel:[0,1,0] op_sel_hi:[1,1,1] neg_lo:[0,1,0] neg_hi:[0,1,0]
    v_pk_fma_f32 v[126:127], v[82:83], v[54:55], v[118:119] op_sel:[0,1,0] op_sel_hi:[1,1,1] neg_lo:[0,1,0] neg_hi:[0,1,0]
    v_pk_fma_f32 v[128:129], v[84:85], v[54:55], v[120:121] op_sel:[0,1,0] op_sel_hi:[1,1,1] neg_lo:[0,1,0] neg_hi:[0,1,0]
    v_pk_fma_f32 v[130:131], v[86:87], v[54:55], v[122:123] op_sel:[0,1,0] op_sel_hi:[1,1,1] neg_lo:[0,1,0] neg_hi:[0,1,0]
    v_pk_fma_f32 v[228:229], v[228:229], v[54:55], v[124:125] op_sel:[0,0,0] op_sel_hi:[1,0,1]
    v_pk_fma_f32 v[230:231], v[230:231], v[54:55], v[126:127] op_sel:[0,0,0] op_sel_hi:[1,0,1]
    v_pk_fma_f32 v[244:245], v[244:245], v[54:55], v[128:129] op_sel:[0,0,0] op_sel_hi:[1,0,1]
    v_pk_fma_f32 v[246:247], v[246:247], v[54:55], v[130:131] op_sel:[0,0,0] op_sel_hi:[1,0,1]
    v_pk_mul_f32 v[124:125], v[228:229], v[228:229]
    v_pk_mul_f32 v[126:127], v[230:231], v[230:231]
    v_pk_mul_f32 v[128:129], v[244:245], v[244:245]
    v_pk_mul_f32 v[130:131], v[246:247], v[246:247]
    v_pk_fma_f32 v[124:125], v[124:125], s[82:83], s[82:83] op_sel:[0,0,1] op_sel_hi:[1,0,1]
    v_pk_fma_f32 v[126:127], v[126:127], s[82:83], s[82:83] op_sel:[0,0,1] op_sel_hi:[1,0,1]
    v_pk_fma_f32 v[128:129], v[128:129], s[82:83], s[82:83] op_sel:[0,0,1] op_sel_hi:[1,0,1]
    v_pk_fma_f32 v[130:131], v[130:131], s[82:83], s[82:83] op_sel:[0,0,1] op_sel_hi:[1,0,1]
    v_pk_mul_f32 v[124:125], v[124:125], v[228:229]
    v_pk_mul_f32 v[126:127], v[126:127], v[230:231]
    v_pk_mul_f32 v[128:129], v[128:129], v[244:245]
    v_pk_mul_f32 v[130:131], v[130:131], v[246:247]
    v_exp_f32 v132, v124
    v_exp_f32 v133, v125
    v_exp_f32 v134, v126
    v_exp_f32 v135, v127
    v_exp_f32 v136, v128
    v_exp_f32 v137, v129
    v_exp_f32 v138, v130
    v_exp_f32 v139, v131
    v_pk_add_f32 v[132:133], v[132:133], 1.0 op_sel_hi:[1,0]
    v_pk_add_f32 v[134:135], v[134:135], 1.0 op_sel_hi:[1,0]
    v_pk_add_f32 v[136:137], v[136:137], 1.0 op_sel_hi:[1,0]
    v_pk_add_f32 v[138:139], v[138:139], 1.0 op_sel_hi:[1,0]
    v_rcp_f32 v132, v132
    v_rcp_f32 v133, v133
    v_rcp_f32 v134, v134
    v_rcp_f32 v135, v135
    v_rcp_f32 v136, v136
    v_rcp_f32 v137, v137
    v_rcp_f32 v138, v138
    v_rcp_f32 v139, v139
    v_pk_mul_f32 v[228:229], v[228:229], v[132:133]
    v_pk_mul_f32 v[230:231], v[230:231], v[134:135]
    v_pk_mul_f32 v[244:245], v[244:245], v[136:137]
    v_pk_mul_f32 v[246:247], v[246:247], v[138:139]
    v_cvt_pk_bf16_f32 v92, v228, v229
    v_cvt_pk_bf16_f32 v93, v230, v231
    v_cvt_pk_bf16_f32 v94, v244, v245
    v_cvt_pk_bf16_f32 v95, v246, v247
    buffer_store_dwordx4 v[92:95], v26, s[60:63], s86 offen offset:1024 sc1
    s_branch L_sc1_hmmlp
L_sc0_hmmlp:
    s_sub_u32 s81, s81, 1
    s_cbranch_scc1 L_end
    s_add_u32 s12, s32, 128
    s_load_dwordx8 s[36:43], s[48:49], s32 glc
    s_load_dwordx8 s[64:71], s[48:49], s12 glc
L_sc1_hmmlp:
    s_waitcnt lgkmcnt(0)
    s_cmp_eq_u64 s[36:37], s[84:85]
    s_cbranch_scc0 L_sc0_hmmlp
    s_cmp_eq_u64 s[38:39], s[84:85]
    s_cbranch_scc0 L_sc0_hmmlp
    s_cmp_eq_u64 s[40:41], s[84:85]
    s_cbranch_scc0 L_sc0_hmmlp
    s_cmp_eq_u64 s[42:43], s[84:85]
    s_cbranch_scc0 L_sc0_hmmlp
    s_cmp_eq_u64 s[64:65], s[84:85]
    s_cbranch_scc0 L_sc0_hmmlp
    s_cmp_eq_u64 s[66:67], s[84:85]
    s_cbranch_scc0 L_sc0_hmmlp
    s_cmp_eq_u64 s[68:69], s[84:85]
    s_cbranch_scc0 L_sc0_hmmlp
    s_cmp_eq_u64 s[70:71], s[84:85]
    s_cbranch_scc0 L_sc0_hmmlp
    s_cmp_gt_u32 s26, 0
    s_cselect_b32 s15, s22, s23
    s_add_u32 s15, s15, 0
    buffer_load_dwordx4 v[40:43], v32, s[60:63], s15 offen sc1
    buffer_load_dwordx4 v[44:47], v33, s[60:63], s15 offen sc1
    buffer_load_dwordx4 v[48:51], v34, s[60:63], s15 offen sc1
    buffer_load_dwordx4 v[52:55], v35, s[60:63], s15 offen sc1
    s_cmp_gt_u32 s26, 1
    s_cselect_b32 s15, s22, s23
    s_add_u32 s15, s15, 4096
    buffer_load_dwordx4 v[56:59], v32, s[60:63], s15 offen sc1
    buffer_load_dwordx4 v[60:63], v33, s[60:63], s15 offen sc1
    buffer_load_dwordx4 v[64:67], v34, s[60:63], s15 offen sc1
    buffer_load_dwordx4 v[68:71], v35, s[60:63], s15 offen sc1
    s_cmp_gt_u32 s26, 2
    s_cselect_b32 s15, s22, s23
    s_add_u32 s15, s15, 8192
    buffer_load_dwordx4 v[72:75], v32, s[60:63], s15 offen sc1
    buffer_load_dwordx4 v[76:79], v33, s[60:63], s15 offen sc1
    buffer_load_dwordx4 v[80:83], v34, s[60:63], s15 offen sc1
    buffer_load_dwordx4 v[84:87], v35, s[60:63], s15 offen sc1
    s_cmp_gt_u32 s26, 3
    s_cselect_b32 s15, s22, s23
    s_add_u32 s15, s15, 12288
    buffer_load_dwordx4 a[100:103], v32, s[60:63], s15 offen sc1
    buffer_load_dwordx4 a[104:107], v33, s[60:63], s15 offen sc1
    buffer_load_dwordx4 a[248:251], v34, s[60:63], s15 offen sc1
    buffer_load_dwordx4 a[252:255], v35, s[60:63], s15 offen sc1
    ds_read_b64 v[212:213], v96 offset:0
    ds_read_b64 v[176:177], v97 offset:20160
    ds_read_b64 v[178:179], v97 offset:20192
    ds_read_b64 v[180:181], v97 offset:20224
    ds_read_b64 v[182:183], v97 offset:20256
    ds_read_b64 v[192:193], v97 offset:20288
    ds_read_b64 v[194:195], v97 offset:20320
    ds_read_b64 v[196:197], v97 offset:20352
    ds_read_b64 v[198:199], v97 offset:20384
    ds_read_b64 v[208:209], v97 offset:20416
    ds_read_b64 v[210:211], v97 offset:20448
    buffer_load_dwordx4 a[232:235], v26, s[60:63], s14 offen offset:1024 sc1
    buffer_load_dwordx4 a[236:239], v26, s[60:63], s14 offen offset:2048 sc1
    buffer_load_dwordx4 a[240:243], v26, s[60:63], s14 offen offset:3072 sc1
    s_add_u32 s14, s14, 4096
    buffer_load_dwordx4 a[244:247], v26, s[60:63], s14 offen offset:0 sc1
    s_cmp_gt_u32 s26, 7
    s_cselect_b32 s14, s18, s19
    s_add_u32 s14, s14, 35840
    buffer_load_dwordx4 a[0:3], v26, s[60:63], s14 offen offset:0 sc1
    buffer_load_dwordx4 a[4:7], v26, s[60:63], s14 offen offset:1024 sc1
    buffer_load_dwordx4 a[8:11], v26, s[60:63], s14 offen offset:2048 sc1
    buffer_load_dwordx4 a[12:15], v26, s[60:63], s14 offen offset:3072 sc1
    s_waitcnt vmcnt(20)
    buffer_store_dwordx2 v[36:37], v24, s[60:63], s73 offen sc1
    v_mfma_f32_16x16x32_bf16 v[96:99], a[108:111], v[40:43], 0
    s_cmp_gt_u32 s26, 4
    s_cselect_b32 s15, s22, s23
    v_mfma_f32_16x16x32_bf16 v[112:115], a[112:115], v[40:43], 0
    s_add_u32 s14, s14, 4096
    v_bfe_u32 v88, v2, 1, 2
    v_mfma_f32_16x16x32_bf16 v[128:131], a[116:119], v[40:43], 0
    s_add_u32 s15, s15, 16384
    v_mul_u32_u24 v27, 320, v2
    v_mfma_f32_16x16x32_bf16 v[144:147], a[120:123], v[40:43], 0
    buffer_load_dwordx4 a[16:19], v26, s[60:63], s14 offen offset:0 sc1
    v_mfma_f32_16x16x32_bf16 v[160:163], a[124:127], v[40:43], 0
    buffer_load_dwordx4 v[40:43], v32, s[60:63], s15 offen sc1
    v_mfma_f32_16x16x32_bf16 v[100:103], a[108:111], v[44:47], 0
    v_xor_b32 v88, v88, v3
    v_mfma_f32_16x16x32_bf16 v[116:119], a[112:115], v[44:47], 0
    s_cmp_gt_u32 s26, 8
    s_cselect_b32 s14, s18, s19
    v_mfma_f32_16x16x32_bf16 v[132:135], a[116:119], v[44:47], 0
    v_lshl_add_u32 v27, v88, 4, v27
    v_mfma_f32_16x16x32_bf16 v[148:151], a[120:123], v[44:47], 0
    v_add_u32 v27, s34, v27
    v_lshlrev_b32 v38, 1, v38
    v_mfma_f32_16x16x32_bf16 v[164:167], a[124:127], v[44:47], 0
    buffer_load_dwordx4 v[44:47], v33, s[60:63], s15 offen sc1
    v_mfma_f32_16x16x32_bf16 v[104:107], a[108:111], v[48:51], 0
    s_add_u32 s14, s14, 40960
    s_lshl_b32 s76, s72, 1
    v_mfma_f32_16x16x32_bf16 v[120:123], a[112:115], v[48:51], 0
    buffer_load_dwordx4 a[20:23], v26, s[60:63], s14 offen offset:0 sc1
    v_mfma_f32_16x16x32_bf16 v[136:139], a[116:119], v[48:51], 0
    s_mov_b32 s56, s44
    s_mov_b32 s57, s45
    v_mfma_f32_16x16x32_bf16 v[152:155], a[120:123], v[48:51], 0
    buffer_load_dwordx4 a[24:27], v26, s[60:63], s14 offen offset:1024 sc1
    v_mfma_f32_16x16x32_bf16 v[168:171], a[124:127], v[48:51], 0
    buffer_load_dwordx4 v[48:51], v34, s[60:63], s15 offen sc1
    v_mfma_f32_16x16x32_bf16 v[108:111], a[108:111], v[52:55], 0
    s_mov_b32 s58, 5242880
    s_mov_b32 s59, 0x20000
    v_mfma_f32_16x16x32_bf16 v[124:127], a[112:115], v[52:55], 0
    buffer_load_dwordx4 a[28:31], v26, s[60:63], s14 offen offset:2048 sc1
    v_mfma_f32_16x16x32_bf16 v[140:143], a[116:119], v[52:55], 0
    s_lshl_b32 s86, s6, 3
    s_add_u32 s86, s86, s7
    v_mfma_f32_16x16x32_bf16 v[156:159], a[120:123], v[52:55], 0
    s_lshl_b32 s86, s86, 1
    s_add_u32 s86, s86, s88
    v_mfma_f32_16x16x32_bf16 v[172:175], a[124:127], v[52:55], 0
    buffer_load_dwordx4 v[52:55], v35, s[60:63], s15 offen sc1
    s_waitcnt vmcnt(25)
    v_mfma_f32_16x16x32_bf16 v[96:99], a[128:131], v[56:59], v[96:99]
    s_cmp_gt_u32 s26, 5
    s_cselect_b32 s15, s22, s23
    v_mfma_f32_16x16x32_bf16 v[112:115], a[132:135], v[56:59], v[112:115]
    buffer_load_dwordx4 a[32:35], v26, s[60:63], s14 offen offset:3072 sc1
    v_mfma_f32_16x16x32_bf16 v[128:131], a[136:139], v[56:59], v[128:131]
    s_add_u32 s15, s15, 20480
    s_xor_b32 s75, s86, 1
    v_mfma_f32_16x16x32_bf16 v[144:147], a[140:143], v[56:59], v[144:147]
    s_lshl_b32 s87, s75, 6
    s_lshl_b32 s74, s3, 4
    v_mfma_f32_16x16x32_bf16 v[160:163], a[144:147], v[56:59], v[160:163]
    buffer_load_dwordx4 v[56:59], v32, s[60:63], s15 offen sc1
    v_mfma_f32_16x16x32_bf16 v[100:103], a[128:131], v[60:63], v[100:103]
    s_add_u32 s14, s14, 4096
    s_add_u32 s74, s74, 17956864
    v_mfma_f32_16x16x32_bf16 v[116:119], a[132:135], v[60:63], v[116:119]
    buffer_load_dwordx4 a[36:39], v26, s[60:63], s14 offen offset:0 sc1
    v_mfma_f32_16x16x32_bf16 v[132:135], a[136:139], v[60:63], v[132:135]
    s_add_u32 s87, s87, s74
    s_lshl_b32 s78, s86, 6
    v_mfma_f32_16x16x32_bf16 v[148:151], a[140:143], v[60:63], v[148:151]
    s_add_u32 s78, s78, s74
    s_mul_i32 s74, s3, 5120
    v_mfma_f32_16x16x32_bf16 v[164:167], a[144:147], v[60:63], v[164:167]
    buffer_load_dwordx4 v[60:63], v33, s[60:63], s15 offen sc1
    v_mfma_f32_16x16x32_bf16 v[104:107], a[128:131], v[64:67], v[104:107]
    s_cmp_gt_u32 s26, 9
    s_cselect_b32 s14, s18, s19
    v_mfma_f32_16x16x32_bf16 v[120:123], a[132:135], v[64:67], v[120:123]
    s_add_u32 s14, s14, 46080
    s_add_u32 s74, s74, 25165824
    v_mfma_f32_16x16x32_bf16 v[136:139], a[136:139], v[64:67], v[136:139]
    s_mul_i32 s86, s86, 20480
    s_add_u32 s86, s86, s74
    v_mfma_f32_16x16x32_bf16 v[152:155], a[140:143], v[64:67], v[152:155]
    buffer_load_dwordx4 a[40:43], v26, s[60:63], s14 offen offset:0 sc1
    v_mfma_f32_16x16x32_bf16 v[168:171], a[144:147], v[64:67], v[168:171]
    buffer_load_dwordx4 v[64:67], v34, s[60:63], s15 offen sc1
    v_mfma_f32_16x16x32_bf16 v[108:111], a[128:131], v[68:71], v[108:111]
    s_mul_i32 s75, s75, 20480
    s_add_u32 s75, s75, s74
    v_mfma_f32_16x16x32_bf16 v[124:127], a[132:135], v[68:71], v[124:127]
    buffer_load_dwordx4 a[44:47], v26, s[60:63], s14 offen offset:1024 sc1
    v_mfma_f32_16x16x32_bf16 v[140:143], a[136:139], v[68:71], v[140:143]
    s_add_u32 s77, s86, 4096
    s_add_u32 s51, s75, 4096
    v_mfma_f32_16x16x32_bf16 v[156:159], a[140:143], v[68:71], v[156:159]
    s_xor_b32 s74, s3, 0
    s_mul_i32 s74, s74, 20480
    v_mfma_f32_16x16x32_bf16 v[172:175], a[144:147], v[68:71], v[172:175]
    buffer_load_dwordx4 v[68:71], v35, s[60:63], s15 offen sc1
    s_waitcnt vmcnt(29)
    v_mfma_f32_16x16x32_bf16 v[96:99], a[148:151], v[72:75], v[96:99]
    s_cmp_gt_u32 s26, 6
    s_cselect_b32 s15, s22, s23
    v_mfma_f32_16x16x32_bf16 v[112:115], a[152:155], v[72:75], v[112:115]
    buffer_load_dwordx4 a[48:51], v26, s[60:63], s14 offen offset:2048 sc1
    v_mfma_f32_16x16x32_bf16 v[128:131], a[156:159], v[72:75], v[128:131]
    s_add_u32 s15, s15, 24576
    s_add_u32 s74, s74, 20480
    v_mfma_f32_16x16x32_bf16 v[144:147], a[160:163], v[72:75], v[144:147]
    v_add_u32 v88, s74, v39
    s_xor_b32 s74, s3, 1
    v_mfma_f32_16x16x32_bf16 v[160:163], a[164:167], v[72:75], v[160:163]
    buffer_load_dwordx4 v[72:75], v32, s[60:63], s15 offen sc1
    v_mfma_f32_16x16x32_bf16 v[100:103], a[148:151], v[76:79], v[100:103]
    buffer_load_dwordx4 a[52:55], v26, s[60:63], s14 offen offset:3072 sc1
    v_mfma_f32_16x16x32_bf16 v[116:119], a[152:155], v[76:79], v[116:119]
    s_mul_i32 s74, s74, 20480
    s_add_u32 s74, s74, 25600
    v_mfma_f32_16x16x32_bf16 v[132:135], a[156:159], v[76:79], v[132:135]
    s_add_u32 s14, s14, 4096
    v_add_u32 v89, s74, v39
    v_mfma_f32_16x16x32_bf16 v[148:151], a[160:163], v[76:79], v[148:151]
    s_xor_b32 s74, s3, 2
    s_mul_i32 s74, s74, 20480
    v_mfma_f32_16x16x32_bf16 v[164:167], a[164:167], v[76:79], v[164:167]
    buffer_load_dwordx4 v[76:79], v33, s[60:63], s15 offen sc1
    v_mfma_f32_16x16x32_bf16 v[104:107], a[148:151], v[80:83], v[104:107]
    buffer_load_dwordx4 a[56:59], v26, s[60:63], s14 offen offset:0 sc1
    v_mfma_f32_16x16x32_bf16 v[120:123], a[152:155], v[80:83], v[120:123]
    s_cmp_gt_u32 s26, 10
    s_cselect_b32 s14, s18, s19
    v_mfma_f32_16x16x32_bf16 v[136:139], a[156:159], v[80:83], v[136:139]
    s_add_u32 s74, s74, 30720
    v_add_u32 v90, s74, v39
    v_mfma_f32_16x16x32_bf16 v[152:155], a[160:163], v[80:83], v[152:155]
    s_xor_b32 s74, s3, 3
    s_mul_i32 s74, s74, 20480
    v_mfma_f32_16x16x32_bf16 v[168:171], a[164:167], v[80:83], v[168:171]
    buffer_load_dwordx4 v[80:83], v34, s[60:63], s15 offen sc1
    v_mfma_f32_16x16x32_bf16 v[108:111], a[148:151], v[84:87], v[108:111]
    s_add_u32 s14, s14, 51200
    s_add_u32 s74, s74, 35840
    v_mfma_f32_16x16x32_bf16 v[124:127], a[152:155], v[84:87], v[124:127]
    buffer_load_dwordx4 a[60:63], v26, s[60:63], s14 offen offset:0 sc1
    v_mfma_f32_16x16x32_bf16 v[140:143], a[156:159], v[84:87], v[140:143]
    v_add_u32 v91, s74, v39
    s_waitcnt lgkmcnt(0)
    v_mfma_f32_16x16x32_bf16 v[156:159], a[160:163], v[84:87], v[156:159]
    v_lshlrev_b32 v224, 16, v14
    v_lshlrev_b32 v240, 16, v15
    v_mfma_f32_16x16x32_bf16 v[172:175], a[164:167], v[84:87], v[172:175]
    buffer_load_dwordx4 v[84:87], v35, s[60:63], s15 offen sc1
    s_waitcnt vmcnt(33)
    v_mfma_f32_16x16x32_bf16 v[96:99], a[168:171], a[100:103], v[96:99]
    s_cmp_gt_u32 s26, 7
    s_cselect_b32 s15, s22, s23
    v_mfma_f32_16x16x32_bf16 v[112:115], a[172:175], a[100:103], v[112:115]
    buffer_load_dwordx4 a[64:67], v26, s[60:63], s14 offen offset:1024 sc1
    v_mfma_f32_16x16x32_bf16 v[128:131], a[176:179], a[100:103], v[128:131]
    s_add_u32 s15, s15, 28672
    v_and_b32 v225, 0xffff0000, v14
    v_mfma_f32_16x16x32_bf16 v[144:147], a[180:183], a[100:103], v[144:147]
    v_and_b32 v241, 0xffff0000, v15
    v_sub_f32 v226, v224, v212
    v_mfma_f32_16x16x32_bf16 v[160:163], a[184:187], a[100:103], v[160:163]
    buffer_load_dwordx4 a[100:103], v32, s[60:63], s15 offen sc1
    v_mfma_f32_16x16x32_bf16 v[100:103], a[168:171], a[104:107], v[100:103]
    buffer_load_dwordx4 a[68:71], v26, s[60:63], s14 offen offset:2048 sc1
    v_mfma_f32_16x16x32_bf16 v[116:119], a[172:175], a[104:107], v[116:119]
    v_sub_f32 v242, v240, v212
    v_sub_f32 v227, v225, v212
    v_mfma_f32_16x16x32_bf16 v[132:135], a[176:179], a[104:107], v[132:135]
    v_sub_f32 v243, v241, v212
    v_cvt_pk_bf16_f32 v227, v226, v227
    v_mfma_f32_16x16x32_bf16 v[148:151], a[180:183], a[104:107], v[148:151]
    v_cvt_pk_bf16_f32 v243, v242, v243
    v_lshlrev_b32 v226, 16, v227
    v_mfma_f32_16x16x32_bf16 v[164:167], a[184:187], a[104:107], v[164:167]
    buffer_load_dwordx4 a[104:107], v33, s[60:63], s15 offen sc1
    v_mfma_f32_16x16x32_bf16 v[104:107], a[168:171], a[248:251], v[104:107]
    buffer_load_dwordx4 a[72:75], v26, s[60:63], s14 offen offset:3072 sc1
    v_mfma_f32_16x16x32_bf16 v[120:123], a[172:175], a[248:251], v[120:123]
    v_lshlrev_b32 v242, 16, v243
    v_and_b32 v227, 0xffff0000, v227
    v_mfma_f32_16x16x32_bf16 v[136:139], a[176:179], a[248:251], v[136:139]
    v_and_b32 v243, 0xffff0000, v243
    v_mul_f32 v226, v226, v213
    v_mfma_f32_16x16x32_bf16 v[152:155], a[180:183], a[248:251], v[152:155]
    s_add_u32 s14, s14, 4096
    v_mul_f32 v242, v242, v213
    v_mfma_f32_16x16x32_bf16 v[168:171], a[184:187], a[248:251], v[168:171]
    buffer_load_dwordx4 a[248:251], v34, s[60:63], s15 offen sc1
    v_mfma_f32_16x16x32_bf16 v[108:111], a[168:171], a[252:255], v[108:111]
    buffer_load_dwordx4 a[76:79], v26, s[60:63], s14 offen offset:0 sc1
    v_mfma_f32_16x16x32_bf16 v[124:127], a[172:175], a[252:255], v[124:127]
    v_mul_f32 v227, v227, v213
    v_mul_f32 v243, v243, v213
    v_mfma_f32_16x16x32_bf16 v[140:143], a[176:179], a[252:255], v[140:143]
    v_cvt_pk_bf16_f32 v227, v226, v227
    v_cvt_pk_bf16_f32 v243, v242, v243
    v_mfma_f32_16x16x32_bf16 v[156:159], a[180:183], a[252:255], v[156:159]
    v_lshlrev_b32 v226, 16, v227
    v_lshlrev_b32 v242, 16, v243
    v_mfma_f32_16x16x32_bf16 v[172:175], a[184:187], a[252:255], v[172:175]
    buffer_load_dwordx4 a[252:255], v35, s[60:63], s15 offen sc1
    s_waitcnt vmcnt(24)
    v_mfma_f32_16x16x32_bf16 v[96:99], a[188:191], v[40:43], v[96:99]
    s_cmp_gt_u32 s26, 8
    s_cselect_b32 s15, s22, s23
    v_mfma_f32_16x16x32_bf16 v[112:115], a[192:195], v[40:43], v[112:115]
    s_cmp_gt_u32 s26, 11
    s_cselect_b32 s14, s18, s19
    v_mfma_f32_16x16x32_bf16 v[128:131], a[196:199], v[40:43], v[128:131]
    s_add_u32 s15, s15, 32768
    v_and_b32 v227, 0xffff0000, v227
    v_mfma_f32_16x16x32_bf16 v[144:147], a[200:203], v[40:43], v[144:147]
    v_and_b32 v243, 0xffff0000, v243
    v_lshlrev_b32 v228, 16, v176
    v_mfma_f32_16x16x32_bf16 v[160:163], a[204:207], v[40:43], v[160:163]
    buffer_load_dwordx4 v[40:43], v32, s[60:63], s15 offen sc1
    v_mfma_f32_16x16x32_bf16 v[100:103], a[188:191], v[44:47], v[100:103]
    s_add_u32 s14, s14, 56320
    v_lshlrev_b32 v244, 16, v177
    v_mfma_f32_16x16x32_bf16 v[116:119], a[192:195], v[44:47], v[116:119]
    buffer_load_dwordx4 a[80:83], v26, s[60:63], s14 offen offset:0 sc1
    v_mfma_f32_16x16x32_bf16 v[132:135], a[196:199], v[44:47], v[132:135]
    v_and_b32 v229, 0xffff0000, v176
    v_and_b32 v245, 0xffff0000, v177
    v_mfma_f32_16x16x32_bf16 v[148:151], a[200:203], v[44:47], v[148:151]
    v_mul_f32 v226, v226, v228
    v_mul_f32 v242, v242, v244
    v_mfma_f32_16x16x32_bf16 v[164:167], a[204:207], v[44:47], v[164:167]
    buffer_load_dwordx4 v[44:47], v33, s[60:63], s15 offen sc1
    v_mfma_f32_16x16x32_bf16 v[104:107], a[188:191], v[48:51], v[104:107]
    buffer_load_dwordx4 a[84:87], v26, s[60:63], s14 offen offset:1024 sc1
    v_mfma_f32_16x16x32_bf16 v[120:123], a[192:195], v[48:51], v[120:123]
    v_mul_f32 v227, v227, v229
    v_mul_f32 v243, v243, v245
    v_mfma_f32_16x16x32_bf16 v[136:139], a[196:199], v[48:51], v[136:139]
    buffer_load_dwordx4 a[88:91], v26, s[60:63], s14 offen offset:2048 sc1
    v_mfma_f32_16x16x32_bf16 v[152:155], a[200:203], v[48:51], v[152:155]
    v_cvt_pk_bf16_f32 v227, v226, v227
    v_cvt_pk_bf16_f32 v243, v242, v243
    v_mfma_f32_16x16x32_bf16 v[168:171], a[204:207], v[48:51], v[168:171]
    buffer_load_dwordx4 v[48:51], v34, s[60:63], s15 offen sc1
    v_mfma_f32_16x16x32_bf16 v[108:111], a[188:191], v[52:55], v[108:111]
    buffer_load_dwordx4 a[92:95], v26, s[60:63], s14 offen offset:3072 sc1
    v_mfma_f32_16x16x32_bf16 v[124:127], a[192:195], v[52:55], v[124:127]
    v_lshlrev_b32 v226, 16, v227
    v_lshlrev_b32 v242, 16, v243
    v_mfma_f32_16x16x32_bf16 v[140:143], a[196:199], v[52:55], v[140:143]
    v_and_b32 v227, 0xffff0000, v227
    v_and_b32 v243, 0xffff0000, v243
    v_mfma_f32_16x16x32_bf16 v[156:159], a[200:203], v[52:55], v[156:159]
    v_lshlrev_b32 v228, 16, v194
    v_lshlrev_b32 v244, 16, v195
    v_mfma_f32_16x16x32_bf16 v[172:175], a[204:207], v[52:55], v[172:175]
    buffer_load_dwordx4 v[52:55], v35, s[60:63], s15 offen sc1
    s_waitcnt vmcnt(24)
    v_mfma_f32_16x16x32_bf16 v[96:99], a[208:211], v[56:59], v[96:99]
    s_cmp_gt_u32 s26, 9
    s_cselect_b32 s15, s22, s23
    v_mfma_f32_16x16x32_bf16 v[112:115], a[212:215], v[56:59], v[112:115]
    s_add_u32 s14, s14, 4096
    v_and_b32 v229, 0xffff0000, v194
    v_mfma_f32_16x16x32_bf16 v[128:131], a[216:219], v[56:59], v[128:131]
    s_add_u32 s15, s15, 36864
    v_and_b32 v245, 0xffff0000, v195
    v_mfma_f32_16x16x32_bf16 v[144:147], a[220:223], v[56:59], v[144:147]
    v_add_f32 v226, v224, v226
    v_add_f32 v242, v240, v242
    v_mfma_f32_16x16x32_bf16 v[160:163], a[224:227], v[56:59], v[160:163]
    buffer_load_dwordx4 v[56:59], v32, s[60:63], s15 offen sc1
    v_mfma_f32_16x16x32_bf16 v[100:103], a[208:211], v[60:63], v[100:103]
    v_add_f32 v227, v225, v227
    v_add_f32 v243, v241, v243
    v_mfma_f32_16x16x32_bf16 v[116:119], a[212:215], v[60:63], v[116:119]
    v_add_f32 v4, v226, v228
    v_add_f32 v6, v242, v244
    v_mfma_f32_16x16x32_bf16 v[132:135], a[216:219], v[60:63], v[132:135]
    buffer_load_dwordx4 a[96:99], v26, s[60:63], s14 offen offset:0 sc1
    v_mfma_f32_16x16x32_bf16 v[148:151], a[220:223], v[60:63], v[148:151]
    v_add_f32 v5, v227, v229
    v_add_f32 v7, v243, v245
    v_mfma_f32_16x16x32_bf16 v[164:167], a[224:227], v[60:63], v[164:167]
    buffer_load_dwordx4 v[60:63], v33, s[60:63], s15 offen sc1
    v_mfma_f32_16x16x32_bf16 v[104:107], a[208:211], v[64:67], v[104:107]
    v_lshlrev_b32 v224, 16, v16
    v_lshlrev_b32 v240, 16, v17
    v_mfma_f32_16x16x32_bf16 v[120:123], a[212:215], v[64:67], v[120:123]
    v_and_b32 v225, 0xffff0000, v16
    v_and_b32 v241, 0xffff0000, v17
    v_mfma_f32_16x16x32_bf16 v[136:139], a[216:219], v[64:67], v[136:139]
    v_sub_f32 v226, v224, v212
    v_sub_f32 v242, v240, v212
    v_mfma_f32_16x16x32_bf16 v[152:155], a[220:223], v[64:67], v[152:155]
    v_sub_f32 v227, v225, v212
    v_sub_f32 v243, v241, v212
    v_mfma_f32_16x16x32_bf16 v[168:171], a[224:227], v[64:67], v[168:171]
    buffer_load_dwordx4 v[64:67], v34, s[60:63], s15 offen sc1
    v_mfma_f32_16x16x32_bf16 v[108:111], a[208:211], v[68:71], v[108:111]
    v_cvt_pk_bf16_f32 v227, v226, v227
    v_cvt_pk_bf16_f32 v243, v242, v243
    v_mfma_f32_16x16x32_bf16 v[124:127], a[212:215], v[68:71], v[124:127]
    v_lshlrev_b32 v226, 16, v227
    v_lshlrev_b32 v242, 16, v243
    v_mfma_f32_16x16x32_bf16 v[140:143], a[216:219], v[68:71], v[140:143]
    v_and_b32 v227, 0xffff0000, v227
    v_and_b32 v243, 0xffff0000, v243
    v_mfma_f32_16x16x32_bf16 v[156:159], a[220:223], v[68:71], v[156:159]
    v_mul_f32 v226, v226, v213
    v_mul_f32 v242, v242, v213
    v_mfma_f32_16x16x32_bf16 v[172:175], a[224:227], v[68:71], v[172:175]
    buffer_load_dwordx4 v[68:71], v35, s[60:63], s15 offen sc1
    s_waitcnt vmcnt(21)
    s_add_u32 s12, s33, 128
    s_load_dwordx8 s[36:43], s[48:49], s33 glc
    s_load_dwordx8 s[64:71], s[48:49], s12 glc
    v_mfma_f32_16x16x32_bf16 v[96:99], a[228:231], v[72:75], v[96:99]
    s_cmp_gt_u32 s26, 10
    s_cselect_b32 s15, s22, s23
    v_mfma_f32_16x16x32_bf16 v[112:115], a[232:235], v[72:75], v[112:115]
    v_mul_f32 v227, v227, v213
    v_mul_f32 v243, v243, v213
    v_mfma_f32_16x16x32_bf16 v[128:131], a[236:239], v[72:75], v[128:131]
    s_add_u32 s15, s15, 40960
    v_cvt_pk_bf16_f32 v227, v226, v227
    v_mfma_f32_16x16x32_bf16 v[144:147], a[240:243], v[72:75], v[144:147]
    v_cvt_pk_bf16_f32 v243, v242, v243
    v_lshlrev_b32 v226, 16, v227
    v_mfma_f32_16x16x32_bf16 v[160:163], a[244:247], v[72:75], v[160:163]
    buffer_load_dwordx4 v[72:75], v32, s[60:63], s15 offen sc1
    v_mfma_f32_16x16x32_bf16 v[100:103], a[228:231], v[76:79], v[100:103]
    v_lshlrev_b32 v242, 16, v243
    v_and_b32 v227, 0xffff0000, v227
    v_mfma_f32_16x16x32_bf16 v[116:119], a[232:235], v[76:79], v[116:119]
    v_and_b32 v243, 0xffff0000, v243
    v_lshlrev_b32 v228, 16, v178
    v_mfma_f32_16x16x32_bf16 v[132:135], a[236:239], v[76:79], v[132:135]
    v_lshlrev_b32 v244, 16, v179
    v_and_b32 v229, 0xffff0000, v178
    v_mfma_f32_16x16x32_bf16 v[148:151], a[240:243], v[76:79], v[148:151]
    v_and_b32 v245, 0xffff0000, v179
    v_mul_f32 v226, v226, v228
    v_mfma_f32_16x16x32_bf16 v[164:167], a[244:247], v[76:79], v[164:167]
    buffer_load_dwordx4 v[76:79], v33, s[60:63], s15 offen sc1
    v_mfma_f32_16x16x32_bf16 v[104:107], a[228:231], v[80:83], v[104:107]
    v_mul_f32 v242, v242, v244
    v_mul_f32 v227, v227, v229
    v_mfma_f32_16x16x32_bf16 v[120:123], a[232:235], v[80:83], v[120:123]
    v_mul_f32 v243, v243, v245
    v_cvt_pk_bf16_f32 v227, v226, v227
    v_mfma_f32_16x16x32_bf16 v[136:139], a[236:239], v[80:83], v[136:139]
    v_cvt_pk_bf16_f32 v243, v242, v243
    v_lshlrev_b32 v226, 16, v227
    v_mfma_f32_16x16x32_bf16 v[152:155], a[240:243], v[80:83], v[152:155]
    v_lshlrev_b32 v242, 16, v243
    v_and_b32 v227, 0xffff0000, v227
    v_mfma_f32_16x16x32_bf16 v[168:171], a[244:247], v[80:83], v[168:171]
    buffer_load_dwordx4 v[80:83], v34, s[60:63], s15 offen sc1
    v_mfma_f32_16x16x32_bf16 v[108:111], a[228:231], v[84:87], v[108:111]
    v_and_b32 v243, 0xffff0000, v243
    v_lshlrev_b32 v228, 16, v196
    v_mfma_f32_16x16x32_bf16 v[124:127], a[232:235], v[84:87], v[124:127]
    v_lshlrev_b32 v244, 16, v197
    v_and_b32 v229, 0xffff0000, v196
    v_mfma_f32_16x16x32_bf16 v[140:143], a[236:239], v[84:87], v[140:143]
    v_and_b32 v245, 0xffff0000, v197
    v_add_f32 v226, v224, v226
    v_mfma_f32_16x16x32_bf16 v[156:159], a[240:243], v[84:87], v[156:159]
    v_add_f32 v242, v240, v242
    v_add_f32 v227, v225, v227
    v_mfma_f32_16x16x32_bf16 v[172:175], a[244:247], v[84:87], v[172:175]
    buffer_load_dwordx4 v[84:87], v35, s[60:63], s15 offen sc1
    s_waitcnt vmcnt(17)
    v_mfma_f32_16x16x32_bf16 v[96:99], a[0:3], a[100:103], v[96:99]
    s_cmp_gt_u32 s26, 11
    s_cselect_b32 s15, s22, s23
    v_mfma_f32_16x16x32_bf16 v[112:115], a[4:7], a[100:103], v[112:115]
    v_add_f32 v243, v241, v243
    v_add_f32 v8, v226, v228
    v_mfma_f32_16x16x32_bf16 v[128:131], a[8:11], a[100:103], v[128:131]
    s_add_u32 s15, s15, 45056
    v_add_f32 v10, v242, v244
    v_mfma_f32_16x16x32_bf16 v[144:147], a[12:15], a[100:103], v[144:147]
    v_add_f32 v9, v227, v229
    v_add_f32 v11, v243, v245
    v_mfma_f32_16x16x32_bf16 v[160:163], a[16:19], a[100:103], v[160:163]
    buffer_load_dwordx4 a[100:103], v32, s[60:63], s15 offen sc1
    v_mfma_f32_16x16x32_bf16 v[100:103], a[0:3], a[104:107], v[100:103]
    v_lshlrev_b32 v224, 16, v18
    v_lshlrev_b32 v240, 16, v19
    v_mfma_f32_16x16x32_bf16 v[116:119], a[4:7], a[104:107], v[116:119]
    v_and_b32 v225, 0xffff0000, v18
    v_and_b32 v241, 0xffff0000, v19
    v_mfma_f32_16x16x32_bf16 v[132:135], a[8:11], a[104:107], v[132:135]
    v_sub_f32 v226, v224, v212
    v_sub_f32 v242, v240, v212
    v_mfma_f32_16x16x32_bf16 v[148:151], a[12:15], a[104:107], v[148:151]
    v_sub_f32 v227, v225, v212
    v_sub_f32 v243, v241, v212
    v_mfma_f32_16x16x32_bf16 v[164:167], a[16:19], a[104:107], v[164:167]
    buffer_load_dwordx4 a[104:107], v33, s[60:63], s15 offen sc1
    v_mfma_f32_16x16x32_bf16 v[104:107], a[0:3], a[248:251], v[104:107]
    v_cvt_pk_bf16_f32 v227, v226, v227
    v_cvt_pk_bf16_f32 v243, v242, v243
    v_mfma_f32_16x16x32_bf16 v[120:123], a[4:7], a[248:251], v[120:123]
    v_lshlrev_b32 v226, 16, v227
    v_lshlrev_b32 v242, 16, v243
    v_mfma_f32_16x16x32_bf16 v[136:139], a[8:11], a[248:251], v[136:139]
    v_and_b32 v227, 0xffff0000, v227
    v_and_b32 v243, 0xffff0000, v243
    v_mfma_f32_16x16x32_bf16 v[152:155], a[12:15], a[248:251], v[152:155]
    v_mul_f32 v226, v226, v213
    v_mul_f32 v242, v242, v213
    v_mfma_f32_16x16x32_bf16 v[168:171], a[16:19], a[248:251], v[168:171]
    buffer_load_dwordx4 a[248:251], v34, s[60:63], s15 offen sc1
    v_mfma_f32_16x16x32_bf16 v[108:111], a[0:3], a[252:255], v[108:111]
    v_mul_f32 v227, v227, v213
    v_mul_f32 v243, v243, v213
    v_mfma_f32_16x16x32_bf16 v[124:127], a[4:7], a[252:255], v[124:127]
    v_cvt_pk_bf16_f32 v227, v226, v227
    v_cvt_pk_bf16_f32 v243, v242, v243
    v_mfma_f32_16x16x32_bf16 v[140:143], a[8:11], a[252:255], v[140:143]
    v_lshlrev_b32 v226, 16, v227
    v_lshlrev_b32 v242, 16, v243
    v_mfma_f32_16x16x32_bf16 v[156:159], a[12:15], a[252:255], v[156:159]
    v_and_b32 v227, 0xffff0000, v227
    v_and_b32 v243, 0xffff0000, v243
    v_mfma_f32_16x16x32_bf16 v[172:175], a[16:19], a[252:255], v[172:175]
    buffer_load_dwordx4 a[252:255], v35, s[60:63], s15 offen sc1
    s_waitcnt vmcnt(13)
    s_branch L_sc1_hbmlp
L_sc0_hbmlp:
    s_sub_u32 s81, s81, 1
    s_cbranch_scc1 L_end
    s_add_u32 s12, s33, 128
    s_load_dwordx8 s[36:43], s[48:49], s33 glc
    s_load_dwordx8 s[64:71], s[48:49], s12 glc
L_sc1_hbmlp:
    s_waitcnt lgkmcnt(0)
    s_cmp_eq_u64 s[36:37], s[84:85]
    s_cbranch_scc0 L_sc0_hbmlp
    s_cmp_eq_u64 s[38:39], s[84:85]
    s_cbranch_scc0 L_sc0_hbmlp
    s_cmp_eq_u64 s[40:41], s[84:85]
    s_cbranch_scc0 L_sc0_hbmlp
    s_cmp_eq_u64 s[42:43], s[84:85]
    s_cbranch_scc0 L_sc0_hbmlp
    s_cmp_eq_u64 s[64:65], s[84:85]
    s_cbranch_scc0 L_sc0_hbmlp
    s_cmp_eq_u64 s[66:67], s[84:85]
    s_cbranch_scc0 L_sc0_hbmlp
    s_cmp_eq_u64 s[68:69], s[84:85]
    s_cbranch_scc0 L_sc0_hbmlp
    s_cmp_eq_u64 s[70:71], s[84:85]
    s_cbranch_scc0 L_sc0_hbmlp
    v_mfma_f32_16x16x32_bf16 v[96:99], a[20:23], v[40:43], v[96:99]
    s_cmp_gt_u32 s26, 0
    s_cselect_b32 s15, s24, s25
    v_mfma_f32_16x16x32_bf16 v[112:115], a[24:27], v[40:43], v[112:115]
    v_lshlrev_b32 v228, 16, v180
    v_lshlrev_b32 v244, 16, v181
    v_mfma_f32_16x16x32_bf16 v[128:131], a[28:31], v[40:43], v[128:131]
    s_add_u32 s15, s15, 0
    v_and_b32 v229, 0xffff0000, v180
    v_mfma_f32_16x16x32_bf16 v[144:147], a[32:35], v[40:43], v[144:147]
    v_and_b32 v245, 0xffff0000, v181
    v_mul_f32 v226, v226, v228
    v_mfma_f32_16x16x32_bf16 v[160:163], a[36:39], v[40:43], v[160:163]
    buffer_load_dwordx4 v[40:43], v32, s[60:63], s15 offen sc1
    v_mfma_f32_16x16x32_bf16 v[100:103], a[20:23], v[44:47], v[100:103]
    v_mul_f32 v242, v242, v244
    v_mul_f32 v227, v227, v229
    v_mfma_f32_16x16x32_bf16 v[116:119], a[24:27], v[44:47], v[116:119]
    v_mul_f32 v243, v243, v245
    v_cvt_pk_bf16_f32 v227, v226, v227
    v_mfma_f32_16x16x32_bf16 v[132:135], a[28:31], v[44:47], v[132:135]
    v_cvt_pk_bf16_f32 v243, v242, v243
    v_lshlrev_b32 v226, 16, v227
    v_mfma_f32_16x16x32_bf16 v[148:151], a[32:35], v[44:47], v[148:151]
    v_lshlrev_b32 v242, 16, v243
    v_and_b32 v227, 0xffff0000, v227
    v_mfma_f32_16x16x32_bf16 v[164:167], a[36:39], v[44:47], v[164:167]
    buffer_load_dwordx4 v[44:47], v33, s[60:63], s15 offen sc1
    v_mfma_f32_16x16x32_bf16 v[104:107], a[20:23], v[48:51], v[104:107]
    v_and_b32 v243, 0xffff0000, v243
    v_lshlrev_b32 v228, 16, v198
    v_mfma_f32_16x16x32_bf16 v[120:123], a[24:27], v[48:51], v[120:123]
    v_lshlrev_b32 v244, 16, v199
    v_and_b32 v229, 0xffff0000, v198
    v_mfma_f32_16x16x32_bf16 v[136:139], a[28:31], v[48:51], v[136:139]
    v_and_b32 v245, 0xffff0000, v199
    v_add_f32 v226, v224, v226
    v_mfma_f32_16x16x32_bf16 v[152:155], a[32:35], v[48:51], v[152:155]
    v_add_f32 v242, v240, v242
    v_add_f32 v227, v225, v227
    v_mfma_f32_16x16x32_bf16 v[168:171], a[36:39], v[48:51], v[168:171]
    buffer_load_dwordx4 v[48:51], v34, s[60:63], s15 offen sc1
    v_mfma_f32_16x16x32_bf16 v[108:111], a[20:23], v[52:55], v[108:111]
    v_add_f32 v243, v241, v243
    v_add_f32 v12, v226, v228
    v_mfma_f32_16x16x32_bf16 v[124:127], a[24:27], v[52:55], v[124:127]
    v_add_f32 v14, v242, v244
    v_add_f32 v13, v227, v229
    v_mfma_f32_16x16x32_bf16 v[140:143], a[28:31], v[52:55], v[140:143]
    v_add_f32 v15, v243, v245
    v_lshlrev_b32 v224, 16, v20
    v_mfma_f32_16x16x32_bf16 v[156:159], a[32:35], v[52:55], v[156:159]
    v_lshlrev_b32 v240, 16, v21
    v_and_b32 v225, 0xffff0000, v20
    v_mfma_f32_16x16x32_bf16 v[172:175], a[36:39], v[52:55], v[172:175]
    buffer_load_dwordx4 v[52:55], v35, s[60:63], s15 offen sc1
    s_waitcnt vmcnt(12)
    v_mfma_f32_16x16x32_bf16 v[96:99], a[40:43], v[56:59], v[96:99]
    s_cmp_gt_u32 s26, 1
    s_cselect_b32 s15, s24, s25
    v_mfma_f32_16x16x32_bf16 v[112:115], a[44:47], v[56:59], v[112:115]
    v_and_b32 v241, 0xffff0000, v21
    v_sub_f32 v226, v224, v212
    v_mfma_f32_16x16x32_bf16 v[128:131], a[48:51], v[56:59], v[128:131]
    s_add_u32 s15, s15, 4096
    v_sub_f32 v242, v240, v212
    v_mfma_f32_16x16x32_bf16 v[144:147], a[52:55], v[56:59], v[144:147]
    v_sub_f32 v227, v225, v212
    v_sub_f32 v243, v241, v212
    v_mfma_f32_16x16x32_bf16 v[160:163], a[56:59], v[56:59], v[160:163]
    buffer_load_dwordx4 v[56:59], v32, s[60:63], s15 offen sc1
    v_mfma_f32_16x16x32_bf16 v[100:103], a[40:43], v[60:63], v[100:103]
    v_cvt_pk_bf16_f32 v227, v226, v227
    v_cvt_pk_bf16_f32 v243, v242, v243
    v_mfma_f32_16x16x32_bf16 v[116:119], a[44:47], v[60:63], v[116:119]
    v_lshlrev_b32 v226, 16, v227
    v_lshlrev_b32 v242, 16, v243
    v_mfma_f32_16x16x32_bf16 v[132:135], a[48:51], v[60:63], v[132:135]
    v_and_b32 v227, 0xffff0000, v227
    v_and_b32 v243, 0xffff0000, v243
    v_mfma_f32_16x16x32_bf16 v[148:151], a[52:55], v[60:63], v[148:151]
    v_mul_f32 v226, v226, v213
    v_mul_f32 v242, v242, v213
    v_mfma_f32_16x16x32_bf16 v[164:167], a[56:59], v[60:63], v[164:167]
    buffer_load_dwordx4 v[60:63], v33, s[60:63], s15 offen sc1
    v_mfma_f32_16x16x32_bf16 v[104:107], a[40:43], v[64:67], v[104:107]
    v_mul_f32 v227, v227, v213
    v_mul_f32 v243, v243, v213
    v_mfma_f32_16x16x32_bf16 v[120:123], a[44:47], v[64:67], v[120:123]
    v_cvt_pk_bf16_f32 v227, v226, v227
    v_cvt_pk_bf16_f32 v243, v242, v243
    v_mfma_f32_16x16x32_bf16 v[136:139], a[48:51], v[64:67], v[136:139]
    v_lshlrev_b32 v226, 16, v227
    v_lshlrev_b32 v242, 16, v243
    v_mfma_f32_16x16x32_bf16 v[152:155], a[52:55], v[64:67], v[152:155]
    v_and_b32 v227, 0xffff0000, v227
    v_and_b32 v243, 0xffff0000, v243
    v_mfma_f32_16x16x32_bf16 v[168:171], a[56:59], v[64:67], v[168:171]
    buffer_load_dwordx4 v[64:67], v34, s[60:63], s15 offen sc1
    v_mfma_f32_16x16x32_bf16 v[108:111], a[40:43], v[68:71], v[108:111]
    v_lshlrev_b32 v228, 16, v182
    v_lshlrev_b32 v244, 16, v183
    v_mfma_f32_16x16x32_bf16 v[124:127], a[44:47], v[68:71], v[124:127]
    v_and_b32 v229, 0xffff0000, v182
    v_and_b32 v245, 0xffff0000, v183
    v_mfma_f32_16x16x32_bf16 v[140:143], a[48:51], v[68:71], v[140:143]
    v_mul_f32 v226, v226, v228
    v_mul_f32 v242, v242, v244
    v_mfma_f32_16x16x32_bf16 v[156:159], a[52:55], v[68:71], v[156:159]
    v_mul_f32 v227, v227, v229
    v_mul_f32 v243, v243, v245
    v_mfma_f32_16x16x32_bf16 v[172:175], a[56:59], v[68:71], v[172:175]
    buffer_load_dwordx4 v[68:71], v35, s[60:63], s15 offen sc1
    s_waitcnt vmcnt(12)
    v_mfma_f32_16x16x32_bf16 v[96:99], a[60:63], v[72:75], v[96:99]
    s_cmp_gt_u32 s26, 2
    s_cselect_b32 s15, s24, s25
    v_mfma_f32_16x16x32_bf16 v[112:115], a[64:67], v[72:75], v[112:115]
    v_cvt_pk_bf16_f32 v227, v226, v227
    v_cvt_pk_bf16_f32 v243, v242, v243
    v_mfma_f32_16x16x32_bf16 v[128:131], a[68:71], v[72:75], v[128:131]
    s_add_u32 s15, s15, 8192
    v_lshlrev_b32 v226, 16, v227
    v_mfma_f32_16x16x32_bf16 v[144:147], a[72:75], v[72:75], v[144:147]
    v_lshlrev_b32 v242, 16, v243
    v_and_b32 v227, 0xffff0000, v227
    v_mfma_f32_16x16x32_bf16 v[160:163], a[76:79], v[72:75], v[160:163]
    buffer_load_dwordx4 v[72:75], v32, s[60:63], s15 offen sc1
    v_mfma_f32_16x16x32_bf16 v[100:103], a[60:63], v[76:79], v[100:103]
    v_and_b32 v243, 0xffff0000, v243
    v_lshlrev_b32 v228, 16, v208
    v_mfma_f32_16x16x32_bf16 v[116:119], a[64:67], v[76:79], v[116:119]
    v_lshlrev_b32 v244, 16, v209
    v_and_b32 v229, 0xffff0000, v208
    v_mfma_f32_16x16x32_bf16 v[132:135], a[68:71], v[76:79], v[132:135]
    v_and_b32 v245, 0xffff0000, v209
    v_add_f32 v226, v224, v226
    v_mfma_f32_16x16x32_bf16 v[148:151], a[72:75], v[76:79], v[148:151]
    v_add_f32 v242, v240, v242
    v_add_f32 v227, v225, v227
    v_mfma_f32_16x16x32_bf16 v[164:167], a[76:79], v[76:79], v[164:167]
    buffer_load_dwordx4 v[76:79], v33, s[60:63], s15 offen sc1
    v_mfma_f32_16x16x32_bf16 v[104:107], a[60:63], v[80:83], v[104:107]
    v_add_f32 v243, v241, v243
    v_add_f32 v16, v226, v228
    v_mfma_f32_16x16x32_bf16 v[120:123], a[64:67], v[80:83], v[120:123]
    v_add_f32 v18, v242, v244
    v_add_f32 v17, v227, v229
    v_mfma_f32_16x16x32_bf16 v[136:139], a[68:71], v[80:83], v[136:139]
    v_add_f32 v19, v243, v245
    v_lshlrev_b32 v224, 16, v22
    v_mfma_f32_16x16x32_bf16 v[152:155], a[72:75], v[80:83], v[152:155]
    v_lshlrev_b32 v240, 16, v23
    v_and_b32 v225, 0xffff0000, v22
    v_mfma_f32_16x16x32_bf16 v[168:171], a[76:79], v[80:83], v[168:171]
    buffer_load_dwordx4 v[80:83], v34, s[60:63], s15 offen sc1
    v_mfma_f32_16x16x32_bf16 v[108:111], a[60:63], v[84:87], v[108:111]
    v_and_b32 v241, 0xffff0000, v23
    v_sub_f32 v226, v224, v212
    v_mfma_f32_16x16x32_bf16 v[124:127], a[64:67], v[84:87], v[124:127]
    v_sub_f32 v242, v240, v212
    v_sub_f32 v227, v225, v212
    v_mfma_f32_16x16x32_bf16 v[140:143], a[68:71], v[84:87], v[140:143]
    v_sub_f32 v243, v241, v212
    v_cvt_pk_bf16_f32 v227, v226, v227
    v_mfma_f32_16x16x32_bf16 v[156:159], a[72:75], v[84:87], v[156:159]
    v_cvt_pk_bf16_f32 v243, v242, v243
    v_lshlrev_b32 v226, 16, v227
    v_mfma_f32_16x16x32_bf16 v[172:175], a[76:79], v[84:87], v[172:175]
    buffer_load_dwordx4 v[84:87], v35, s[60:63], s15 offen sc1
    s_waitcnt vmcnt(12)
    v_mfma_f32_16x16x32_bf16 v[96:99], a[80:83], a[100:103], v[96:99]
    s_cmp_gt_u32 s26, 3
    s_cselect_b32 s15, s24, s25
    v_mfma_f32_16x16x32_bf16 v[112:115], a[84:87], a[100:103], v[112:115]
    v_lshlrev_b32 v242, 16, v243
    v_and_b32 v227, 0xffff0000, v227
    v_mfma_f32_16x16x32_bf16 v[128:131], a[88:91], a[100:103], v[128:131]
    s_add_u32 s15, s15, 12288
    v_and_b32 v243, 0xffff0000, v243
    v_mfma_f32_16x16x32_bf16 v[144:147], a[92:95], a[100:103], v[144:147]
    v_mul_f32 v226, v226, v213
    v_mul_f32 v242, v242, v213
    v_mfma_f32_16x16x32_bf16 v[160:163], a[96:99], a[100:103], v[160:163]
    buffer_load_dwordx4 a[100:103], v32, s[60:63], s15 offen sc1
    v_mfma_f32_16x16x32_bf16 v[100:103], a[80:83], a[104:107], v[100:103]
    v_mul_f32 v227, v227, v213
    v_mul_f32 v243, v243, v213
    v_mfma_f32_16x16x32_bf16 v[116:119], a[84:87], a[104:107], v[116:119]
    v_cvt_pk_bf16_f32 v227, v226, v227
    v_cvt_pk_bf16_f32 v243, v242, v243
    v_mfma_f32_16x16x32_bf16 v[132:135], a[88:91], a[104:107], v[132:135]
    v_lshlrev_b32 v226, 16, v227
    v_lshlrev_b32 v242, 16, v243
    v_mfma_f32_16x16x32_bf16 v[148:151], a[92:95], a[104:107], v[148:151]
    v_and_b32 v227, 0xffff0000, v227
    v_and_b32 v243, 0xffff0000, v243
    v_mfma_f32_16x16x32_bf16 v[164:167], a[96:99], a[104:107], v[164:167]
    buffer_load_dwordx4 a[104:107], v33, s[60:63], s15 offen sc1
    v_mfma_f32_16x16x32_bf16 v[104:107], a[80:83], a[248:251], v[104:107]
    v_lshlrev_b32 v228, 16, v192
    v_lshlrev_b32 v244, 16, v193
    v_mfma_f32_16x16x32_bf16 v[120:123], a[84:87], a[248:251], v[120:123]
    v_and_b32 v229, 0xffff0000, v192
    v_and_b32 v245, 0xffff0000, v193
    v_mfma_f32_16x16x32_bf16 v[136:139], a[88:91], a[248:251], v[136:139]
    v_mul_f32 v226, v226, v228
    v_mul_f32 v242, v242, v244
    v_mfma_f32_16x16x32_bf16 v[152:155], a[92:95], a[248:251], v[152:155]
    v_mul_f32 v227, v227, v229
    v_mul_f32 v243, v243, v245
    v_mfma_f32_16x16x32_bf16 v[168:171], a[96:99], a[248:251], v[168:171]
    buffer_load_dwordx4 a[248:251], v34, s[60:63], s15 offen sc1
    v_mfma_f32_16x16x32_bf16 v[108:111], a[80:83], a[252:255], v[108:111]
    v_cvt_pk_bf16_f32 v227, v226, v227
    v_cvt_pk_bf16_f32 v243, v242, v243
    v_mfma_f32_16x16x32_bf16 v[124:127], a[84:87], a[252:255], v[124:127]
    v_lshlrev_b32 v226, 16, v227
    v_lshlrev_b32 v242, 16, v243
    v_mfma_f32_16x16x32_bf16 v[140:143], a[88:91], a[252:255], v[140:143]
    v_and_b32 v227, 0xffff0000, v227
    v_and_b32 v243, 0xffff0000, v243
    v_mfma_f32_16x16x32_bf16 v[156:159], a[92:95], a[252:255], v[156:159]
    v_lshlrev_b32 v228, 16, v210
    v_lshlrev_b32 v244, 16, v211
    v_mfma_f32_16x16x32_bf16 v[172:175], a[96:99], a[252:255], v[172:175]
    buffer_load_dwordx4 a[252:255], v35, s[60:63], s15 offen sc1
    v_and_b32 v229, 0xffff0000, v210
    v_and_b32 v245, 0xffff0000, v211
    v_add_f32 v226, v224, v226
    v_add_f32 v242, v240, v242
    v_add_f32 v227, v225, v227
    v_add_f32 v243, v241, v243
    v_add_f32 v20, v226, v228
    v_add_f32 v22, v242, v244
    v_add_f32 v21, v227, v229
    v_add_f32 v23, v243, v245
    s_waitcnt vmcnt(12)
    v_mfma_f32_16x16x32_bf16 v[176:179], a[108:111], v[40:43], 0
    s_cmp_gt_u32 s26, 4
    s_cselect_b32 s15, s24, s25
    v_mfma_f32_16x16x32_bf16 v[192:195], a[112:115], v[40:43], 0
    v_mfma_f32_16x16x32_bf16 v[208:211], a[116:119], v[40:43], 0
    s_add_u32 s15, s15, 16384
    ds_write_b128 v27, v[96:99] offset:0
    v_mfma_f32_16x16x32_bf16 v[224:227], a[120:123], v[40:43], 0
    v_mfma_f32_16x16x32_bf16 v[240:243], a[124:127], v[40:43], 0
    buffer_load_dwordx4 v[40:43], v32, s[60:63], s15 offen sc1
    v_mfma_f32_16x16x32_bf16 v[180:183], a[108:111], v[44:47], 0
    ds_write_b128 v27, v[112:115] offset:64
    v_mfma_f32_16x16x32_bf16 v[196:199], a[112:115], v[44:47], 0
    v_mfma_f32_16x16x32_bf16 v[212:215], a[116:119], v[44:47], 0
    ds_write_b128 v27, v[128:131] offset:128
    v_mfma_f32_16x16x32_bf16 v[228:231], a[120:123], v[44:47], 0
    v_mfma_f32_16x16x32_bf16 v[244:247], a[124:127], v[44:47], 0
    buffer_load_dwordx4 v[44:47], v33, s[60:63], s15 offen sc1
    v_mfma_f32_16x16x32_bf16 v[184:187], a[108:111], v[48:51], 0
    ds_write_b128 v27, v[144:147] offset:192
    v_mfma_f32_16x16x32_bf16 v[200:203], a[112:115], v[48:51], 0
    v_mfma_f32_16x16x32_bf16 v[216:219], a[116:119], v[48:51], 0
    ds_write_b128 v27, v[160:163] offset:256
    v_mfma_f32_16x16x32_bf16 v[232:235], a[120:123], v[48:51], 0
    v_mfma_f32_16x16x32_bf16 v[248:251], a[124:127], v[48:51], 0
    buffer_load_dwordx4 v[48:51], v34, s[60:63], s15 offen sc1
    v_mfma_f32_16x16x32_bf16 v[188:191], a[108:111], v[52:55], 0
    ds_write_b128 v27, v[100:103] offset:5120
    v_mfma_f32_16x16x32_bf16 v[204:207], a[112:115], v[52:55], 0
    ds_write_b128 v27, v[116:119] offset:5184
    v_mfma_f32_16x16x32_bf16 v[220:223], a[116:119], v[52:55], 0
    v_mfma_f32_16x16x32_bf16 v[236:239], a[120:123], v[52:55], 0
    v_mfma_f32_16x16x32_bf16 v[252:255], a[124:127], v[52:55], 0
    buffer_load_dwordx4 v[52:55], v35, s[60:63], s15 offen sc1
    s_waitcnt vmcnt(12)
    v_mfma_f32_16x16x32_bf16 v[176:179], a[128:131], v[56:59], v[176:179]
    s_cmp_gt_u32 s26, 5
    s_cselect_b32 s15, s24, s25
    v_mfma_f32_16x16x32_bf16 v[192:195], a[132:135], v[56:59], v[192:195]
    v_mfma_f32_16x16x32_bf16 v[208:211], a[136:139], v[56:59], v[208:211]
    s_add_u32 s15, s15, 20480
    ds_write_b128 v27, v[132:135] offset:5248
    v_mfma_f32_16x16x32_bf16 v[224:227], a[140:143], v[56:59], v[224:227]
    v_mfma_f32_16x16x32_bf16 v[240:243], a[144:147], v[56:59], v[240:243]
    buffer_load_dwordx4 v[56:59], v32, s[60:63], s15 offen sc1
    v_mfma_f32_16x16x32_bf16 v[180:183], a[128:131], v[60:63], v[180:183]
    ds_write_b128 v27, v[148:151] offset:5312
    v_mfma_f32_16x16x32_bf16 v[196:199], a[132:135], v[60:63], v[196:199]
    v_mfma_f32_16x16x32_bf16 v[212:215], a[136:139], v[60:63], v[212:215]
    ds_write_b128 v27, v[164:167] offset:5376
    v_mfma_f32_16x16x32_bf16 v[228:231], a[140:143], v[60:63], v[228:231]
    v_mfma_f32_16x16x32_bf16 v[244:247], a[144:147], v[60:63], v[244:247]
    buffer_load_dwordx4 v[60:63], v33, s[60:63], s15 offen sc1
    v_mfma_f32_16x16x32_bf16 v[184:187], a[128:131], v[64:67], v[184:187]
    ds_write_b128 v27, v[104:107] offset:10240
    v_mfma_f32_16x16x32_bf16 v[200:203], a[132:135], v[64:67], v[200:203]
    v_mfma_f32_16x16x32_bf16 v[216:219], a[136:139], v[64:67], v[216:219]
    ds_write_b128 v27, v[120:123] offset:10304
    v_mfma_f32_16x16x32_bf16 v[232:235], a[140:143], v[64:67], v[232:235]
    v_mfma_f32_16x16x32_bf16 v[248:251], a[144:147], v[64:67], v[248:251]
    buffer_load_dwordx4 v[64:67], v34, s[60:63], s15 offen sc1
    v_mfma_f32_16x16x32_bf16 v[188:191], a[128:131], v[68:71], v[188:191]
    ds_write_b128 v27, v[136:139] offset:10368
    v_mfma_f32_16x16x32_bf16 v[204:207], a[132:135], v[68:71], v[204:207]
    ds_write_b128 v27, v[152:155] offset:10432
    v_mfma_f32_16x16x32_bf16 v[220:223], a[136:139], v[68:71], v[220:223]
    v_mfma_f32_16x16x32_bf16 v[236:239], a[140:143], v[68:71], v[236:239]
    v_mfma_f32_16x16x32_bf16 v[252:255], a[144:147], v[68:71], v[252:255]
    buffer_load_dwordx4 v[68:71], v35, s[60:63], s15 offen sc1
    s_waitcnt vmcnt(12)
    v_mfma_f32_16x16x32_bf16 v[176:179], a[148:151], v[72:75], v[176:179]
    s_cmp_gt_u32 s26, 6
    s_cselect_b32 s15, s24, s25
    v_mfma_f32_16x16x32_bf16 v[192:195], a[152:155], v[72:75], v[192:195]
    v_mfma_f32_16x16x32_bf16 v[208:211], a[156:159], v[72:75], v[208:211]
    s_add_u32 s15, s15, 24576
    ds_write_b128 v27, v[168:171] offset:10496
    v_mfma_f32_16x16x32_bf16 v[224:227], a[160:163], v[72:75], v[224:227]
    v_mfma_f32_16x16x32_bf16 v[240:243], a[164:167], v[72:75], v[240:243]
    buffer_load_dwordx4 v[72:75], v32, s[60:63], s15 offen sc1
    v_mfma_f32_16x16x32_bf16 v[180:183], a[148:151], v[76:79], v[180:183]
    ds_write_b128 v27, v[108:111] offset:15360
    v_mfma_f32_16x16x32_bf16 v[196:199], a[152:155], v[76:79], v[196:199]
    ds_write_b128 v27, v[124:127] offset:15424
    v_mfma_f32_16x16x32_bf16 v[212:215], a[156:159], v[76:79], v[212:215]
    v_mfma_f32_16x16x32_bf16 v[228:231], a[160:163], v[76:79], v[228:231]
    ds_write_b128 v27, v[140:143] offset:15488
    v_mfma_f32_16x16x32_bf16 v[244:247], a[164:167], v[76:79], v[244:247]
    buffer_load_dwordx4 v[76:79], v33, s[60:63], s15 offen sc1
    v_mfma_f32_16x16x32_bf16 v[184:187], a[148:151], v[80:83], v[184:187]
    ds_write_b128 v27, v[156:159] offset:15552
    v_mfma_f32_16x16x32_bf16 v[200:203], a[152:155], v[80:83], v[200:203]
    v_mfma_f32_16x16x32_bf16 v[216:219], a[156:159], v[80:83], v[216:219]
    ds_write_b128 v27, v[172:175] offset:15616
    v_mfma_f32_16x16x32_bf16 v[232:235], a[160:163], v[80:83], v[232:235]
    v_mfma_f32_16x16x32_bf16 v[248:251], a[164:167], v[80:83], v[248:251]
    buffer_load_dwordx4 v[80:83], v34, s[60:63], s15 offen sc1
    v_mfma_f32_16x16x32_bf16 v[188:191], a[148:151], v[84:87], v[188:191]
    v_mfma_f32_16x16x32_bf16 v[204:207], a[152:155], v[84:87], v[204:207]
    v_mfma_f32_16x16x32_bf16 v[220:223], a[156:159], v[84:87], v[220:223]
    v_mfma_f32_16x16x32_bf16 v[236:239], a[160:163], v[84:87], v[236:239]
    v_mfma_f32_16x16x32_bf16 v[252:255], a[164:167], v[84:87], v[252:255]
    buffer_load_dwordx4 v[84:87], v35, s[60:63], s15 offen sc1
    s_waitcnt vmcnt(12)
    s_waitcnt lgkmcnt(0)
    s_barrier
    v_mfma_f32_16x16x32_bf16 v[176:179], a[168:171], a[100:103], v[176:179]
    s_cmp_gt_u32 s26, 7
    s_cselect_b32 s15, s24, s25
    v_mfma_f32_16x16x32_bf16 v[192:195], a[172:175], a[100:103], v[192:195]
    ds_read_b128 v[96:99], v88 offset:0
    v_mfma_f32_16x16x32_bf16 v[208:211], a[176:179], a[100:103], v[208:211]
    s_add_u32 s15, s15, 28672
    ds_read_b128 v[100:103], v89 offset:0
    v_mfma_f32_16x16x32_bf16 v[224:227], a[180:183], a[100:103], v[224:227]
    ds_read_b128 v[104:107], v90 offset:0
    v_mfma_f32_16x16x32_bf16 v[240:243], a[184:187], a[100:103], v[240:243]
    buffer_load_dwordx4 a[100:103], v32, s[60:63], s15 offen sc1
    v_mfma_f32_16x16x32_bf16 v[180:183], a[168:171], a[104:107], v[180:183]
    ds_read_b128 v[108:111], v91 offset:0
    v_mfma_f32_16x16x32_bf16 v[196:199], a[172:175], a[104:107], v[196:199]
    ds_read_b128 v[112:115], v88 offset:64
    v_mfma_f32_16x16x32_bf16 v[212:215], a[176:179], a[104:107], v[212:215]
    ds_read_b128 v[116:119], v89 offset:64
    v_mfma_f32_16x16x32_bf16 v[228:231], a[180:183], a[104:107], v[228:231]
    ds_read_b128 v[120:123], v90 offset:64
    v_mfma_f32_16x16x32_bf16 v[244:247], a[184:187], a[104:107], v[244:247]
    buffer_load_dwordx4 a[104:107], v33, s[60:63], s15 offen sc1
    v_mfma_f32_16x16x32_bf16 v[184:187], a[168:171], a[248:251], v[184:187]
    ds_read_b128 v[124:127], v91 offset:64
    v_mfma_f32_16x16x32_bf16 v[200:203], a[172:175], a[248:251], v[200:203]
    ds_read_b128 v[128:131], v88 offset:128
    v_mfma_f32_16x16x32_bf16 v[216:219], a[176:179], a[248:251], v[216:219]
    ds_read_b128 v[132:135], v89 offset:128
    v_mfma_f32_16x16x32_bf16 v[232:235], a[180:183], a[248:251], v[232:235]
    v_mfma_f32_16x16x32_bf16 v[248:251], a[184:187], a[248:251], v[248:251]
    buffer_load_dwordx4 a[248:251], v34, s[60:63], s15 offen sc1
    v_mfma_f32_16x16x32_bf16 v[188:191], a[168:171], a[252:255], v[188:191]
    ds_read_b128 v[136:139], v90 offset:128
    v_mfma_f32_16x16x32_bf16 v[204:207], a[172:175], a[252:255], v[204:207]
    ds_read_b128 v[140:143], v91 offset:128
    v_mfma_f32_16x16x32_bf16 v[220:223], a[176:179], a[252:255], v[220:223]
    v_mfma_f32_16x16x32_bf16 v[236:239], a[180:183], a[252:255], v[236:239]
    v_mfma_f32_16x16x32_bf16 v[252:255], a[184:187], a[252:255], v[252:255]
    buffer_load_dwordx4 a[252:255], v35, s[60:63], s15 offen sc1
    s_waitcnt vmcnt(12)
    v_mfma_f32_16x16x32_bf16 v[176:179], a[188:191], v[40:43], v[176:179]
    s_cmp_gt_u32 s26, 8
    s_cselect_b32 s15, s24, s25
    v_mfma_f32_16x16x32_bf16 v[192:195], a[192:195], v[40:43], v[192:195]
    ds_read_b128 v[144:147], v88 offset:192
    s_waitcnt lgkmcnt(9)
    v_mfma_f32_16x16x32_bf16 v[208:211], a[196:199], v[40:43], v[208:211]
    s_add_u32 s15, s15, 32768
    ds_read_b128 v[148:151], v89 offset:192
    v_mfma_f32_16x16x32_bf16 v[224:227], a[200:203], v[40:43], v[224:227]
    ds_read_b128 v[152:155], v90 offset:192
    v_add_f32 v96, v96, v100
    v_mfma_f32_16x16x32_bf16 v[240:243], a[204:207], v[40:43], v[240:243]
    buffer_load_dwordx4 v[40:43], v32, s[60:63], s15 offen sc1
    v_mfma_f32_16x16x32_bf16 v[180:183], a[188:191], v[44:47], v[180:183]
    ds_read_b128 v[156:159], v91 offset:192
    v_add_f32 v97, v97, v101
    v_mfma_f32_16x16x32_bf16 v[196:199], a[192:195], v[44:47], v[196:199]
    ds_read_b128 v[160:163], v88 offset:256
    v_add_f32 v98, v98, v102
    v_mfma_f32_16x16x32_bf16 v[212:215], a[196:199], v[44:47], v[212:215]
    v_add_f32 v99, v99, v103
    v_add_f32 v104, v104, v108
    v_mfma_f32_16x16x32_bf16 v[228:231], a[200:203], v[44:47], v[228:231]
    ds_read_b128 v[164:167], v89 offset:256
    v_add_f32 v105, v105, v109
    v_mfma_f32_16x16x32_bf16 v[244:247], a[204:207], v[44:47], v[244:247]
    buffer_load_dwordx4 v[44:47], v33, s[60:63], s15 offen sc1
    v_mfma_f32_16x16x32_bf16 v[184:187], a[188:191], v[48:51], v[184:187]
    ds_read_b128 v[168:171], v90 offset:256
    v_add_f32 v106, v106, v110
    v_mfma_f32_16x16x32_bf16 v[200:203], a[192:195], v[48:51], v[200:203]
    ds_read_b128 v[172:175], v91 offset:256
    v_add_f32 v107, v107, v111
    v_mfma_f32_16x16x32_bf16 v[216:219], a[196:199], v[48:51], v[216:219]
    v_add_f32 v96, v96, v104
    v_add_f32 v97, v97, v105
    v_mfma_f32_16x16x32_bf16 v[232:235], a[200:203], v[48:51], v[232:235]
    v_add_f32 v98, v98, v106
    v_add_f32 v99, v99, v107
    v_mfma_f32_16x16x32_bf16 v[248:251], a[204:207], v[48:51], v[248:251]
    buffer_load_dwordx4 v[48:51], v34, s[60:63], s15 offen sc1
    v_mfma_f32_16x16x32_bf16 v[188:191], a[188:191], v[52:55], v[188:191]
    buffer_store_dwordx4 v[96:99], v26, s[60:63], s75 offen offset:0 sc1
    v_mfma_f32_16x16x32_bf16 v[204:207], a[192:195], v[52:55], v[204:207]
    s_waitcnt lgkmcnt(12)
    v_add_f32 v112, v112, v116
    v_mfma_f32_16x16x32_bf16 v[220:223], a[196:199], v[52:55], v[220:223]
    v_add_f32 v113, v113, v117
    v_add_f32 v114, v114, v118
    v_mfma_f32_16x16x32_bf16 v[236:239], a[200:203], v[52:55], v[236:239]
    v_add_f32 v115, v115, v119
    v_add_f32 v120, v120, v124
    v_mfma_f32_16x16x32_bf16 v[252:255], a[204:207], v[52:55], v[252:255]
    buffer_load_dwordx4 v[52:55], v35, s[60:63], s15 offen sc1
    s_waitcnt vmcnt(13)
    v_mfma_f32_16x16x32_bf16 v[176:179], a[208:211], v[56:59], v[176:179]
    s_cmp_gt_u32 s26, 9
    s_cselect_b32 s15, s24, s25
    v_mfma_f32_16x16x32_bf16 v[192:195], a[212:215], v[56:59], v[192:195]
    v_add_f32 v121, v121, v125
    v_add_f32 v122, v122, v126
    v_mfma_f32_16x16x32_bf16 v[208:211], a[216:219], v[56:59], v[208:211]
    s_add_u32 s15, s15, 36864
    v_add_f32 v123, v123, v127
    v_mfma_f32_16x16x32_bf16 v[224:227], a[220:223], v[56:59], v[224:227]
    v_add_f32 v112, v112, v120
    v_add_f32 v113, v113, v121
    v_mfma_f32_16x16x32_bf16 v[240:243], a[224:227], v[56:59], v[240:243]
    buffer_load_dwordx4 v[56:59], v32, s[60:63], s15 offen sc1
    v_mfma_f32_16x16x32_bf16 v[180:183], a[208:211], v[60:63], v[180:183]
    v_add_f32 v114, v114, v122
    v_add_f32 v115, v115, v123
    v_mfma_f32_16x16x32_bf16 v[196:199], a[212:215], v[60:63], v[196:199]
    buffer_store_dwordx4 v[112:115], v26, s[60:63], s75 offen offset:1024 sc1
    v_mfma_f32_16x16x32_bf16 v[212:215], a[216:219], v[60:63], v[212:215]
    s_waitcnt lgkmcnt(8)
    v_add_f32 v128, v128, v132
    v_mfma_f32_16x16x32_bf16 v[228:231], a[220:223], v[60:63], v[228:231]
    v_add_f32 v129, v129, v133
    v_add_f32 v130, v130, v134
    v_mfma_f32_16x16x32_bf16 v[244:247], a[224:227], v[60:63], v[244:247]
    buffer_load_dwordx4 v[60:63], v33, s[60:63], s15 offen sc1
    v_mfma_f32_16x16x32_bf16 v[184:187], a[208:211], v[64:67], v[184:187]
    v_add_f32 v131, v131, v135
    v_add_f32 v136, v136, v140
    v_mfma_f32_16x16x32_bf16 v[200:203], a[212:215], v[64:67], v[200:203]
    v_add_f32 v137, v137, v141
    v_add_f32 v138, v138, v142
    v_mfma_f32_16x16x32_bf16 v[216:219], a[216:219], v[64:67], v[216:219]
    v_add_f32 v139, v139, v143
    v_add_f32 v128, v128, v136
    v_mfma_f32_16x16x32_bf16 v[232:235], a[220:223], v[64:67], v[232:235]
    v_add_f32 v129, v129, v137
    v_add_f32 v130, v130, v138
    v_mfma_f32_16x16x32_bf16 v[248:251], a[224:227], v[64:67], v[248:251]
    buffer_load_dwordx4 v[64:67], v34, s[60:63], s15 offen sc1
    v_mfma_f32_16x16x32_bf16 v[188:191], a[208:211], v[68:71], v[188:191]
    v_add_f32 v131, v131, v139
    v_mfma_f32_16x16x32_bf16 v[204:207], a[212:215], v[68:71], v[204:207]
    buffer_store_dwordx4 v[128:131], v26, s[60:63], s75 offen offset:2048 sc1
    v_mfma_f32_16x16x32_bf16 v[220:223], a[216:219], v[68:71], v[220:223]
    s_waitcnt lgkmcnt(4)
    v_add_f32 v144, v144, v148
    v_mfma_f32_16x16x32_bf16 v[236:239], a[220:223], v[68:71], v[236:239]
    v_add_f32 v145, v145, v149
    v_add_f32 v146, v146, v150
    v_mfma_f32_16x16x32_bf16 v[252:255], a[224:227], v[68:71], v[252:255]
    buffer_load_dwordx4 v[68:71], v35, s[60:63], s15 offen sc1
    s_waitcnt vmcnt(15)
    v_mfma_f32_16x16x32_bf16 v[176:179], a[228:231], v[72:75], v[176:179]
    s_cmp_gt_u32 s26, 10
    s_cselect_b32 s15, s24, s25
    v_mfma_f32_16x16x32_bf16 v[192:195], a[232:235], v[72:75], v[192:195]
    v_add_f32 v147, v147, v151
    v_add_f32 v152, v152, v156
    v_mfma_f32_16x16x32_bf16 v[208:211], a[236:239], v[72:75], v[208:211]
    s_add_u32 s15, s15, 40960
    v_add_f32 v153, v153, v157
    v_mfma_f32_16x16x32_bf16 v[224:227], a[240:243], v[72:75], v[224:227]
    v_add_f32 v154, v154, v158
    v_add_f32 v155, v155, v159
    v_mfma_f32_16x16x32_bf16 v[240:243], a[244:247], v[72:75], v[240:243]
    buffer_load_dwordx4 v[72:75], v32, s[60:63], s15 offen sc1
    v_mfma_f32_16x16x32_bf16 v[180:183], a[228:231], v[76:79], v[180:183]
    v_add_f32 v144, v144, v152
    v_add_f32 v145, v145, v153
    v_mfma_f32_16x16x32_bf16 v[196:199], a[232:235], v[76:79], v[196:199]
    v_add_f32 v146, v146, v154
    v_add_f32 v147, v147, v155
    v_mfma_f32_16x16x32_bf16 v[212:215], a[236:239], v[76:79], v[212:215]
    buffer_store_dwordx4 v[144:147], v26, s[60:63], s75 offen offset:3072 sc1
    v_mfma_f32_16x16x32_bf16 v[228:231], a[240:243], v[76:79], v[228:231]
    s_waitcnt lgkmcnt(0)
    v_add_f32 v160, v160, v164
    v_mfma_f32_16x16x32_bf16 v[244:247], a[244:247], v[76:79], v[244:247]
    buffer_load_dwordx4 v[76:79], v33, s[60:63], s15 offen sc1
    v_mfma_f32_16x16x32_bf16 v[184:187], a[228:231], v[80:83], v[184:187]
    v_add_f32 v161, v161, v165
    v_add_f32 v162, v162, v166
    v_mfma_f32_16x16x32_bf16 v[200:203], a[232:235], v[80:83], v[200:203]
    v_add_f32 v163, v163, v167
    v_add_f32 v168, v168, v172
    v_mfma_f32_16x16x32_bf16 v[216:219], a[236:239], v[80:83], v[216:219]
    v_add_f32 v169, v169, v173
    v_add_f32 v170, v170, v174
    v_mfma_f32_16x16x32_bf16 v[232:235], a[240:243], v[80:83], v[232:235]
    v_add_f32 v171, v171, v175
    v_add_f32 v160, v160, v168
    v_mfma_f32_16x16x32_bf16 v[248:251], a[244:247], v[80:83], v[248:251]
    buffer_load_dwordx4 v[80:83], v34, s[60:63], s15 offen sc1
    v_mfma_f32_16x16x32_bf16 v[188:191], a[228:231], v[84:87], v[188:191]
    v_add_f32 v161, v161, v169
    v_add_f32 v162, v162, v170
    v_mfma_f32_16x16x32_bf16 v[204:207], a[232:235], v[84:87], v[204:207]
    v_add_f32 v163, v163, v171
    v_mfma_f32_16x16x32_bf16 v[220:223], a[236:239], v[84:87], v[220:223]
    buffer_store_dwordx4 v[160:163], v26, s[60:63], s51 offen offset:0 sc1
    v_mfma_f32_16x16x32_bf16 v[236:239], a[240:243], v[84:87], v[236:239]
    v_mfma_f32_16x16x32_bf16 v[252:255], a[244:247], v[84:87], v[252:255]
    buffer_load_dwordx4 v[84:87], v35, s[60:63], s15 offen sc1
    s_waitcnt vmcnt(17)
    v_mfma_f32_16x16x32_bf16 v[176:179], a[0:3], a[100:103], v[176:179]
    s_cmp_gt_u32 s26, 11
    s_cselect_b32 s15, s24, s25
    v_mfma_f32_16x16x32_bf16 v[192:195], a[4:7], a[100:103], v[192:195]
    v_mfma_f32_16x16x32_bf16 v[208:211], a[8:11], a[100:103], v[208:211]
    s_add_u32 s15, s15, 45056
    v_mfma_f32_16x16x32_bf16 v[224:227], a[12:15], a[100:103], v[224:227]
    v_mfma_f32_16x16x32_bf16 v[240:243], a[16:19], a[100:103], v[240:243]
    buffer_load_dwordx4 a[100:103], v32, s[60:63], s15 offen sc1
    v_mfma_f32_16x16x32_bf16 v[180:183], a[0:3], a[104:107], v[180:183]
    v_mfma_f32_16x16x32_bf16 v[196:199], a[4:7], a[104:107], v[196:199]
    v_mfma_f32_16x16x32_bf16 v[212:215], a[8:11], a[104:107], v[212:215]
    v_mfma_f32_16x16x32_bf16 v[228:231], a[12:15], a[104:107], v[228:231]
    v_mfma_f32_16x16x32_bf16 v[244:247], a[16:19], a[104:107], v[244:247]
    buffer_load_dwordx4 a[104:107], v33, s[60:63], s15 offen sc1
    v_mfma_f32_16x16x32_bf16 v[184:187], a[0:3], a[248:251], v[184:187]
    v_mfma_f32_16x16x32_bf16 v[200:203], a[4:7], a[248:251], v[200:203]
    v_mfma_f32_16x16x32_bf16 v[216:219], a[8:11], a[248:251], v[216:219]
    v_mfma_f32_16x16x32_bf16 v[232:235], a[12:15], a[248:251], v[232:235]
    v_mfma_f32_16x16x32_bf16 v[248:251], a[16:19], a[248:251], v[248:251]
    buffer_load_dwordx4 a[248:251], v34, s[60:63], s15 offen sc1
    v_mfma_f32_16x16x32_bf16 v[188:191], a[0:3], a[252:255], v[188:191]
    v_mfma_f32_16x16x32_bf16 v[204:207], a[4:7], a[252:255], v[204:207]
    v_mfma_f32_16x16x32_bf16 v[220:223], a[8:11], a[252:255], v[220:223]
    v_mfma_f32_16x16x32_bf16 v[236:239], a[12:15], a[252:255], v[236:239]
    v_mfma_f32_16x16x32_bf16 v[252:255], a[16:19], a[252:255], v[252:255]
    buffer_load_dwordx4 a[252:255], v35, s[60:63], s15 offen sc1
    s_waitcnt vmcnt(16)
    v_mfma_f32_16x16x32_bf16 v[176:179], a[20:23], v[40:43], v[176:179]
    v_mfma_f32_16x16x32_bf16 v[192:195], a[24:27], v[40:43], v[192:195]
    v_mfma_f32_16x16x32_bf16 v[208:211], a[28:31], v[40:43], v[208:211]
    v_mfma_f32_16x16x32_bf16 v[224:227], a[32:35], v[40:43], v[224:227]
    v_mfma_f32_16x16x32_bf16 v[240:243], a[36:39], v[40:43], v[240:243]
    v_mfma_f32_16x16x32_bf16 v[180:183], a[20:23], v[44:47], v[180:183]
    v_mfma_f32_16x16x32_bf16 v[196:199], a[24:27], v[44:47], v[196:199]
    v_mfma_f32_16x16x32_bf16 v[212:215], a[28:31], v[44:47], v[212:215]
    v_mfma_f32_16x16x32_bf16 v[228:231], a[32:35], v[44:47], v[228:231]
    v_mfma_f32_16x16x32_bf16 v[244:247], a[36:39], v[44:47], v[244:247]
    v_mfma_f32_16x16x32_bf16 v[184:187], a[20:23], v[48:51], v[184:187]
    v_mfma_f32_16x16x32_bf16 v[200:203], a[24:27], v[48:51], v[200:203]
    v_mfma_f32_16x16x32_bf16 v[216:219], a[28:31], v[48:51], v[216:219]
    v_mfma_f32_16x16x32_bf16 v[232:235], a[32:35], v[48:51], v[232:235]
    v_mfma_f32_16x16x32_bf16 v[248:251], a[36:39], v[48:51], v[248:251]
    v_mfma_f32_16x16x32_bf16 v[188:191], a[20:23], v[52:55], v[188:191]
    v_mfma_f32_16x16x32_bf16 v[204:207], a[24:27], v[52:55], v[204:207]
    v_mfma_f32_16x16x32_bf16 v[220:223], a[28:31], v[52:55], v[220:223]
    v_mfma_f32_16x16x32_bf16 v[236:239], a[32:35], v[52:55], v[236:239]
    v_mfma_f32_16x16x32_bf16 v[252:255], a[36:39], v[52:55], v[252:255]
    s_waitcnt vmcnt(10)
    s_barrier
    s_waitcnt vmcnt(5)
    buffer_store_dwordx2 v[36:37], v24, s[60:63], s87 offen sc1
    v_mfma_f32_16x16x32_bf16 v[176:179], a[40:43], v[56:59], v[176:179]
    v_mfma_f32_16x16x32_bf16 v[192:195], a[44:47], v[56:59], v[192:195]
    v_mfma_f32_16x16x32_bf16 v[208:211], a[48:51], v[56:59], v[208:211]
    v_mfma_f32_16x16x32_bf16 v[224:227], a[52:55], v[56:59], v[224:227]
    v_mfma_f32_16x16x32_bf16 v[240:243], a[56:59], v[56:59], v[240:243]
    v_mfma_f32_16x16x32_bf16 v[180:183], a[40:43], v[60:63], v[180:183]
    v_mfma_f32_16x16x32_bf16 v[196:199], a[44:47], v[60:63], v[196:199]
    v_mfma_f32_16x16x32_bf16 v[212:215], a[48:51], v[60:63], v[212:215]
    v_mfma_f32_16x16x32_bf16 v[228:231], a[52:55], v[60:63], v[228:231]
    v_mfma_f32_16x16x32_bf16 v[244:247], a[56:59], v[60:63], v[244:247]
    v_mfma_f32_16x16x32_bf16 v[184:187], a[40:43], v[64:67], v[184:187]
    v_mfma_f32_16x16x32_bf16 v[200:203], a[44:47], v[64:67], v[200:203]
    v_mfma_f32_16x16x32_bf16 v[216:219], a[48:51], v[64:67], v[216:219]
    v_mfma_f32_16x16x32_bf16 v[232:235], a[52:55], v[64:67], v[232:235]
    v_mfma_f32_16x16x32_bf16 v[248:251], a[56:59], v[64:67], v[248:251]
    v_mfma_f32_16x16x32_bf16 v[188:191], a[40:43], v[68:71], v[188:191]
    v_mfma_f32_16x16x32_bf16 v[204:207], a[44:47], v[68:71], v[204:207]
    v_mfma_f32_16x16x32_bf16 v[220:223], a[48:51], v[68:71], v[220:223]
    v_mfma_f32_16x16x32_bf16 v[236:239], a[52:55], v[68:71], v[236:239]
    v_mfma_f32_16x16x32_bf16 v[252:255], a[56:59], v[68:71], v[252:255]
    s_waitcnt vmcnt(5)
    s_waitcnt lgkmcnt(0)
    s_load_dwordx2 s[36:37], s[48:49], s78 glc
    s_waitcnt vmcnt(1)
    v_mfma_f32_16x16x32_bf16 v[176:179], a[60:63], v[72:75], v[176:179]
    v_mfma_f32_16x16x32_bf16 v[192:195], a[64:67], v[72:75], v[192:195]
    v_mfma_f32_16x16x32_bf16 v[208:211], a[68:71], v[72:75], v[208:211]
    v_mfma_f32_16x16x32_bf16 v[224:227], a[72:75], v[72:75], v[224:227]
    v_mfma_f32_16x16x32_bf16 v[240:243], a[76:79], v[72:75], v[240:243]
    v_mfma_f32_16x16x32_bf16 v[176:179], a[80:83], a[100:103], v[176:179]
    v_mfma_f32_16x16x32_bf16 v[192:195], a[84:87], a[100:103], v[192:195]
    v_mfma_f32_16x16x32_bf16 v[208:211], a[88:91], a[100:103], v[208:211]
    v_mfma_f32_16x16x32_bf16 v[224:227], a[92:95], a[100:103], v[224:227]
    v_mfma_f32_16x16x32_bf16 v[240:243], a[96:99], a[100:103], v[240:243]
    v_mfma_f32_16x16x32_bf16 v[180:183], a[60:63], v[76:79], v[180:183]
    v_mfma_f32_16x16x32_bf16 v[196:199], a[64:67], v[76:79], v[196:199]
    v_mfma_f32_16x16x32_bf16 v[212:215], a[68:71], v[76:79], v[212:215]
    v_mfma_f32_16x16x32_bf16 v[228:231], a[72:75], v[76:79], v[228:231]
    ds_write_b128 v27, v[176:179] offset:0
    v_mfma_f32_16x16x32_bf16 v[244:247], a[76:79], v[76:79], v[244:247]
    v_mfma_f32_16x16x32_bf16 v[180:183], a[80:83], a[104:107], v[180:183]
    ds_write_b128 v27, v[192:195] offset:64
    v_mfma_f32_16x16x32_bf16 v[196:199], a[84:87], a[104:107], v[196:199]
    ds_write_b128 v27, v[208:211] offset:128
    v_mfma_f32_16x16x32_bf16 v[212:215], a[88:91], a[104:107], v[212:215]
    ds_write_b128 v27, v[224:227] offset:192
    v_mfma_f32_16x16x32_bf16 v[228:231], a[92:95], a[104:107], v[228:231]
    ds_write_b128 v27, v[240:243] offset:256
    v_mfma_f32_16x16x32_bf16 v[244:247], a[96:99], a[104:107], v[244:247]
    v_mfma_f32_16x16x32_bf16 v[184:187], a[60:63], v[80:83], v[184:187]
    v_mfma_f32_16x16x32_bf16 v[200:203], a[64:67], v[80:83], v[200:203]
    v_mfma_f32_16x16x32_bf16 v[216:219], a[68:71], v[80:83], v[216:219]
    s_waitcnt lgkmcnt(0)
    s_cmp_eq_u64 s[36:37], s[84:85]
    s_cbranch_scc0 L_xe_mlp
    buffer_load_dwordx4 v[40:43], v26, s[60:63], s86 offen offset:0 sc1
    buffer_load_dwordx4 v[44:47], v26, s[60:63], s86 offen offset:1024 sc1
    buffer_load_dwordx4 v[48:51], v26, s[60:63], s86 offen offset:2048 sc1
    buffer_load_dwordx4 v[52:55], v26, s[60:63], s86 offen offset:3072 sc1
    buffer_load_dwordx4 v[56:59], v26, s[60:63], s77 offen offset:0 sc1
L_xe_mlp:
    v_mfma_f32_16x16x32_bf16 v[232:235], a[72:75], v[80:83], v[232:235]
    ds_write_b128 v27, v[180:183] offset:5120
    v_mfma_f32_16x16x32_bf16 v[248:251], a[76:79], v[80:83], v[248:251]
    v_mfma_f32_16x16x32_bf16 v[184:187], a[80:83], a[248:251], v[184:187]
    ds_write_b128 v27, v[196:199] offset:5184
    v_mfma_f32_16x16x32_bf16 v[200:203], a[84:87], a[248:251], v[200:203]
    ds_write_b128 v27, v[212:215] offset:5248
    v_mfma_f32_16x16x32_bf16 v[216:219], a[88:91], a[248:251], v[216:219]
    ds_write_b128 v27, v[228:231] offset:5312
    v_mfma_f32_16x16x32_bf16 v[232:235], a[92:95], a[248:251], v[232:235]
    ds_write_b128 v27, v[244:247] offset:5376
    v_mfma_f32_16x16x32_bf16 v[248:251], a[96:99], a[248:251], v[248:251]
    v_mfma_f32_16x16x32_bf16 v[188:191], a[60:63], v[84:87], v[188:191]
    v_mfma_f32_16x16x32_bf16 v[204:207], a[64:67], v[84:87], v[204:207]
    v_mfma_f32_16x16x32_bf16 v[220:223], a[68:71], v[84:87], v[220:223]
    v_mfma_f32_16x16x32_bf16 v[236:239], a[72:75], v[84:87], v[236:239]
    ds_write_b128 v27, v[184:187] offset:10240
    v_mfma_f32_16x16x32_bf16 v[252:255], a[76:79], v[84:87], v[252:255]
    v_mfma_f32_16x16x32_bf16 v[188:191], a[80:83], a[252:255], v[188:191]
    ds_write_b128 v27, v[200:203] offset:10304
    v_mfma_f32_16x16x32_bf16 v[204:207], a[84:87], a[252:255], v[204:207]
    ds_write_b128 v27, v[216:219] offset:10368
    v_mfma_f32_16x16x32_bf16 v[220:223], a[88:91], a[252:255], v[220:223]
    ds_write_b128 v27, v[232:235] offset:10432
    v_mfma_f32_16x16x32_bf16 v[236:239], a[92:95], a[252:255], v[236:239]
    ds_write_b128 v27, v[248:251] offset:10496
    v_mfma_f32_16x16x32_bf16 v[252:255], a[96:99], a[252:255], v[252:255]
    s_cmp_eq_u64 s[36:37], s[84:85]
    s_cbranch_scc1 L_xd_mlp
L_xp_mlp:
    s_sub_u32 s81, s81, 1
    s_cbranch_scc1 L_end
    s_load_dwordx2 s[36:37], s[48:49], s78 glc
    s_waitcnt lgkmcnt(0)
    s_cmp_eq_u64 s[36:37], s[84:85]
    s_cbranch_scc0 L_xp_mlp
    buffer_load_dwordx4 v[40:43], v26, s[60:63], s86 offen offset:0 sc1
    buffer_load_dwordx4 v[44:47], v26, s[60:63], s86 offen offset:1024 sc1
    buffer_load_dwordx4 v[48:51], v26, s[60:63], s86 offen offset:2048 sc1
    buffer_load_dwordx4 v[52:55], v26, s[60:63], s86 offen offset:3072 sc1
    buffer_load_dwordx4 v[56:59], v26, s[60:63], s77 offen offset:0 sc1
L_xd_mlp:
    s_nop 2
    ds_write_b128 v27, v[188:191] offset:15360
    ds_write_b128 v27, v[204:207] offset:15424
    ds_write_b128 v27, v[220:223] offset:15488
    ds_write_b128 v27, v[236:239] offset:15552
    ds_write_b128 v27, v[252:255] offset:15616
    s_waitcnt lgkmcnt(0)
    s_barrier
    ds_read_b128 v[96:99], v88 offset:0
    ds_read_b128 v[100:103], v89 offset:0
    ds_read_b128 v[104:107], v90 offset:0
    ds_read_b128 v[108:111], v91 offset:0
    ds_read_b128 v[112:115], v88 offset:64
    ds_read_b128 v[116:119], v89 offset:64
    ds_read_b128 v[120:123], v90 offset:64
    ds_read_b128 v[124:127], v91 offset:64
    ds_read_b128 v[128:131], v88 offset:128
    ds_read_b128 v[132:135], v89 offset:128
    ds_read_b128 v[136:139], v90 offset:128
    ds_read_b128 v[140:143], v91 offset:128
    ds_read_b128 v[144:147], v88 offset:192
    ds_read_b128 v[148:151], v89 offset:192
    ds_read_b128 v[152:155], v90 offset:192
    ds_read_b128 v[156:159], v91 offset:192
    ds_read_b128 v[160:163], v88 offset:256
    ds_read_b128 v[164:167], v89 offset:256
    ds_read_b128 v[168:171], v90 offset:256
    ds_read_b128 v[172:175], v91 offset:256
    s_waitcnt lgkmcnt(15)
    v_pk_add_f32 v[96:97], v[96:97], v[100:101]
    v_pk_add_f32 v[98:99], v[98:99], v[102:103]
    v_pk_add_f32 v[104:105], v[104:105], v[108:109]
    v_pk_add_f32 v[106:107], v[106:107], v[110:111]
    v_pk_add_f32 v[4:5], v[4:5], v[96:97]
    v_pk_add_f32 v[6:7], v[6:7], v[98:99]
    v_pk_add_f32 v[4:5], v[4:5], v[104:105]
    v_pk_add_f32 v[6:7], v[6:7], v[106:107]
    s_waitcnt lgkmcnt(12)
    v_pk_add_f32 v[112:113], v[112:113], v[116:117]
    v_pk_add_f32 v[114:115], v[114:115], v[118:119]
    v_pk_add_f32 v[120:121], v[120:121], v[124:125]
    v_pk_add_f32 v[122:123], v[122:123], v[126:127]
    v_pk_add_f32 v[8:9], v[8:9], v[112:113]
    v_pk_add_f32 v[10:11], v[10:11], v[114:115]
    v_pk_add_f32 v[8:9], v[8:9], v[120:121]
    v_pk_add_f32 v[10:11], v[10:11], v[122:123]
    s_waitcnt lgkmcnt(8)
    v_pk_add_f32 v[128:129], v[128:129], v[132:133]
    v_pk_add_f32 v[130:131], v[130:131], v[134:135]
    v_pk_add_f32 v[136:137], v[136:137], v[140:141]
    v_pk_add_f32 v[138:139], v[138:139], v[142:143]
    v_pk_add_f32 v[12:13], v[12:13], v[128:129]
    v_pk_add_f32 v[14:15], v[14:15], v[130:131]
    v_pk_add_f32 v[12:13], v[12:13], v[136:137]
    v_pk_add_f32 v[14:15], v[14:15], v[138:139]
    s_waitcnt lgkmcnt(4)
    v_pk_add_f32 v[144:145], v[144:145], v[148:149]
    v_pk_add_f32 v[146:147], v[146:147], v[150:151]
    v_pk_add_f32 v[152:153], v[152:153], v[156:157]
    v_pk_add_f32 v[154:155], v[154:155], v[158:159]
    v_pk_add_f32 v[16:17], v[16:17], v[144:145]
    v_pk_add_f32 v[18:19], v[18:19], v[146:147]
    v_pk_add_f32 v[16:17], v[16:17], v[152:153]
    v_pk_add_f32 v[18:19], v[18:19], v[154:155]
    s_waitcnt lgkmcnt(0)
    v_pk_add_f32 v[160:161], v[160:161], v[164:165]
    v_pk_add_f32 v[162:163], v[162:163], v[166:167]
    v_pk_add_f32 v[168:169], v[168:169], v[172:173]
    v_pk_add_f32 v[170:171], v[170:171], v[174:175]
    v_pk_add_f32 v[20:21], v[20:21], v[160:161]
    v_pk_add_f32 v[22:23], v[22:23], v[162:163]
    v_pk_add_f32 v[20:21], v[20:21], v[168:169]
    v_pk_add_f32 v[22:23], v[22:23], v[170:171]
    s_waitcnt vmcnt(0)
    v_pk_add_f32 v[4:5], v[4:5], v[40:41]
    v_pk_add_f32 v[6:7], v[6:7], v[42:43]
    buffer_store_dwordx4 v[4:7], v38, s[56:59], s76 offen offset:0 nt
    v_pk_add_f32 v[8:9], v[8:9], v[44:45]
    v_pk_add_f32 v[10:11], v[10:11], v[46:47]
    buffer_store_dwordx4 v[8:11], v38, s[56:59], s76 offen offset:64 nt
    v_pk_add_f32 v[12:13], v[12:13], v[48:49]
    v_pk_add_f32 v[14:15], v[14:15], v[50:51]
    buffer_store_dwordx4 v[12:15], v38, s[56:59], s76 offen offset:128 nt
    v_pk_add_f32 v[16:17], v[16:17], v[52:53]
    v_pk_add_f32 v[18:19], v[18:19], v[54:55]
    buffer_store_dwordx4 v[16:19], v38, s[56:59], s76 offen offset:192 nt
    v_pk_add_f32 v[20:21], v[20:21], v[56:57]
    v_pk_add_f32 v[22:23], v[22:23], v[58:59]
    buffer_store_dwordx4 v[20:23], v38, s[56:59], s76 offen offset:256 nt
    s_endpgm
L_end:
    s_endpgm
L_code_end:
.set CODE_BYTES, L_code_end - parallel_sum__ssm_conv_s5__mixer_channel_mlp__prompt_kernel - 512
.section .rodata,"a"
.p2align 6
.amdhsa_kernel parallel_sum__ssm_conv_s5__mixer_channel_mlp__prompt_kernel
  .amdhsa_next_free_vgpr 512
  .amdhsa_next_free_sgpr 102
  .amdhsa_accum_offset 256
  .amdhsa_group_segment_fixed_size 0
  .amdhsa_kernarg_size 136
  .amdhsa_user_sgpr_count 2
  .amdhsa_user_sgpr_kernarg_segment_ptr 1
  .amdhsa_system_sgpr_workgroup_id_x 1
.end_amdhsa_kernel
```
